```python
import torch

def _softmax(x, axis=-1):
    return torch.softmax(x, dim=axis)
def _gelu(x):
    return torch.nn.functional.gelu(x, approximate="tanh")
def _silu(x):
    return torch.nn.functional.silu(x)
def _sigmoid(x):
    return torch.sigmoid(x)
def _layernorm(x, axis=-1, eps=1e-5):
    m = x.mean(dim=axis, keepdim=True)
    v = x.var(dim=axis, keepdim=True, unbiased=False)
    return (x - m) / torch.sqrt(v + eps)
def _scatter_add(tgt, idx, src, axis=0):
    return tgt.clone().index_add_(axis, idx, src)
def _segment_sum(src, seg, n):
    out = torch.zeros((n,) + src.shape[1:], dtype=src.dtype)
    return out.index_add_(0, seg, src)
def _pad(x, pw):
    flat = tuple(v for pair in reversed(pw) for v in pair)
    return torch.nn.functional.pad(x, flat)

kernel_name = 'interleave_layers__grouped_kv_mqa__dense_activation_mish__prompt'

def setup_inputs():

    _w = (lambda a: (lambda t: t.to(torch.bfloat16) if t.is_floating_point() else t)(torch.as_tensor(a)))
    def _A_setup():
        B, S, D, H = 1, 2048, 640, 32
        Dh = D // H
        return {
            "x": _w((lambda *s: torch.randn(*s, dtype=torch.bfloat16) * 0.05)(B, S, D)),
            "wq": _w((lambda *s: torch.randn(*s, dtype=torch.bfloat16) * 0.05)(D, H * Dh)),
            "wk": _w((lambda *s: torch.randn(*s, dtype=torch.bfloat16) * 0.05)(D, Dh)),
            "wv": _w((lambda *s: torch.randn(*s, dtype=torch.bfloat16) * 0.05)(D, Dh)),
            "wo": _w((lambda *s: torch.randn(*s, dtype=torch.bfloat16) * 0.05)(H * Dh, D)),
        }
    _A_in = _A_setup()

    def _B_setup():
        B, S, D, F = 1, 2048, 640, 1728
        return {
            "x": _w((lambda *s: torch.randn(*s, dtype=torch.bfloat16) * 0.05)(B, S, D)),
            "w1": _w((lambda *s: torch.randn(*s, dtype=torch.bfloat16) * 1.6)(D, F) * (D ** -0.5)),
            "b1": _w((lambda *s: torch.randn(*s, dtype=torch.bfloat16) * 0.2)(F)),
            "w2": _w((lambda *s: torch.randn(*s, dtype=torch.bfloat16) * 0.2)(F, D) * (F ** -0.5)),
        }
    _B_in = _B_setup()

    return {
        "A_x": _A_in["x"],
        "A_wq": _A_in["wq"],
        "A_wk": _A_in["wk"],
        "A_wv": _A_in["wv"],
        "A_wo": _A_in["wo"],
        "B_x": _B_in["x"],
        "B_w1": _B_in["w1"],
        "B_b1": _B_in["b1"],
        "B_w2": _B_in["w2"],
    }

def reference(A_x, A_wq, A_wk, A_wv, A_wo, B_x, B_w1, B_b1, B_w2):
    def _A_ref(x, wq, wk, wv, wo):
        B, S, D = x.shape
        H = 32
        Dh = D // H
        q = (lambda x, *d: x.permute(*d))((x @ wq).reshape(B, S, H, Dh), 0, 2, 1, 3)
        k = x @ wk
        v = x @ wv
        scores = torch.einsum("bhqd,bkd->bhqk", q, k) * (Dh ** -0.5)
        p = _softmax(scores, axis=-1)
        o = torch.einsum("bhqk,bkd->bhqd", p, v)
        return (lambda x, *d: x.permute(*d))(o, 0, 2, 1, 3).reshape(B, S, H * Dh) @ wo

    def _B_ref(x, w1, b1, w2):
        h = torch.einsum("bsd,df->bsf", x, w1) + b1
        sp = torch.log1p(torch.exp(-torch.abs(h))) + torch.where(h > 0, h, torch.zeros_like(h))
        act = h * torch.tanh(sp)
        return torch.einsum("bsf,fd->bsd", act, w2)

    x = A_x
    x = x + _A_ref(_layernorm(x, axis=-1), A_wq, A_wk, A_wv, A_wo)
    x = x + _B_ref(_layernorm(x, axis=-1), B_w1, B_b1, B_w2)
    x = x + _A_ref(_layernorm(x, axis=-1), A_wq, A_wk, A_wv, A_wo)
    x = x + _B_ref(_layernorm(x, axis=-1), B_w1, B_b1, B_w2)
    return x
```

```asm
; @launch grid=(256,1,1) block=(256,1,1) lds=163840
.amdgcn_target "amdgcn-amd-amdhsa--gfx950"
.text
.globl interleave_layers__grouped_kv_mqa__dense_activation_mish__prompt_kernel
.p2align 8
.type interleave_layers__grouped_kv_mqa__dense_activation_mish__prompt_kernel,@function
interleave_layers__grouped_kv_mqa__dense_activation_mish__prompt_kernel:
    s_cmp_ge_u32 s2, 256
    s_cbranch_scc1 L_end
    s_cmp_ge_u32 s2, 16
    s_cbranch_scc1 L_noct
    s_getpc_b64 s[62:63]
L_pc0:
    s_lshr_b32 s30, s2, 3
    s_and_b32 s30, s30, 1
    s_lshl_b32 s30, s30, 15
    v_lshlrev_b32 v5, 7, v0
    v_add_u32 v5, s30, v5
    v_min_u32 v5, L_codeend-L_pc0-4, v5
    global_load_dword v255, v5, s[62:63]
L_noct:
    s_load_dwordx8 s[36:43], s[0:1], 0
    s_load_dwordx2 s[96:97], s[0:1], 32
    s_load_dwordx2 s[98:99], s[0:1], 48
    s_load_dwordx2 s[56:57], s[0:1], 56
    s_load_dwordx2 s[100:101], s[0:1], 64
    s_load_dwordx2 s[58:59], s[0:1], 72
    s_load_dwordx2 s[60:61], s[0:1], 88
    v_lshrrev_b32 v2, 6, v0
    v_and_b32 v0, 63, v0
    v_readfirstlane_b32 s20, v2
    v_lshlrev_b32 v1, 4, v0
    v_lshlrev_b32 v2, 3, v0
    v_and_b32 v3, 15, v0
    v_lshrrev_b32 v4, 4, v0
    s_and_b32 s21, s2, 7
    s_lshr_b32 s22, s2, 3
    s_lshl_b32 s23, s21, 2
    s_lshr_b32 s30, s22, 3
    s_add_u32 s23, s23, s30
    s_and_b32 s24, s22, 7
    s_lshl_b32 s25, s21, 1
    s_lshr_b32 s30, s22, 4
    s_add_u32 s25, s25, s30
    s_and_b32 s26, s22, 15
    s_mov_b32 s28, 0
    s_mov_b32 s29, 1
    s_mov_b32 s76, 0
    s_getreg_b32 s75, hwreg(HW_REG_XCC_ID, 0, 3)
    s_cmp_lt_u32 s2, 160
    s_cselect_b32 s73, 0, 1
    s_or_b32 s73, s73, s20
    s_cbranch_scc1 L_nowq1
    s_lshr_b32 s47, s2, 3
    s_and_b32 s48, s2, 7
    s_mul_i32 s49, s47, 52
    s_lshr_b32 s49, s49, 8
    s_mul_i32 s50, s49, 5
    s_sub_u32 s50, s47, s50
    s_mul_i32 s31, s49, 160
    s_lshl_b32 s32, s50, 5
    s_add_u32 s31, s31, s32
    s_cmp_gt_u32 s50, 2
    s_cselect_b32 s32, 16, 0
    s_sub_u32 s31, s31, s32
    s_cmp_eq_u32 s50, 2
    s_cselect_b32 s32, 80, 16
    s_mov_b32 s33, 8
    s_mov_b32 s34, 4
    s_mov_b32 s44, 0
    s_mov_b32 s45, 0
    s_mul_i32 s46, s48, 160
    s_mul_i32 s67, s48, 20
    s_add_u32 s67, s67, s47
    s_mul_i32 s68, s67, 384
    s_add_u32 s68, s68, 999424
    s_mul_i32 s67, s67, 6144
    s_add_u32 s67, s67, 16384
    s_lshl_b32 s66, s48, 5
    s_add_u32 s66, s66, s47
    s_lshl_b32 s66, s66, 2
    s_add_u32 s66, s66, 12288
    s_movk_i32 s52, 6554
    s_movk_i32 s53, 1280
    s_add_u32 s46, s46, s44
    v_add_u32 v5, 0, v0
    v_mul_u32_u24 v6, s52, v5
    v_lshrrev_b32 v6, 16, v6
    v_mul_u32_u24 v7, 10, v6
    v_sub_u32 v5, v5, v7
    v_lshrrev_b32 v7, 4, v6
    v_mul_u32_u24 v18, s32, v7
    v_bfe_u32 v7, v6, 3, 1
    v_mad_u32_u24 v18, v7, s33, v18
    v_bfe_u32 v7, v6, 2, 1
    v_mad_u32_u24 v18, v7, s34, v18
    v_and_b32 v6, 3, v6
    v_add3_u32 v18, v18, v6, s31
    v_mul_u32_u24 v18, s53, v18
    v_lshl_add_u32 v18, v5, 4, v18
    v_add_u32 v100, s46, v18
    v_add_u32 v5, 64, v0
    v_mul_u32_u24 v6, s52, v5
    v_lshrrev_b32 v6, 16, v6
    v_mul_u32_u24 v7, 10, v6
    v_sub_u32 v5, v5, v7
    v_lshrrev_b32 v7, 4, v6
    v_mul_u32_u24 v18, s32, v7
    v_bfe_u32 v7, v6, 3, 1
    v_mad_u32_u24 v18, v7, s33, v18
    v_bfe_u32 v7, v6, 2, 1
    v_mad_u32_u24 v18, v7, s34, v18
    v_and_b32 v6, 3, v6
    v_add3_u32 v18, v18, v6, s31
    v_mul_u32_u24 v18, s53, v18
    v_lshl_add_u32 v18, v5, 4, v18
    v_add_u32 v101, s46, v18
    v_add_u32 v5, 128, v0
    v_mul_u32_u24 v6, s52, v5
    v_lshrrev_b32 v6, 16, v6
    v_mul_u32_u24 v7, 10, v6
    v_sub_u32 v5, v5, v7
    v_lshrrev_b32 v7, 4, v6
    v_mul_u32_u24 v18, s32, v7
    v_bfe_u32 v7, v6, 3, 1
    v_mad_u32_u24 v18, v7, s33, v18
    v_bfe_u32 v7, v6, 2, 1
    v_mad_u32_u24 v18, v7, s34, v18
    v_and_b32 v6, 3, v6
    v_add3_u32 v18, v18, v6, s31
    v_mul_u32_u24 v18, s53, v18
    v_lshl_add_u32 v18, v5, 4, v18
    v_add_u32 v102, s46, v18
    v_add_u32 v5, 192, v0
    v_mul_u32_u24 v6, s52, v5
    v_lshrrev_b32 v6, 16, v6
    v_mul_u32_u24 v7, 10, v6
    v_sub_u32 v5, v5, v7
    v_lshrrev_b32 v7, 4, v6
    v_mul_u32_u24 v18, s32, v7
    v_bfe_u32 v7, v6, 3, 1
    v_mad_u32_u24 v18, v7, s33, v18
    v_bfe_u32 v7, v6, 2, 1
    v_mad_u32_u24 v18, v7, s34, v18
    v_and_b32 v6, 3, v6
    v_add3_u32 v18, v18, v6, s31
    v_mul_u32_u24 v18, s53, v18
    v_lshl_add_u32 v18, v5, 4, v18
    v_add_u32 v103, s46, v18
    v_add_u32 v5, 256, v0
    v_mul_u32_u24 v6, s52, v5
    v_lshrrev_b32 v6, 16, v6
    v_mul_u32_u24 v7, 10, v6
    v_sub_u32 v5, v5, v7
    v_lshrrev_b32 v7, 4, v6
    v_mul_u32_u24 v18, s32, v7
    v_bfe_u32 v7, v6, 3, 1
    v_mad_u32_u24 v18, v7, s33, v18
    v_bfe_u32 v7, v6, 2, 1
    v_mad_u32_u24 v18, v7, s34, v18
    v_and_b32 v6, 3, v6
    v_add3_u32 v18, v18, v6, s31
    v_mul_u32_u24 v18, s53, v18
    v_lshl_add_u32 v18, v5, 4, v18
    v_add_u32 v104, s46, v18
    s_waitcnt lgkmcnt(0)
    s_mov_b32 s84, s38
    s_mov_b32 s85, s39
    s_mov_b32 s86, 819200
    s_mov_b32 s87, 0x20000
    s_bitcmp1_b32 s2, 1
    s_cselect_b32 s88, s42, s40
    s_cselect_b32 s89, s43, s41
    s_mov_b32 s90, 25600
    s_mov_b32 s91, 0x20000
    s_mov_b32 m0, 86016
    s_nop 0
    buffer_load_dwordx4 v100, s[84:87], 0 offen lds
    s_mov_b32 m0, 87040
    s_nop 0
    buffer_load_dwordx4 v101, s[84:87], 0 offen lds
    s_mov_b32 m0, 88064
    s_nop 0
    buffer_load_dwordx4 v102, s[84:87], 0 offen lds
    s_mov_b32 m0, 89088
    s_nop 0
    buffer_load_dwordx4 v103, s[84:87], 0 offen lds
    s_mov_b32 m0, 90112
    s_nop 0
    buffer_load_dwordx4 v104, s[84:87], 0 offen lds
    s_mul_i32 s31, s31, 40
    s_mul_i32 s32, s32, 40
    s_add_u32 s32, s32, s31
    s_mov_b32 m0, 91136
    s_nop 0
    buffer_load_dwordx4 v1, s[88:91], s31 offen lds
    s_mov_b32 m0, 92160
    s_nop 0
    buffer_load_dwordx4 v1, s[88:91], s32 offen lds
L_nowq1:
    s_movk_i32 s54, 1280
    s_mul_i32 s30, s23, 81920
    s_mul_i32 s31, s20, 20480
    s_add_u32 s30, s30, s31
    s_mul_i32 s64, s20, 20480
    v_add_u32 v5, 0, v4
    v_and_b32 v5, 15, v5
    v_xor_b32 v5, v5, v3
    v_lshlrev_b32 v5, 4, v5
    v_mad_u32_u24 v100, v4, s54, v5
    v_add_u32 v5, 4, v4
    v_and_b32 v5, 15, v5
    v_xor_b32 v5, v5, v3
    v_lshlrev_b32 v5, 4, v5
    v_mad_u32_u24 v101, v4, s54, v5
    v_add_u32 v5, 8, v4
    v_and_b32 v5, 15, v5
    v_xor_b32 v5, v5, v3
    v_lshlrev_b32 v5, 4, v5
    v_mad_u32_u24 v102, v4, s54, v5
    v_add_u32 v5, 12, v4
    v_and_b32 v5, 15, v5
    v_xor_b32 v5, v5, v3
    v_lshlrev_b32 v5, 4, v5
    v_mad_u32_u24 v103, v4, s54, v5
    s_lshl_b32 s31, s20, 2
    v_add_u32 v5, s31, v4
    v_and_b32 v5, 15, v5
    v_xor_b32 v5, v5, v3
    v_lshlrev_b32 v5, 4, v5
    v_mad_u32_u24 v105, v4, s54, v5
    s_waitcnt lgkmcnt(0)
    s_mov_b32 s80, s36
    s_mov_b32 s81, s37
    s_mov_b32 s82, 2621440
    s_mov_b32 s83, 0x20000
    s_bitcmp1_b32 s24, 1
    s_cselect_b32 s16, s42, s40
    s_cselect_b32 s17, s43, s41
    s_mov_b32 s18, 25600
    s_mov_b32 s19, 0x20000
    s_cmp_eq_u32 s20, 0
    s_cbranch_scc1 L_x0done
    s_add_u32 m0, s64, 0
    s_add_u32 s32, s30, 0
    buffer_load_dwordx4 v100, s[80:83], s32 offen lds
    s_add_u32 m0, s64, 1024
    s_add_u32 s32, s30, 256
    buffer_load_dwordx4 v100, s[80:83], s32 offen lds
    s_add_u32 m0, s64, 2048
    s_add_u32 s32, s30, 512
    buffer_load_dwordx4 v100, s[80:83], s32 offen lds
    s_add_u32 m0, s64, 3072
    s_add_u32 s32, s30, 768
    buffer_load_dwordx4 v100, s[80:83], s32 offen lds
    s_add_u32 m0, s64, 4096
    s_add_u32 s32, s30, 1024
    buffer_load_dwordx4 v100, s[80:83], s32 offen lds
    s_add_u32 m0, s64, 5120
    s_add_u32 s32, s30, 5120
    buffer_load_dwordx4 v101, s[80:83], s32 offen lds
    s_add_u32 m0, s64, 6144
    s_add_u32 s32, s30, 5376
    buffer_load_dwordx4 v101, s[80:83], s32 offen lds
    s_add_u32 m0, s64, 7168
    s_add_u32 s32, s30, 5632
    buffer_load_dwordx4 v101, s[80:83], s32 offen lds
    s_add_u32 m0, s64, 8192
    s_add_u32 s32, s30, 5888
    buffer_load_dwordx4 v101, s[80:83], s32 offen lds
    s_add_u32 m0, s64, 9216
    s_add_u32 s32, s30, 6144
    buffer_load_dwordx4 v101, s[80:83], s32 offen lds
    s_add_u32 m0, s64, 10240
    s_add_u32 s32, s30, 10240
    buffer_load_dwordx4 v102, s[80:83], s32 offen lds
    s_add_u32 m0, s64, 11264
    s_add_u32 s32, s30, 10496
    buffer_load_dwordx4 v102, s[80:83], s32 offen lds
    s_add_u32 m0, s64, 12288
    s_add_u32 s32, s30, 10752
    buffer_load_dwordx4 v102, s[80:83], s32 offen lds
    s_add_u32 m0, s64, 13312
    s_add_u32 s32, s30, 11008
    buffer_load_dwordx4 v102, s[80:83], s32 offen lds
    s_add_u32 m0, s64, 14336
    s_add_u32 s32, s30, 11264
    buffer_load_dwordx4 v102, s[80:83], s32 offen lds
    s_add_u32 m0, s64, 15360
    s_add_u32 s32, s30, 15360
    buffer_load_dwordx4 v103, s[80:83], s32 offen lds
    s_add_u32 m0, s64, 16384
    s_add_u32 s32, s30, 15616
    buffer_load_dwordx4 v103, s[80:83], s32 offen lds
    s_add_u32 m0, s64, 17408
    s_add_u32 s32, s30, 15872
    buffer_load_dwordx4 v103, s[80:83], s32 offen lds
    s_add_u32 m0, s64, 18432
    s_add_u32 s32, s30, 16128
    buffer_load_dwordx4 v103, s[80:83], s32 offen lds
    s_add_u32 m0, s64, 19456
    s_add_u32 s32, s30, 16384
    buffer_load_dwordx4 v103, s[80:83], s32 offen lds
    s_mul_i32 s30, s23, 81920
    s_mul_i32 s31, s20, 5120
    s_add_u32 m0, s31, 0
    s_add_u32 s32, s30, s31
    s_add_u32 s32, s32, 0
    buffer_load_dwordx4 v105, s[80:83], s32 offen lds
    s_add_u32 m0, s31, 1024
    s_add_u32 s32, s30, s31
    s_add_u32 s32, s32, 256
    buffer_load_dwordx4 v105, s[80:83], s32 offen lds
    s_add_u32 m0, s31, 2048
    s_add_u32 s32, s30, s31
    s_add_u32 s32, s32, 512
    buffer_load_dwordx4 v105, s[80:83], s32 offen lds
    s_add_u32 m0, s31, 3072
    s_add_u32 s32, s30, s31
    s_add_u32 s32, s32, 768
    buffer_load_dwordx4 v105, s[80:83], s32 offen lds
    s_add_u32 m0, s31, 4096
    s_add_u32 s32, s30, s31
    s_add_u32 s32, s32, 1024
    buffer_load_dwordx4 v105, s[80:83], s32 offen lds
    s_lshl_b32 s31, s20, 1
    s_add_u32 s31, s31, 0
    s_sub_u32 s31, s31, 2
    s_min_u32 s31, s31, 4
    s_lshl_b32 s32, s31, 10
    s_add_u32 m0, s32, 0
    s_lshl_b32 s32, s31, 8
    s_add_u32 s32, s32, s30
    buffer_load_dwordx4 v100, s[80:83], s32 offen lds
    s_lshl_b32 s31, s20, 1
    s_add_u32 s31, s31, 1
    s_sub_u32 s31, s31, 2
    s_min_u32 s31, s31, 4
    s_lshl_b32 s32, s31, 10
    s_add_u32 m0, s32, 0
    s_lshl_b32 s32, s31, 8
    s_add_u32 s32, s32, s30
    buffer_load_dwordx4 v100, s[80:83], s32 offen lds
    s_sub_u32 s31, s20, 1
    s_mul_i32 s52, s31, 9216
    s_add_u32 s53, s52, 94208
    s_mov_b32 m0, s53
    s_nop 0
    buffer_load_dwordx4 v1, s[16:19], s52 offen offset:0 lds
    buffer_load_dwordx4 v1, s[16:19], s52 offen offset:1024 lds
    buffer_load_dwordx4 v1, s[16:19], s52 offen offset:2048 lds
    buffer_load_dwordx4 v1, s[16:19], s52 offen offset:3072 lds
    s_add_u32 s52, s52, 4096
    s_add_u32 s53, s53, 4096
    s_mov_b32 m0, s53
    s_nop 0
    buffer_load_dwordx4 v1, s[16:19], s52 offen offset:0 lds
    buffer_load_dwordx4 v1, s[16:19], s52 offen offset:1024 lds
    buffer_load_dwordx4 v1, s[16:19], s52 offen offset:2048 lds
    buffer_load_dwordx4 v1, s[16:19], s52 offen offset:3072 lds
    s_add_u32 s52, s52, 4096
    s_add_u32 s53, s53, 4096
    s_mov_b32 m0, s53
    s_nop 0
    buffer_load_dwordx4 v1, s[16:19], s52 offen offset:0 lds
L_x0done:
    s_load_dword s27, s[60:61], 0
    s_mov_b32 s4, s60
    s_mov_b32 s5, s61
    s_mov_b32 s6, 20905984
    s_mov_b32 s7, 0x20000
    s_mov_b32 s8, s58
    s_mov_b32 s9, s59
    s_mov_b32 s10, 2621440
    s_mov_b32 s11, 0x20000
    s_mov_b32 s12, s56
    s_mov_b32 s13, s57
    s_mov_b32 s14, 3456
    s_mov_b32 s15, 0x20000
    s_mov_b32 s92, s96
    s_mov_b32 s93, s97
    s_mov_b32 s94, 819200
    s_mov_b32 s95, 0x20000
    v_mov_b32 v192, 0x3f803f80
    v_mov_b32 v193, 0x3f803f80
    v_mov_b32 v194, 0x3f803f80
    v_mov_b32 v195, 0x3f803f80
    s_cmp_ge_u32 s2, 160
    s_cselect_b32 s36, 0, 1
    s_or_b32 s36, s36, s20
    s_cbranch_scc1 L_notouch
    s_sub_u32 s36, s2, 160
    s_lshl_b32 s37, s36, 13
    s_add_u32 s37, s37, 6873088
    s_cmp_eq_u32 s36, 50
    s_cselect_b32 s37, 8192, s37
    s_cmp_gt_u32 s36, 50
    s_cbranch_scc1 L_notouch
    v_lshlrev_b32 v5, 7, v0
    buffer_load_dword v254, v5, s[4:7], s37 offen
L_notouch:
    s_mov_b32 s53, 0
    s_mul_i32 s54, s26, 7
    s_mul_i32 s58, s26, 6
    s_add_u32 s58, s58, 12
    s_cmp_lt_u32 s26, 12
    s_cselect_b32 s54, s54, s58
    s_cselect_b32 s58, 7, 6
    s_add_u32 s54, s54, s53
    s_cmp_lt_u32 s53, s58
    s_cselect_b32 s56, 0, 1073741824
    s_mov_b32 s53, 6
    s_mul_i32 s55, s26, 7
    s_mul_i32 s58, s26, 6
    s_add_u32 s58, s58, 12
    s_cmp_lt_u32 s26, 12
    s_cselect_b32 s55, s55, s58
    s_cselect_b32 s58, 7, 6
    s_add_u32 s55, s55, s53
    s_cmp_lt_u32 s53, s58
    s_cselect_b32 s57, 0, 1073741824
    s_lshl_b32 s54, s54, 5
    v_mov_b32 v6, s57
    v_cmp_lt_u32 vcc, 23, v0
    s_nop 1
    v_cndmask_b32 v6, 0, v6, vcc
    v_add_u32 v6, v6, v2
    buffer_load_dwordx2 v[252:253], v6, s[12:15], s54 offen
    s_waitcnt lgkmcnt(0)
    s_mul_i32 s27, s27, 1664525
    s_add_u32 s27, s27, 1013904223
    s_and_b32 s36, s27, 0xfffffff8
    s_or_b32 s75, s75, s36
    s_lshl_b32 s30, s2, 1
    s_and_b32 s31, s20, 1
    s_add_u32 s30, s30, s31
    s_movk_i32 s31, 192
    s_cmp_lt_u32 s2, 160
    s_cselect_b32 s31, 608, s31
    s_cmp_lt_u32 s20, 2
    s_cselect_b32 s31, s31, 0
    s_add_u32 s30, s30, s31
    s_cmp_ge_u32 s2, 208
    s_cselect_b32 s31, 1024, 0
    s_cmp_lt_u32 s20, 2
    s_cselect_b32 s31, s31, 0
    s_add_u32 s30, s30, s31
    s_min_u32 s31, s20, 2
    s_mul_i32 s72, s31, 7168
    s_cmp_eq_u32 s20, 3
    s_cselect_b32 s31, 5120, 0
    s_add_u32 s72, s72, s31
    s_add_u32 s72, s72, 122880
    s_cmp_lt_u32 s20, 2
    s_cselect_b32 s65, s72, 78848
    v_mov_b32 v244, 1073741824
    v_mov_b32 v245, 1073741824
    v_mov_b32 v246, 1073741824
    v_mov_b32 v247, 1073741824
    v_mov_b32 v248, 1073741824
    v_mov_b32 v249, 1073741824
    v_mov_b32 v250, 1073741824
    s_cmp_ge_u32 s30, 928
    s_cbranch_scc1 L_ppnone_3
    s_cmp_ge_u32 s30, 608
    s_cbranch_scc1 L_ppw1_2
    s_cmp_ge_u32 s30, 160
    s_cbranch_scc1 L_ppw2_1
    s_lshr_b32 s47, s30, 3
    s_and_b32 s48, s30, 7
    s_mul_i32 s49, s47, 52
    s_lshr_b32 s49, s49, 8
    s_mul_i32 s50, s49, 5
    s_sub_u32 s50, s47, s50
    s_mul_i32 s31, s49, 160
    s_mul_i32 s32, s50, 40
    s_cmp_gt_u32 s50, 2
    s_cselect_b32 s33, 40, 0
    s_sub_u32 s32, s32, s33
    s_cmp_eq_u32 s50, 2
    s_cselect_b32 s32, 16, s32
    s_add_u32 s31, s31, s32
    s_cmp_eq_u32 s50, 2
    s_cselect_b32 s32, 80, 8
    s_cselect_b32 s33, 40, 20
    s_cselect_b32 s34, 20, 4
    s_mov_b32 s44, 0
    s_mov_b32 s45, 0
    s_mul_i32 s46, s48, 160
    s_mul_i32 s70, s48, 20
    s_add_u32 s70, s70, s47
    s_mul_i32 s70, s70, 5120
    s_add_u32 s70, s70, 1060864
    s_mov_b32 s92, s96
    s_mov_b32 s93, s97
    s_mov_b32 s94, 819200
    s_branch L_ppn10_4
L_ppw2_1:
    s_sub_u32 s30, s30, 160
    s_lshr_b32 s47, s30, 3
    s_and_b32 s48, s30, 7
    s_mul_i32 s49, s47, 37
    s_lshr_b32 s49, s49, 8
    s_mul_i32 s50, s49, 7
    s_sub_u32 s50, s47, s50
    s_lshl_b32 s49, s49, 1
    s_cmp_gt_u32 s50, 3
    s_cselect_b32 s52, 1, 0
    s_cselect_b32 s53, 4, 0
    s_sub_u32 s53, s50, s53
    s_lshl_b32 s53, s53, 1
    s_add_u32 s53, s53, 0
    s_cmp_eq_u32 s50, 3
    s_cselect_b32 s52, 0, s52
    s_cselect_b32 s53, 6, s53
    s_add_u32 s52, s52, s49
    s_mul_i32 s31, s52, 7
    s_mul_i32 s54, s52, 6
    s_add_u32 s54, s54, 12
    s_cmp_lt_u32 s52, 12
    s_cselect_b32 s31, s31, s54
    s_cselect_b32 s54, 7, 6
    s_add_u32 s31, s31, s53
    s_cmp_lt_u32 s53, s54
    s_cselect_b32 s44, 0, 1073741824
    s_cmp_gt_u32 s50, 3
    s_cselect_b32 s52, 1, 0
    s_cselect_b32 s53, 4, 0
    s_sub_u32 s53, s50, s53
    s_lshl_b32 s53, s53, 1
    s_add_u32 s53, s53, 1
    s_cmp_eq_u32 s50, 3
    s_cselect_b32 s52, 1, s52
    s_cselect_b32 s53, 6, s53
    s_add_u32 s52, s52, s49
    s_mul_i32 s32, s52, 7
    s_mul_i32 s54, s52, 6
    s_add_u32 s54, s54, 12
    s_cmp_lt_u32 s52, 12
    s_cselect_b32 s32, s32, s54
    s_cselect_b32 s54, 7, 6
    s_add_u32 s32, s32, s53
    s_cmp_lt_u32 s53, s54
    s_cselect_b32 s45, 0, 1073741824
    s_lshl_b32 s31, s31, 4
    s_lshl_b32 s32, s32, 4
    s_sub_u32 s32, s32, s31
    s_mov_b32 s33, 8
    s_mov_b32 s34, 4
    s_mul_i32 s46, s48, 160
    s_mul_i32 s70, s48, 56
    s_add_u32 s70, s70, s47
    s_mul_i32 s70, s70, 5120
    s_add_u32 s70, s70, 1880064
    s_mov_b32 s92, s100
    s_mov_b32 s93, s101
    s_mov_b32 s94, 2211840
L_ppn10_4:
    s_movk_i32 s52, 6554
    s_movk_i32 s53, 1280
    s_add_u32 s46, s46, s44
    v_add_u32 v5, 0, v0
    v_mul_u32_u24 v6, s52, v5
    v_lshrrev_b32 v6, 16, v6
    v_mul_u32_u24 v7, 10, v6
    v_sub_u32 v5, v5, v7
    v_lshrrev_b32 v7, 4, v6
    v_mul_u32_u24 v18, s32, v7
    v_bfe_u32 v7, v6, 3, 1
    v_mad_u32_u24 v18, v7, s33, v18
    v_bfe_u32 v7, v6, 2, 1
    v_mad_u32_u24 v18, v7, s34, v18
    v_and_b32 v6, 3, v6
    v_add3_u32 v18, v18, v6, s31
    v_mul_u32_u24 v18, s53, v18
    v_lshl_add_u32 v18, v5, 4, v18
    v_add_u32 v244, s46, v18
    v_add_u32 v5, 64, v0
    v_mul_u32_u24 v6, s52, v5
    v_lshrrev_b32 v6, 16, v6
    v_mul_u32_u24 v7, 10, v6
    v_sub_u32 v5, v5, v7
    v_lshrrev_b32 v7, 4, v6
    v_mul_u32_u24 v18, s32, v7
    v_bfe_u32 v7, v6, 3, 1
    v_mad_u32_u24 v18, v7, s33, v18
    v_bfe_u32 v7, v6, 2, 1
    v_mad_u32_u24 v18, v7, s34, v18
    v_and_b32 v6, 3, v6
    v_add3_u32 v18, v18, v6, s31
    v_mul_u32_u24 v18, s53, v18
    v_lshl_add_u32 v18, v5, 4, v18
    v_add_u32 v245, s46, v18
    v_add_u32 v5, 128, v0
    v_mul_u32_u24 v6, s52, v5
    v_lshrrev_b32 v6, 16, v6
    v_mul_u32_u24 v7, 10, v6
    v_sub_u32 v5, v5, v7
    v_lshrrev_b32 v7, 4, v6
    v_mul_u32_u24 v18, s32, v7
    v_bfe_u32 v7, v6, 3, 1
    v_mad_u32_u24 v18, v7, s33, v18
    v_bfe_u32 v7, v6, 2, 1
    v_mad_u32_u24 v18, v7, s34, v18
    v_and_b32 v6, 3, v6
    v_add3_u32 v18, v18, v6, s31
    v_mul_u32_u24 v18, s53, v18
    v_lshl_add_u32 v18, v5, 4, v18
    v_add_u32 v246, s46, v18
    v_add_u32 v5, 192, v0
    v_mul_u32_u24 v6, s52, v5
    v_lshrrev_b32 v6, 16, v6
    v_mul_u32_u24 v7, 10, v6
    v_sub_u32 v5, v5, v7
    v_lshrrev_b32 v7, 4, v6
    v_mul_u32_u24 v18, s32, v7
    v_bfe_u32 v7, v6, 3, 1
    v_mad_u32_u24 v18, v7, s33, v18
    v_bfe_u32 v7, v6, 2, 1
    v_mad_u32_u24 v18, v7, s34, v18
    v_and_b32 v6, 3, v6
    v_add3_u32 v18, v18, v6, s31
    v_mul_u32_u24 v18, s53, v18
    v_lshl_add_u32 v18, v5, 4, v18
    v_add_u32 v247, s46, v18
    v_add_u32 v5, 256, v0
    v_mul_u32_u24 v6, s52, v5
    v_lshrrev_b32 v6, 16, v6
    v_mul_u32_u24 v7, 10, v6
    v_sub_u32 v5, v5, v7
    v_lshrrev_b32 v7, 4, v6
    v_mul_u32_u24 v18, s32, v7
    v_bfe_u32 v7, v6, 3, 1
    v_mad_u32_u24 v18, v7, s33, v18
    v_bfe_u32 v7, v6, 2, 1
    v_mad_u32_u24 v18, v7, s34, v18
    v_and_b32 v6, 3, v6
    v_add3_u32 v18, v18, v6, s31
    v_mul_u32_u24 v18, s53, v18
    v_lshl_add_u32 v18, v5, 4, v18
    v_add_u32 v248, s46, v18
    s_mov_b32 s69, 5
    s_branch L_ppend_5
L_ppw1_2:
    s_sub_u32 s30, s30, 608
    s_lshr_b32 s47, s30, 4
    s_and_b32 s48, s30, 15
    s_mul_i32 s49, s47, 52
    s_lshr_b32 s49, s49, 8
    s_mul_i32 s50, s49, 5
    s_sub_u32 s50, s47, s50
    s_mul_i32 s31, s49, 160
    s_lshl_b32 s32, s50, 5
    s_add_u32 s31, s31, s32
    s_cmp_gt_u32 s50, 2
    s_cselect_b32 s32, 16, 0
    s_sub_u32 s31, s31, s32
    s_cmp_eq_u32 s50, 2
    s_cselect_b32 s32, 80, 16
    s_mov_b32 s53, 0
    s_mul_i32 s46, s48, 7
    s_mul_i32 s54, s48, 6
    s_add_u32 s54, s54, 12
    s_cmp_lt_u32 s48, 12
    s_cselect_b32 s46, s46, s54
    s_cselect_b32 s54, 7, 6
    s_add_u32 s46, s46, s53
    s_cmp_lt_u32 s53, s54
    s_cselect_b32 s44, 0, 1073741824
    s_lshl_b32 s46, s46, 5
    s_mov_b32 s33, 8
    s_mov_b32 s34, 4
    s_mov_b32 s44, 0
    s_mov_b32 s45, 0
    s_cmp_lt_u32 s48, 12
    s_cselect_b32 s54, 14, 12
    s_mul_i32 s70, s48, 20
    s_add_u32 s70, s70, s47
    s_mul_i32 s71, s70, 448
    s_add_u32 s71, s71, 6467584
    s_mul_i32 s70, s70, 7168
    s_add_u32 s70, s70, 4173824
    s_mov_b32 s92, s98
    s_mov_b32 s93, s99
    s_mov_b32 s94, 2211840
    s_movk_i32 s52, 4682
    s_movk_i32 s53, 3456
    s_add_u32 s46, s46, s44
    v_add_u32 v5, 0, v0
    v_mul_u32_u24 v6, s52, v5
    v_lshrrev_b32 v6, 16, v6
    v_mul_u32_u24 v7, 14, v6
    v_sub_u32 v5, v5, v7
    v_lshrrev_b32 v7, 4, v6
    v_mul_u32_u24 v18, s32, v7
    v_bfe_u32 v7, v6, 3, 1
    v_mad_u32_u24 v18, v7, s33, v18
    v_bfe_u32 v7, v6, 2, 1
    v_mad_u32_u24 v18, v7, s34, v18
    v_and_b32 v6, 3, v6
    v_add3_u32 v18, v18, v6, s31
    v_mul_u32_u24 v18, s53, v18
    v_lshl_add_u32 v18, v5, 4, v18
    v_cmp_le_u32 vcc, s54, v5
    v_mov_b32 v7, 1073741824
    s_nop 0
    v_cndmask_b32 v7, 0, v7, vcc
    v_add_u32 v18, v18, v7
    v_add_u32 v244, s46, v18
    v_add_u32 v5, 64, v0
    v_mul_u32_u24 v6, s52, v5
    v_lshrrev_b32 v6, 16, v6
    v_mul_u32_u24 v7, 14, v6
    v_sub_u32 v5, v5, v7
    v_lshrrev_b32 v7, 4, v6
    v_mul_u32_u24 v18, s32, v7
    v_bfe_u32 v7, v6, 3, 1
    v_mad_u32_u24 v18, v7, s33, v18
    v_bfe_u32 v7, v6, 2, 1
    v_mad_u32_u24 v18, v7, s34, v18
    v_and_b32 v6, 3, v6
    v_add3_u32 v18, v18, v6, s31
    v_mul_u32_u24 v18, s53, v18
    v_lshl_add_u32 v18, v5, 4, v18
    v_cmp_le_u32 vcc, s54, v5
    v_mov_b32 v7, 1073741824
    s_nop 0
    v_cndmask_b32 v7, 0, v7, vcc
    v_add_u32 v18, v18, v7
    v_add_u32 v245, s46, v18
    v_add_u32 v5, 128, v0
    v_mul_u32_u24 v6, s52, v5
    v_lshrrev_b32 v6, 16, v6
    v_mul_u32_u24 v7, 14, v6
    v_sub_u32 v5, v5, v7
    v_lshrrev_b32 v7, 4, v6
    v_mul_u32_u24 v18, s32, v7
    v_bfe_u32 v7, v6, 3, 1
    v_mad_u32_u24 v18, v7, s33, v18
    v_bfe_u32 v7, v6, 2, 1
    v_mad_u32_u24 v18, v7, s34, v18
    v_and_b32 v6, 3, v6
    v_add3_u32 v18, v18, v6, s31
    v_mul_u32_u24 v18, s53, v18
    v_lshl_add_u32 v18, v5, 4, v18
    v_cmp_le_u32 vcc, s54, v5
    v_mov_b32 v7, 1073741824
    s_nop 0
    v_cndmask_b32 v7, 0, v7, vcc
    v_add_u32 v18, v18, v7
    v_add_u32 v246, s46, v18
    v_add_u32 v5, 192, v0
    v_mul_u32_u24 v6, s52, v5
    v_lshrrev_b32 v6, 16, v6
    v_mul_u32_u24 v7, 14, v6
    v_sub_u32 v5, v5, v7
    v_lshrrev_b32 v7, 4, v6
    v_mul_u32_u24 v18, s32, v7
    v_bfe_u32 v7, v6, 3, 1
    v_mad_u32_u24 v18, v7, s33, v18
    v_bfe_u32 v7, v6, 2, 1
    v_mad_u32_u24 v18, v7, s34, v18
    v_and_b32 v6, 3, v6
    v_add3_u32 v18, v18, v6, s31
    v_mul_u32_u24 v18, s53, v18
    v_lshl_add_u32 v18, v5, 4, v18
    v_cmp_le_u32 vcc, s54, v5
    v_mov_b32 v7, 1073741824
    s_nop 0
    v_cndmask_b32 v7, 0, v7, vcc
    v_add_u32 v18, v18, v7
    v_add_u32 v247, s46, v18
    v_add_u32 v5, 256, v0
    v_mul_u32_u24 v6, s52, v5
    v_lshrrev_b32 v6, 16, v6
    v_mul_u32_u24 v7, 14, v6
    v_sub_u32 v5, v5, v7
    v_lshrrev_b32 v7, 4, v6
    v_mul_u32_u24 v18, s32, v7
    v_bfe_u32 v7, v6, 3, 1
    v_mad_u32_u24 v18, v7, s33, v18
    v_bfe_u32 v7, v6, 2, 1
    v_mad_u32_u24 v18, v7, s34, v18
    v_and_b32 v6, 3, v6
    v_add3_u32 v18, v18, v6, s31
    v_mul_u32_u24 v18, s53, v18
    v_lshl_add_u32 v18, v5, 4, v18
    v_cmp_le_u32 vcc, s54, v5
    v_mov_b32 v7, 1073741824
    s_nop 0
    v_cndmask_b32 v7, 0, v7, vcc
    v_add_u32 v18, v18, v7
    v_add_u32 v248, s46, v18
    v_add_u32 v5, 320, v0
    v_mul_u32_u24 v6, s52, v5
    v_lshrrev_b32 v6, 16, v6
    v_mul_u32_u24 v7, 14, v6
    v_sub_u32 v5, v5, v7
    v_lshrrev_b32 v7, 4, v6
    v_mul_u32_u24 v18, s32, v7
    v_bfe_u32 v7, v6, 3, 1
    v_mad_u32_u24 v18, v7, s33, v18
    v_bfe_u32 v7, v6, 2, 1
    v_mad_u32_u24 v18, v7, s34, v18
    v_and_b32 v6, 3, v6
    v_add3_u32 v18, v18, v6, s31
    v_mul_u32_u24 v18, s53, v18
    v_lshl_add_u32 v18, v5, 4, v18
    v_cmp_le_u32 vcc, s54, v5
    v_mov_b32 v7, 1073741824
    s_nop 0
    v_cndmask_b32 v7, 0, v7, vcc
    v_add_u32 v18, v18, v7
    v_add_u32 v249, s46, v18
    v_add_u32 v5, 384, v0
    v_mul_u32_u24 v6, s52, v5
    v_lshrrev_b32 v6, 16, v6
    v_mul_u32_u24 v7, 14, v6
    v_sub_u32 v5, v5, v7
    v_lshrrev_b32 v7, 4, v6
    v_mul_u32_u24 v18, s32, v7
    v_bfe_u32 v7, v6, 3, 1
    v_mad_u32_u24 v18, v7, s33, v18
    v_bfe_u32 v7, v6, 2, 1
    v_mad_u32_u24 v18, v7, s34, v18
    v_and_b32 v6, 3, v6
    v_add3_u32 v18, v18, v6, s31
    v_mul_u32_u24 v18, s53, v18
    v_lshl_add_u32 v18, v5, 4, v18
    v_cmp_le_u32 vcc, s54, v5
    v_mov_b32 v7, 1073741824
    s_nop 0
    v_cndmask_b32 v7, 0, v7, vcc
    v_add_u32 v18, v18, v7
    v_add_u32 v250, s46, v18
    s_mov_b32 s69, 7
    s_branch L_ppend_5
L_ppnone_3:
    s_mov_b32 s69, 0
    s_mov_b32 s70, 1073741824
L_ppend_5:
    s_cmp_lg_u32 s73, 0
    s_cbranch_scc1 L_nowq2
    s_waitcnt vmcnt(1)
    v_lshrrev_b32 v5, 2, v0
    v_and_b32 v6, 3, v0
    v_mul_u32_u24 v7, 160, v5
    v_mad_u32_u24 v7, v6, 40, v7
    v_add_u32 v7, 86016, v7
    v_mul_u32_u24 v5, 40, v5
    v_lshl_add_u32 v5, v6, 3, v5
    s_and_b32 s36, s2, 1
    s_lshl_b32 s36, s36, 5
    s_add_u32 s36, s36, 91136
    v_add_u32 v5, s36, v5
    ds_read_b64_tr_b16 v[132:133], v7 offset:0
    ds_read_b64_tr_b16 v[134:135], v7 offset:2560
    ds_read_b64_tr_b16 v[136:137], v7 offset:8
    ds_read_b64_tr_b16 v[138:139], v7 offset:2568
    ds_read_b64_tr_b16 v[140:141], v7 offset:16
    ds_read_b64_tr_b16 v[142:143], v7 offset:2576
    ds_read_b64_tr_b16 v[144:145], v7 offset:24
    ds_read_b64_tr_b16 v[146:147], v7 offset:2584
    ds_read_b64_tr_b16 v[148:149], v7 offset:32
    ds_read_b64_tr_b16 v[150:151], v7 offset:2592
    ds_read_b64_tr_b16 v[152:153], v5 offset:0
    ds_read_b64_tr_b16 v[154:155], v5 offset:1024
    s_waitcnt lgkmcnt(10)
    buffer_store_dwordx4 v[132:135], v1, s[4:7], s67 offen offset:0 sc1
    s_waitcnt lgkmcnt(8)
    buffer_store_dwordx4 v[136:139], v1, s[4:7], s67 offen offset:1024 sc1
    s_waitcnt lgkmcnt(6)
    buffer_store_dwordx4 v[140:143], v1, s[4:7], s67 offen offset:2048 sc1
    s_waitcnt lgkmcnt(4)
    buffer_store_dwordx4 v[144:147], v1, s[4:7], s67 offen offset:3072 sc1
    s_waitcnt lgkmcnt(2)
    s_add_u32 s67, s67, 4096
    buffer_store_dwordx4 v[148:151], v1, s[4:7], s67 offen offset:0 sc1
    s_waitcnt lgkmcnt(0)
    buffer_store_dwordx4 v[152:155], v1, s[4:7], s67 offen offset:1024 sc1
    v_mfma_f32_16x16x32_bf16 v[156:159], v[132:135], v[192:195], 0
    v_mfma_f32_16x16x32_bf16 v[160:163], v[136:139], v[192:195], 0
    v_mfma_f32_16x16x32_bf16 v[164:167], v[140:143], v[192:195], 0
    v_mfma_f32_16x16x32_bf16 v[168:171], v[144:147], v[192:195], 0
    v_mfma_f32_16x16x32_bf16 v[172:175], v[148:151], v[192:195], 0
    v_mfma_f32_16x16x32_bf16 v[176:179], v[152:155], v[192:195], 0
    v_lshlrev_b32 v5, 4, v4
    s_mov_b32 exec_lo, 0x00010001
    s_mov_b32 exec_hi, 0x00010001
    buffer_store_dwordx4 v[156:159], v5, s[4:7], s68 offen offset:0 sc1
    buffer_store_dwordx4 v[160:163], v5, s[4:7], s68 offen offset:64 sc1
    buffer_store_dwordx4 v[164:167], v5, s[4:7], s68 offen offset:128 sc1
    buffer_store_dwordx4 v[168:171], v5, s[4:7], s68 offen offset:192 sc1
    buffer_store_dwordx4 v[172:175], v5, s[4:7], s68 offen offset:256 sc1
    buffer_store_dwordx4 v[176:179], v5, s[4:7], s68 offen offset:320 sc1
    s_mov_b64 exec, -1
    s_waitcnt vmcnt(0)
    v_mov_b32 v5, s27
    s_mov_b64 exec, 1
    buffer_store_dword v5, off, s[4:7], s66 sc1
    s_mov_b64 exec, -1
    s_branch L_wq3
L_nowq2:
    s_waitcnt vmcnt(0)
L_wq3:
    s_add_u32 m0, s72, 0
    s_nop 0
    buffer_load_dwordx4 v244, s[92:95], 0 offen lds
    s_add_u32 m0, s72, 1024
    s_nop 0
    buffer_load_dwordx4 v245, s[92:95], 0 offen lds
    s_add_u32 m0, s72, 2048
    s_nop 0
    buffer_load_dwordx4 v246, s[92:95], 0 offen lds
    s_add_u32 m0, s72, 3072
    s_nop 0
    buffer_load_dwordx4 v247, s[92:95], 0 offen lds
    s_add_u32 m0, s72, 4096
    s_nop 0
    buffer_load_dwordx4 v248, s[92:95], 0 offen lds
    s_add_u32 m0, s65, 5120
    s_nop 0
    buffer_load_dwordx4 v249, s[92:95], 0 offen lds
    s_add_u32 m0, s65, 6144
    s_nop 0
    buffer_load_dwordx4 v250, s[92:95], 0 offen lds
    s_mul_i32 s94, s23, 5632
    s_lshr_b32 s36, s20, 1
    s_mul_i32 s36, s36, 2816
    s_add_u32 s94, s94, s36
    s_add_u32 s94, s94, 6873088
    s_mul_i32 s95, s23, 32
    s_mul_i32 s36, s24, 4
    s_add_u32 s95, s95, s36
    s_add_u32 s95, s95, 7053312
    v_lshlrev_b32 v20, 16, v252
    v_and_b32 v21, 0xffff0000, v252
    v_lshlrev_b32 v22, 16, v253
    v_and_b32 v23, 0xffff0000, v253
    v_add_u32 v6, 160192, v1
    s_mov_b64 exec, 0x0fffffff
    ds_write_b128 v6, v[20:23]
    s_mov_b64 exec, -1
    v_mov_b32 v6, 161024
    v_mov_b32 v7, 0
    ds_write_b32 v6, v7
    s_barrier
    v_lshrrev_b32 v5, 1, v4
    v_xor_b32 v5, v5, v3
    v_lshlrev_b32 v5, 4, v5
    v_and_b32 v6, 1, v4
    v_lshl_add_u32 v5, v6, 3, v5
    v_lshrrev_b32 v6, 2, v3
    v_mul_u32_u24 v6, 5120, v6
    v_and_b32 v7, 3, v3
    v_lshl_add_u32 v6, v7, 8, v6
    v_add3_u32 v104, v5, v6, s64
    v_xor_b32 v105, 32, v104
    v_xor_b32 v106, 64, v104
    v_xor_b32 v107, 96, v104
    v_xor_b32 v108, 128, v104
    v_xor_b32 v109, 160, v104
    v_xor_b32 v110, 192, v104
    v_xor_b32 v111, 224, v104
    ds_read_b64 v[20:21], v104 offset:0
    ds_read_b64 v[22:23], v105 offset:0
    ds_read_b64 v[24:25], v106 offset:0
    ds_read_b64 v[26:27], v107 offset:0
    ds_read_b64 v[28:29], v108 offset:0
    ds_read_b64 v[30:31], v105 offset:1024
    ds_read_b64 v[32:33], v109 offset:0
    ds_read_b64 v[34:35], v110 offset:0
    ds_read_b64 v[36:37], v111 offset:0
    ds_read_b64 v[38:39], v104 offset:1024
    ds_read_b64 v[40:41], v106 offset:1024
    ds_read_b64 v[42:43], v107 offset:1024
    ds_read_b64 v[44:45], v108 offset:1024
    ds_read_b64 v[46:47], v109 offset:1024
    ds_read_b64 v[48:49], v110 offset:1024
    ds_read_b64 v[50:51], v107 offset:2048
    ds_read_b64 v[52:53], v111 offset:1024
    ds_read_b64 v[54:55], v104 offset:2048
    ds_read_b64 v[56:57], v105 offset:2048
    ds_read_b64 v[58:59], v106 offset:2048
    ds_read_b64 v[60:61], v108 offset:2048
    ds_read_b64 v[62:63], v109 offset:2048
    ds_read_b64 v[64:65], v110 offset:2048
    ds_read_b64 v[66:67], v111 offset:2048
    ds_read_b64 v[68:69], v104 offset:3072
    ds_read_b64 v[70:71], v109 offset:3072
    ds_read_b64 v[72:73], v105 offset:3072
    ds_read_b64 v[74:75], v106 offset:3072
    ds_read_b64 v[76:77], v107 offset:3072
    ds_read_b64 v[78:79], v108 offset:3072
    ds_read_b64 v[80:81], v110 offset:3072
    ds_read_b64 v[82:83], v111 offset:3072
    ds_read_b64 v[84:85], v104 offset:4096
    ds_read_b64 v[86:87], v105 offset:4096
    ds_read_b64 v[88:89], v106 offset:4096
    ds_read_b64 v[90:91], v111 offset:4096
    ds_read_b64 v[92:93], v107 offset:4096
    ds_read_b64 v[94:95], v108 offset:4096
    ds_read_b64 v[96:97], v109 offset:4096
    ds_read_b64 v[98:99], v110 offset:4096
    s_mul_i32 s36, s24, 160
    s_add_u32 s36, s36, 0
    s_and_b32 s37, s36, 0xe0
    s_lshr_b32 s36, s36, 8
    s_lshl_b32 s36, s36, 10
    v_xor_b32 v5, s37, v104
    v_add_u32 v5, s36, v5
    ds_read_b64 v[8:9], v5
    s_mul_i32 s36, s24, 160
    s_add_u32 s36, s36, 32
    s_and_b32 s37, s36, 0xe0
    s_lshr_b32 s36, s36, 8
    s_lshl_b32 s36, s36, 10
    v_xor_b32 v5, s37, v104
    v_add_u32 v5, s36, v5
    ds_read_b64 v[10:11], v5
    s_mul_i32 s36, s24, 160
    s_add_u32 s36, s36, 64
    s_and_b32 s37, s36, 0xe0
    s_lshr_b32 s36, s36, 8
    s_lshl_b32 s36, s36, 10
    v_xor_b32 v5, s37, v104
    v_add_u32 v5, s36, v5
    ds_read_b64 v[12:13], v5
    s_mul_i32 s36, s24, 160
    s_add_u32 s36, s36, 96
    s_and_b32 s37, s36, 0xe0
    s_lshr_b32 s36, s36, 8
    s_lshl_b32 s36, s36, 10
    v_xor_b32 v5, s37, v104
    v_add_u32 v5, s36, v5
    ds_read_b64 v[14:15], v5
    s_mul_i32 s36, s24, 160
    s_add_u32 s36, s36, 128
    s_and_b32 s37, s36, 0xe0
    s_lshr_b32 s36, s36, 8
    s_lshl_b32 s36, s36, 10
    v_xor_b32 v5, s37, v104
    v_add_u32 v5, s36, v5
    ds_read_b64 v[16:17], v5
    s_waitcnt lgkmcnt(0)
    s_barrier
    v_add_u32 v240, 0, v1
    v_add_u32 v241, 61440, v1
    v_lshrrev_b32 v5, 2, v0
    v_mul_u32_u24 v5, 40, v5
    v_and_b32 v6, 3, v0
    v_lshl_add_u32 v5, v6, 3, v5
    s_and_b32 s36, s24, 1
    s_lshl_b32 s36, s36, 5
    s_add_u32 s36, s36, 94208
    v_add_u32 v242, s36, v5
    s_mul_i32 s37, s24, 128
    s_add_u32 s37, s37, 12288
    v_min_u32 v6, 19, v0
    v_lshlrev_b32 v6, 2, v6
    ds_read_b64_tr_b16 v[100:101], v242 offset:0
    ds_read_b64_tr_b16 v[102:103], v242 offset:640
    ds_read_b64_tr_b16 v[104:105], v242 offset:1280
    ds_read_b64_tr_b16 v[106:107], v242 offset:1920
    ds_read_b64_tr_b16 v[108:109], v242 offset:2560
    ds_read_b64_tr_b16 v[110:111], v242 offset:5760
    ds_read_b64_tr_b16 v[112:113], v242 offset:3200
    ds_read_b64_tr_b16 v[114:115], v242 offset:3840
    v_mfma_f32_16x16x32_bf16 v[196:199], v[192:195], v[20:23], 0
    v_mfma_f32_16x16x32_bf16 v[200:203], v[20:23], v[20:23], 0
    v_mfma_f32_16x16x32_bf16 v[196:199], v[192:195], v[24:27], v[196:199]
    v_mfma_f32_16x16x32_bf16 v[200:203], v[24:27], v[24:27], v[200:203]
    v_mfma_f32_16x16x32_bf16 v[196:199], v[192:195], v[28:31], v[196:199]
    v_mfma_f32_16x16x32_bf16 v[200:203], v[28:31], v[28:31], v[200:203]
    v_mfma_f32_16x16x32_bf16 v[196:199], v[192:195], v[32:35], v[196:199]
    v_mfma_f32_16x16x32_bf16 v[200:203], v[32:35], v[32:35], v[200:203]
    v_mfma_f32_16x16x32_bf16 v[196:199], v[192:195], v[36:39], v[196:199]
    v_mfma_f32_16x16x32_bf16 v[200:203], v[36:39], v[36:39], v[200:203]
    v_mfma_f32_16x16x32_bf16 v[196:199], v[192:195], v[40:43], v[196:199]
    v_mfma_f32_16x16x32_bf16 v[200:203], v[40:43], v[40:43], v[200:203]
    v_mfma_f32_16x16x32_bf16 v[196:199], v[192:195], v[44:47], v[196:199]
    v_mfma_f32_16x16x32_bf16 v[200:203], v[44:47], v[44:47], v[200:203]
    v_mfma_f32_16x16x32_bf16 v[196:199], v[192:195], v[48:51], v[196:199]
    v_mfma_f32_16x16x32_bf16 v[200:203], v[48:51], v[48:51], v[200:203]
    v_mfma_f32_16x16x32_bf16 v[196:199], v[192:195], v[52:55], v[196:199]
    v_mfma_f32_16x16x32_bf16 v[200:203], v[52:55], v[52:55], v[200:203]
    v_mfma_f32_16x16x32_bf16 v[196:199], v[192:195], v[56:59], v[196:199]
    v_mfma_f32_16x16x32_bf16 v[200:203], v[56:59], v[56:59], v[200:203]
    v_mfma_f32_16x16x32_bf16 v[196:199], v[192:195], v[60:63], v[196:199]
    v_mfma_f32_16x16x32_bf16 v[200:203], v[60:63], v[60:63], v[200:203]
    v_mfma_f32_16x16x32_bf16 v[196:199], v[192:195], v[64:67], v[196:199]
    v_mfma_f32_16x16x32_bf16 v[200:203], v[64:67], v[64:67], v[200:203]
    v_mfma_f32_16x16x32_bf16 v[196:199], v[192:195], v[68:71], v[196:199]
    v_mfma_f32_16x16x32_bf16 v[200:203], v[68:71], v[68:71], v[200:203]
    v_mfma_f32_16x16x32_bf16 v[196:199], v[192:195], v[72:75], v[196:199]
    v_mfma_f32_16x16x32_bf16 v[200:203], v[72:75], v[72:75], v[200:203]
    v_mfma_f32_16x16x32_bf16 v[196:199], v[192:195], v[76:79], v[196:199]
    v_mfma_f32_16x16x32_bf16 v[200:203], v[76:79], v[76:79], v[200:203]
    v_mfma_f32_16x16x32_bf16 v[196:199], v[192:195], v[80:83], v[196:199]
    v_mfma_f32_16x16x32_bf16 v[200:203], v[80:83], v[80:83], v[200:203]
    v_mfma_f32_16x16x32_bf16 v[196:199], v[192:195], v[84:87], v[196:199]
    v_mfma_f32_16x16x32_bf16 v[200:203], v[84:87], v[84:87], v[200:203]
    v_mfma_f32_16x16x32_bf16 v[196:199], v[192:195], v[88:91], v[196:199]
    v_mfma_f32_16x16x32_bf16 v[200:203], v[88:91], v[88:91], v[200:203]
    v_mfma_f32_16x16x32_bf16 v[196:199], v[192:195], v[92:95], v[196:199]
    v_mfma_f32_16x16x32_bf16 v[200:203], v[92:95], v[92:95], v[200:203]
    v_mfma_f32_16x16x32_bf16 v[196:199], v[192:195], v[96:99], v[196:199]
    v_mfma_f32_16x16x32_bf16 v[200:203], v[96:99], v[96:99], v[200:203]
    buffer_load_dword v253, v6, s[4:7], s37 offen sc1
    s_mov_b32 s35, 0
    s_sleep 1
L_poll_7:
    buffer_load_dword v254, v6, s[4:7], s37 offen sc1
    s_waitcnt vmcnt(1)
    v_cmp_ne_u32 vcc, s27, v253
    s_nop 4
    s_cbranch_vccz L_pollx_8
    buffer_load_dword v253, v6, s[4:7], s37 offen sc1
    s_waitcnt vmcnt(1)
    v_cmp_ne_u32 vcc, s27, v254
    s_nop 4
    s_cbranch_vccz L_pollx_8
    s_add_u32 s35, s35, 1
    s_cmp_lt_u32 s35, 0x20000
    s_cbranch_scc1 L_poll_7
L_pollx_8:
    s_mul_i32 s36, s24, 7680
    s_mul_i32 s37, s20, 1920
    s_add_u32 s36, s36, s37
    s_add_u32 s36, s36, 999424
    s_mov_b64 exec, 0xfffff
    buffer_load_dwordx4 v[216:219], v1, s[4:7], s36 offen offset:0 sc1
    buffer_load_dwordx4 v[220:223], v1, s[4:7], s36 offen offset:384 sc1
    buffer_load_dwordx4 v[224:227], v1, s[4:7], s36 offen offset:768 sc1
    buffer_load_dwordx4 v[228:231], v1, s[4:7], s36 offen offset:1152 sc1
    buffer_load_dwordx4 v[232:235], v1, s[4:7], s36 offen offset:1536 sc1
    s_mov_b64 exec, -1
    s_mul_i32 s53, s20, 6144
    s_mul_i32 s52, s24, 122880
    s_add_u32 s52, s52, s53
    s_add_u32 s52, s52, 16384
    s_mov_b32 m0, s53
    s_nop 0
    buffer_load_dwordx4 v1, s[4:7], s52 offen offset:0 sc1 lds
    buffer_load_dwordx4 v1, s[4:7], s52 offen offset:1024 sc1 lds
    buffer_load_dwordx4 v1, s[4:7], s52 offen offset:2048 sc1 lds
    buffer_load_dwordx4 v1, s[4:7], s52 offen offset:3072 sc1 lds
    s_add_u32 s52, s52, 4096
    s_add_u32 s53, s53, 4096
    s_mov_b32 m0, s53
    s_nop 0
    buffer_load_dwordx4 v1, s[4:7], s52 offen offset:0 sc1 lds
    s_waitcnt lgkmcnt(6)
    v_mfma_f32_16x16x32_bf16 v[168:171], v[100:103], v[20:23], 0
    s_mul_i32 s53, s20, 6144
    s_add_u32 s53, s53, 24576
    s_mul_i32 s52, s24, 122880
    s_add_u32 s52, s52, s53
    s_add_u32 s52, s52, 16384
    s_mov_b32 m0, s53
    s_nop 0
    buffer_load_dwordx4 v1, s[4:7], s52 offen offset:0 sc1 lds
    v_mfma_f32_16x16x32_bf16 v[236:239], v[100:103], v[192:195], 0
    ds_read_b64_tr_b16 v[116:117], v242 offset:4480
    ds_read_b64_tr_b16 v[118:119], v242 offset:5120
    s_waitcnt lgkmcnt(6)
    v_mfma_f32_16x16x32_bf16 v[168:171], v[104:107], v[24:27], v[168:171]
    v_mfma_f32_16x16x32_bf16 v[236:239], v[104:107], v[192:195], v[236:239]
    ds_read_b64_tr_b16 v[120:121], v242 offset:6400
    ds_read_b64_tr_b16 v[122:123], v242 offset:7040
    s_waitcnt lgkmcnt(6)
    v_mfma_f32_16x16x32_bf16 v[168:171], v[108:111], v[28:31], v[168:171]
    buffer_load_dwordx4 v1, s[4:7], s52 offen offset:1024 sc1 lds
    v_mfma_f32_16x16x32_bf16 v[236:239], v[108:111], v[192:195], v[236:239]
    ds_read_b64_tr_b16 v[100:101], v242 offset:7680
    ds_read_b64_tr_b16 v[102:103], v242 offset:8320
    s_waitcnt lgkmcnt(6)
    v_mfma_f32_16x16x32_bf16 v[168:171], v[112:115], v[32:35], v[168:171]
    v_mfma_f32_16x16x32_bf16 v[236:239], v[112:115], v[192:195], v[236:239]
    ds_read_b64_tr_b16 v[104:105], v242 offset:8960
    ds_read_b64_tr_b16 v[106:107], v242 offset:12160
    s_waitcnt lgkmcnt(6)
    v_mfma_f32_16x16x32_bf16 v[168:171], v[116:119], v[36:39], v[168:171]
    buffer_load_dwordx4 v1, s[4:7], s52 offen offset:2048 sc1 lds
    v_mfma_f32_16x16x32_bf16 v[236:239], v[116:119], v[192:195], v[236:239]
    ds_read_b64_tr_b16 v[108:109], v242 offset:9600
    ds_read_b64_tr_b16 v[110:111], v242 offset:10240
    s_waitcnt lgkmcnt(6)
    v_mfma_f32_16x16x32_bf16 v[168:171], v[120:123], v[40:43], v[168:171]
    v_mfma_f32_16x16x32_bf16 v[236:239], v[120:123], v[192:195], v[236:239]
    ds_read_b64_tr_b16 v[112:113], v242 offset:10880
    ds_read_b64_tr_b16 v[114:115], v242 offset:11520
    s_waitcnt lgkmcnt(6)
    v_mfma_f32_16x16x32_bf16 v[168:171], v[100:103], v[44:47], v[168:171]
    buffer_load_dwordx4 v1, s[4:7], s52 offen offset:3072 sc1 lds
    v_mfma_f32_16x16x32_bf16 v[236:239], v[100:103], v[192:195], v[236:239]
    ds_read_b64_tr_b16 v[116:117], v242 offset:12800
    ds_read_b64_tr_b16 v[118:119], v242 offset:13440
    s_waitcnt lgkmcnt(6)
    v_mfma_f32_16x16x32_bf16 v[168:171], v[104:107], v[48:51], v[168:171]
    v_mfma_f32_16x16x32_bf16 v[236:239], v[104:107], v[192:195], v[236:239]
    ds_read_b64_tr_b16 v[120:121], v242 offset:14080
    ds_read_b64_tr_b16 v[122:123], v242 offset:14720
    s_waitcnt lgkmcnt(6)
    v_mfma_f32_16x16x32_bf16 v[168:171], v[108:111], v[52:55], v[168:171]
    s_add_u32 s52, s52, 4096
    s_add_u32 s53, s53, 4096
    s_mov_b32 m0, s53
    s_nop 0
    buffer_load_dwordx4 v1, s[4:7], s52 offen offset:0 sc1 lds
    v_mfma_f32_16x16x32_bf16 v[236:239], v[108:111], v[192:195], v[236:239]
    ds_read_b64_tr_b16 v[100:101], v242 offset:15360
    ds_read_b64_tr_b16 v[102:103], v242 offset:18560
    s_waitcnt lgkmcnt(6)
    v_mfma_f32_16x16x32_bf16 v[168:171], v[112:115], v[56:59], v[168:171]
    v_mfma_f32_16x16x32_bf16 v[236:239], v[112:115], v[192:195], v[236:239]
    ds_read_b64_tr_b16 v[104:105], v242 offset:16000
    ds_read_b64_tr_b16 v[106:107], v242 offset:16640
    s_waitcnt lgkmcnt(6)
    v_mfma_f32_16x16x32_bf16 v[168:171], v[116:119], v[60:63], v[168:171]
    s_mul_i32 s53, s20, 6144
    s_add_u32 s53, s53, 49152
    s_mul_i32 s52, s24, 122880
    s_add_u32 s52, s52, s53
    s_add_u32 s52, s52, 16384
    s_mov_b32 m0, s53
    s_nop 0
    buffer_load_dwordx4 v1, s[4:7], s52 offen offset:0 sc1 lds
    v_mfma_f32_16x16x32_bf16 v[236:239], v[116:119], v[192:195], v[236:239]
    ds_read_b64_tr_b16 v[108:109], v242 offset:17280
    ds_read_b64_tr_b16 v[110:111], v242 offset:17920
    s_waitcnt lgkmcnt(6)
    v_mfma_f32_16x16x32_bf16 v[168:171], v[120:123], v[64:67], v[168:171]
    v_mfma_f32_16x16x32_bf16 v[236:239], v[120:123], v[192:195], v[236:239]
    ds_read_b64_tr_b16 v[112:113], v242 offset:19200
    ds_read_b64_tr_b16 v[114:115], v242 offset:19840
    s_waitcnt lgkmcnt(6)
    v_mfma_f32_16x16x32_bf16 v[168:171], v[100:103], v[68:71], v[168:171]
    buffer_load_dwordx4 v1, s[4:7], s52 offen offset:1024 sc1 lds
    v_mfma_f32_16x16x32_bf16 v[236:239], v[100:103], v[192:195], v[236:239]
    ds_read_b64_tr_b16 v[116:117], v242 offset:20480
    ds_read_b64_tr_b16 v[118:119], v242 offset:21120
    s_waitcnt lgkmcnt(6)
    v_mfma_f32_16x16x32_bf16 v[168:171], v[104:107], v[72:75], v[168:171]
    v_mfma_f32_16x16x32_bf16 v[236:239], v[104:107], v[192:195], v[236:239]
    ds_read_b64_tr_b16 v[120:121], v242 offset:21760
    ds_read_b64_tr_b16 v[122:123], v242 offset:24960
    s_waitcnt lgkmcnt(6)
    v_mfma_f32_16x16x32_bf16 v[168:171], v[108:111], v[76:79], v[168:171]
    buffer_load_dwordx4 v1, s[4:7], s52 offen offset:2048 sc1 lds
    v_mfma_f32_16x16x32_bf16 v[236:239], v[108:111], v[192:195], v[236:239]
    ds_read_b64_tr_b16 v[100:101], v242 offset:22400
    ds_read_b64_tr_b16 v[102:103], v242 offset:23040
    s_waitcnt lgkmcnt(6)
    v_mfma_f32_16x16x32_bf16 v[168:171], v[112:115], v[80:83], v[168:171]
    v_mfma_f32_16x16x32_bf16 v[236:239], v[112:115], v[192:195], v[236:239]
    ds_read_b64_tr_b16 v[104:105], v242 offset:23680
    ds_read_b64_tr_b16 v[106:107], v242 offset:24320
    s_waitcnt lgkmcnt(6)
    v_mfma_f32_16x16x32_bf16 v[168:171], v[116:119], v[84:87], v[168:171]
    buffer_load_dwordx4 v1, s[4:7], s52 offen offset:3072 sc1 lds
    v_mfma_f32_16x16x32_bf16 v[236:239], v[116:119], v[192:195], v[236:239]
    s_waitcnt lgkmcnt(4)
    v_mfma_f32_16x16x32_bf16 v[168:171], v[120:123], v[88:91], v[168:171]
    v_mfma_f32_16x16x32_bf16 v[236:239], v[120:123], v[192:195], v[236:239]
    s_waitcnt lgkmcnt(2)
    v_mfma_f32_16x16x32_bf16 v[168:171], v[100:103], v[92:95], v[168:171]
    s_add_u32 s52, s52, 4096
    s_add_u32 s53, s53, 4096
    s_mov_b32 m0, s53
    s_nop 0
    buffer_load_dwordx4 v1, s[4:7], s52 offen offset:0 sc1 lds
    v_mfma_f32_16x16x32_bf16 v[236:239], v[100:103], v[192:195], v[236:239]
    s_waitcnt lgkmcnt(0)
    v_mfma_f32_16x16x32_bf16 v[168:171], v[104:107], v[96:99], v[168:171]
    v_mfma_f32_16x16x32_bf16 v[236:239], v[104:107], v[192:195], v[236:239]
    v_and_b32 v5, 3, v3
    v_lshrrev_b32 v6, 2, v3
    v_cmp_eq_u32 vcc, 1, v5
    v_cmp_eq_u32 s[62:63], 2, v5
    s_nop 0
    v_cndmask_b32 v200, v200, v201, vcc
    v_cmp_eq_u32 vcc, 3, v5
    v_cndmask_b32 v200, v200, v202, s[62:63]
    v_cmp_eq_u32 s[62:63], v6, v4
    v_cndmask_b32 v200, v200, v203, vcc
    v_mul_f32 v196, 0.25, v196
    v_cndmask_b32 v197, 0, v200, s[62:63]
    v_mov_b32 v198, v196
    v_mov_b32 v199, v197
    s_nop 0
    v_permlane16_swap_b32 v196, v198
    v_permlane16_swap_b32 v197, v199
    v_add_f32 v196, v196, v198
    v_add_f32 v197, v197, v199
    v_mov_b32 v198, v196
    v_mov_b32 v199, v197
    s_nop 0
    v_permlane32_swap_b32 v196, v198
    v_permlane32_swap_b32 v197, v199
    v_add_f32 v196, v196, v198
    v_add_f32 v197, v197, v199
    v_mul_f32 v212, 0xbacccccd, v196
    v_mul_f32 v198, v212, v212
    v_mov_b32 v199, 0x3acccccd
    v_fma_f32 v197, v197, v199, -v198
    v_max_f32 v197, 0, v197
    v_add_f32 v197, 0x3727c5ac, v197
    v_rsq_f32 v213, v197
    v_lshlrev_b32 v6, 4, v4
    v_add_u32 v6, 160960, v6
    s_mov_b32 exec_lo, 0x00010001
    s_mov_b32 exec_hi, 0x00010001
    ds_write_b128 v6, v[236:239]
    s_mov_b64 exec, -1
    v_mov_b32 v214, v213
    s_lshr_b32 s36, s24, 2
    s_xor_b32 s48, s36, s20
    s_and_b32 s48, s48, 1
    s_cbranch_scc1 L_kvdone_9
    v_pk_fma_f32 v[168:169], v[212:213], v[236:237], v[168:169] op_sel_hi:[0,1,1]
    v_pk_fma_f32 v[170:171], v[212:213], v[238:239], v[170:171] op_sel_hi:[0,1,1]
    v_pk_mul_f32 v[168:169], v[214:215], v[168:169] op_sel_hi:[0,1]
    v_pk_mul_f32 v[170:171], v[214:215], v[170:171] op_sel_hi:[0,1]
    v_cvt_pk_bf16_f32 v172, v168, v169
    v_cvt_pk_bf16_f32 v173, v170, v171
    s_and_b32 s37, s20, 1
    s_bitcmp1_b32 s24, 1
    s_cbranch_scc1 L_kvv_10
    s_lshl_b32 s37, s37, 4
    v_add_u32 v6, s37, v3
    s_bitcmp1_b32 s24, 0
    s_cbranch_scc1 L_kvk1_11
    v_lshrrev_b32 v7, 1, v4
    v_lshlrev_b32 v7, 9, v7
    v_lshl_add_u32 v7, v6, 4, v7
    v_and_b32 v6, 1, v4
    v_lshl_add_u32 v7, v6, 3, v7
    buffer_store_dwordx2 v[172:173], v7, s[4:7], s94 offen sc1
    s_branch L_kvj_12
L_kvk1_11:
    v_lshlrev_b32 v6, 3, v6
    s_mov_b64 exec, 0xffff
    buffer_store_dwordx2 v[172:173], v6, s[4:7], s94 offen offset:1024 sc1
    s_mov_b64 exec, -1
    s_branch L_kvj_12
L_kvv_10:
    s_lshr_b32 s36, s20, 1
    s_lshl_b32 s36, s36, 9
    s_add_u32 s36, s36, 161088
    v_lshlrev_b32 v6, 7, v4
    v_lshl_add_u32 v6, v3, 1, v6
    v_add_u32 v6, s36, v6
    ds_write_b16 v6, v172
    ds_write_b16_d16_hi v6, v172 offset:32
    ds_write_b16 v6, v173 offset:64
    ds_write_b16_d16_hi v6, v173 offset:96
    v_lshlrev_b32 v6, 5, v3
    v_lshl_add_u32 v6, v4, 3, v6
    v_add_u32 v6, s36, v6
    ds_read_b64 v[174:175], v6
    s_mul_i32 s37, s37, 768
    s_add_u32 s37, s94, s37
    s_and_b32 s36, s24, 1
    s_lshl_b32 s36, s36, 8
    s_add_u32 s37, s37, s36
    v_and_b32 v6, 1, v4
    v_mul_u32_u24 v6, 384, v6
    v_lshl_add_u32 v6, v3, 4, v6
    v_lshrrev_b32 v7, 1, v4
    v_lshl_add_u32 v6, v7, 3, v6
    s_cmp_lg_u32 s36, 0
    s_cselect_b32 s36, 4, 99
    s_cselect_b32 exec_lo, 0x00ff00ff, -1
    v_cmp_eq_u32 vcc, s36, v3
    v_mov_b32 v7, 0x3f803f80
    s_mov_b32 exec_hi, exec_lo
    s_waitcnt lgkmcnt(0)
    v_cndmask_b32 v174, v174, v7, vcc
    v_cndmask_b32 v175, v175, v7, vcc
    buffer_store_dwordx2 v[174:175], v6, s[4:7], s37 offen offset:1280 sc1
    s_mov_b64 exec, -1
    s_branch L_kvj_12
L_kvdone_9:
    v_mov_b32 v6, 1073741824
    buffer_store_dwordx2 v[172:173], v6, s[4:7], 0 offen
L_kvj_12:
    s_waitcnt vmcnt(1)
    v_add_f32 v216, v216, v220
    v_add_f32 v217, v217, v221
    v_add_f32 v218, v218, v222
    v_add_f32 v219, v219, v223
    v_add_f32 v224, v224, v228
    v_add_f32 v225, v225, v229
    v_add_f32 v226, v226, v230
    v_add_f32 v227, v227, v231
    v_add_f32 v216, v216, v224
    v_add_f32 v217, v217, v225
    v_add_f32 v218, v218, v226
    v_add_f32 v219, v219, v227
    v_add_f32 v216, v216, v232
    v_add_f32 v217, v217, v233
    v_add_f32 v218, v218, v234
    v_add_f32 v219, v219, v235
    s_mul_i32 s36, s20, 384
    s_add_u32 s36, s36, 162112
    v_add_u32 v7, s36, v1
    s_mov_b64 exec, 0xfffff
    ds_write_b128 v7, v[216:219]
    s_mov_b64 exec, -1
    s_waitcnt lgkmcnt(0)
    s_barrier
    ds_read_b128 v[100:103], v240 offset:0
    ds_read_b128 v[104:107], v240 offset:1024
    ds_read_b128 v[108:111], v240 offset:2048
    ds_read_b128 v[112:115], v240 offset:3072
    ds_read_b128 v[116:119], v240 offset:4096
    ds_read_b128 v[120:123], v240 offset:6144
    ds_read_b128 v[124:127], v240 offset:7168
    ds_read_b128 v[128:131], v240 offset:8192
    s_waitcnt lgkmcnt(7)
    v_mfma_f32_16x16x32_bf16 v[148:151], v[100:103], v[20:23], 0
    ds_read_b128 v[132:135], v240 offset:9216
    s_waitcnt lgkmcnt(7)
    v_mfma_f32_16x16x32_bf16 v[152:155], v[104:107], v[20:23], 0
    ds_read_b128 v[136:139], v240 offset:10240
    s_mul_i32 s53, s20, 6144
    s_add_u32 s53, s53, 73728
    s_mul_i32 s52, s24, 122880
    s_add_u32 s52, s52, s53
    s_add_u32 s52, s52, 16384
    s_mov_b32 m0, s53
    s_nop 0
    buffer_load_dwordx4 v1, s[4:7], s52 offen offset:0 sc1 lds
    s_waitcnt lgkmcnt(7)
    v_mfma_f32_16x16x32_bf16 v[156:159], v[108:111], v[20:23], 0
    ds_read_b128 v[140:143], v240 offset:12288
    s_waitcnt lgkmcnt(7)
    v_mfma_f32_16x16x32_bf16 v[160:163], v[112:115], v[20:23], 0
    ds_read_b128 v[144:147], v240 offset:13312
    buffer_load_dwordx4 v1, s[4:7], s52 offen offset:1024 sc1 lds
    s_waitcnt lgkmcnt(7)
    v_mfma_f32_16x16x32_bf16 v[164:167], v[116:119], v[20:23], 0
    ds_read_b128 v[100:103], v240 offset:14336
    s_waitcnt lgkmcnt(7)
    v_mfma_f32_16x16x32_bf16 v[148:151], v[120:123], v[24:27], v[148:151]
    ds_read_b128 v[104:107], v240 offset:15360
    buffer_load_dwordx4 v1, s[4:7], s52 offen offset:2048 sc1 lds
    s_waitcnt lgkmcnt(7)
    v_mfma_f32_16x16x32_bf16 v[152:155], v[124:127], v[24:27], v[152:155]
    ds_read_b128 v[108:111], v240 offset:16384
    s_waitcnt lgkmcnt(7)
    v_mfma_f32_16x16x32_bf16 v[156:159], v[128:131], v[24:27], v[156:159]
    ds_read_b128 v[112:115], v240 offset:18432
    buffer_load_dwordx4 v1, s[4:7], s52 offen offset:3072 sc1 lds
    s_waitcnt lgkmcnt(7)
    v_mfma_f32_16x16x32_bf16 v[160:163], v[132:135], v[24:27], v[160:163]
    ds_read_b128 v[116:119], v240 offset:19456
    s_waitcnt lgkmcnt(7)
    v_mfma_f32_16x16x32_bf16 v[164:167], v[136:139], v[24:27], v[164:167]
    ds_read_b128 v[120:123], v240 offset:20480
    s_add_u32 s52, s52, 4096
    s_add_u32 s53, s53, 4096
    s_mov_b32 m0, s53
    s_nop 0
    buffer_load_dwordx4 v1, s[4:7], s52 offen offset:0 sc1 lds
    s_waitcnt lgkmcnt(7)
    v_mfma_f32_16x16x32_bf16 v[148:151], v[140:143], v[28:31], v[148:151]
    ds_read_b128 v[124:127], v240 offset:21504
    s_waitcnt lgkmcnt(7)
    v_mfma_f32_16x16x32_bf16 v[152:155], v[144:147], v[28:31], v[152:155]
    ds_read_b128 v[128:131], v240 offset:22528
    s_mul_i32 s53, s20, 6144
    s_add_u32 s53, s53, 98304
    s_mul_i32 s52, s24, 122880
    s_add_u32 s52, s52, s53
    s_add_u32 s52, s52, 16384
    s_mov_b32 m0, s53
    s_nop 0
    buffer_load_dwordx4 v1, s[4:7], s52 offen offset:0 sc1 lds
    s_waitcnt lgkmcnt(7)
    v_mfma_f32_16x16x32_bf16 v[156:159], v[100:103], v[28:31], v[156:159]
    ds_read_b128 v[132:135], v240 offset:24576
    s_waitcnt lgkmcnt(7)
    v_mfma_f32_16x16x32_bf16 v[160:163], v[104:107], v[28:31], v[160:163]
    ds_read_b128 v[136:139], v240 offset:25600
    buffer_load_dwordx4 v1, s[4:7], s52 offen offset:1024 sc1 lds
    s_waitcnt lgkmcnt(7)
    v_mfma_f32_16x16x32_bf16 v[164:167], v[108:111], v[28:31], v[164:167]
    ds_read_b128 v[140:143], v240 offset:26624
    s_waitcnt lgkmcnt(7)
    v_mfma_f32_16x16x32_bf16 v[148:151], v[112:115], v[32:35], v[148:151]
    ds_read_b128 v[144:147], v240 offset:27648
    buffer_load_dwordx4 v1, s[4:7], s52 offen offset:2048 sc1 lds
    s_waitcnt lgkmcnt(7)
    v_mfma_f32_16x16x32_bf16 v[152:155], v[116:119], v[32:35], v[152:155]
    ds_read_b128 v[100:103], v240 offset:28672
    s_waitcnt lgkmcnt(7)
    v_mfma_f32_16x16x32_bf16 v[156:159], v[120:123], v[32:35], v[156:159]
    ds_read_b128 v[104:107], v240 offset:30720
    buffer_load_dwordx4 v1, s[4:7], s52 offen offset:3072 sc1 lds
    s_waitcnt lgkmcnt(7)
    v_mfma_f32_16x16x32_bf16 v[160:163], v[124:127], v[32:35], v[160:163]
    ds_read_b128 v[108:111], v240 offset:31744
    s_waitcnt lgkmcnt(7)
    v_mfma_f32_16x16x32_bf16 v[164:167], v[128:131], v[32:35], v[164:167]
    ds_read_b128 v[112:115], v240 offset:32768
    s_add_u32 s52, s52, 4096
    s_add_u32 s53, s53, 4096
    s_mov_b32 m0, s53
    s_nop 0
    buffer_load_dwordx4 v1, s[4:7], s52 offen offset:0 sc1 lds
    s_waitcnt lgkmcnt(7)
    v_mfma_f32_16x16x32_bf16 v[148:151], v[132:135], v[36:39], v[148:151]
    ds_read_b128 v[116:119], v240 offset:33792
    s_waitcnt lgkmcnt(7)
    v_mfma_f32_16x16x32_bf16 v[152:155], v[136:139], v[36:39], v[152:155]
    ds_read_b128 v[120:123], v240 offset:34816
    s_waitcnt lgkmcnt(7)
    v_mfma_f32_16x16x32_bf16 v[156:159], v[140:143], v[36:39], v[156:159]
    ds_read_b128 v[124:127], v240 offset:36864
    s_waitcnt lgkmcnt(7)
    v_mfma_f32_16x16x32_bf16 v[160:163], v[144:147], v[36:39], v[160:163]
    ds_read_b128 v[128:131], v240 offset:37888
    s_waitcnt lgkmcnt(7)
    v_mfma_f32_16x16x32_bf16 v[164:167], v[100:103], v[36:39], v[164:167]
    ds_read_b128 v[132:135], v240 offset:38912
    s_waitcnt vmcnt(10)
    s_barrier
    s_cmp_lg_u32 s20, 0
    s_cbranch_scc1 L_kvsig_13
    v_mov_b32 v5, s75
    s_mov_b64 exec, 1
    buffer_store_dword v5, off, s[4:7], s95 sc1
    s_mov_b64 exec, -1
L_kvsig_13:
    s_waitcnt lgkmcnt(7)
    v_mfma_f32_16x16x32_bf16 v[148:151], v[104:107], v[40:43], v[148:151]
    ds_read_b128 v[136:139], v240 offset:39936
    s_waitcnt lgkmcnt(7)
    v_mfma_f32_16x16x32_bf16 v[152:155], v[108:111], v[40:43], v[152:155]
    ds_read_b128 v[140:143], v240 offset:40960
    s_waitcnt lgkmcnt(7)
    v_mfma_f32_16x16x32_bf16 v[156:159], v[112:115], v[40:43], v[156:159]
    ds_read_b128 v[144:147], v240 offset:43008
    s_waitcnt lgkmcnt(7)
    v_mfma_f32_16x16x32_bf16 v[160:163], v[116:119], v[40:43], v[160:163]
    ds_read_b128 v[100:103], v240 offset:44032
    s_waitcnt lgkmcnt(7)
    v_mfma_f32_16x16x32_bf16 v[164:167], v[120:123], v[40:43], v[164:167]
    ds_read_b128 v[104:107], v240 offset:45056
    s_waitcnt lgkmcnt(7)
    v_mfma_f32_16x16x32_bf16 v[148:151], v[124:127], v[44:47], v[148:151]
    ds_read_b128 v[108:111], v240 offset:46080
    s_waitcnt lgkmcnt(7)
    v_mfma_f32_16x16x32_bf16 v[152:155], v[128:131], v[44:47], v[152:155]
    ds_read_b128 v[112:115], v240 offset:47104
    s_waitcnt lgkmcnt(7)
    v_mfma_f32_16x16x32_bf16 v[156:159], v[132:135], v[44:47], v[156:159]
    ds_read_b128 v[116:119], v240 offset:49152
    s_waitcnt lgkmcnt(7)
    v_mfma_f32_16x16x32_bf16 v[160:163], v[136:139], v[44:47], v[160:163]
    ds_read_b128 v[120:123], v240 offset:50176
    s_waitcnt lgkmcnt(7)
    v_mfma_f32_16x16x32_bf16 v[164:167], v[140:143], v[44:47], v[164:167]
    ds_read_b128 v[124:127], v240 offset:51200
    s_waitcnt lgkmcnt(7)
    v_mfma_f32_16x16x32_bf16 v[148:151], v[144:147], v[48:51], v[148:151]
    ds_read_b128 v[128:131], v240 offset:52224
    s_waitcnt lgkmcnt(7)
    v_mfma_f32_16x16x32_bf16 v[152:155], v[100:103], v[48:51], v[152:155]
    ds_read_b128 v[132:135], v240 offset:53248
    s_waitcnt lgkmcnt(7)
    v_mfma_f32_16x16x32_bf16 v[156:159], v[104:107], v[48:51], v[156:159]
    ds_read_b128 v[136:139], v240 offset:55296
    s_waitcnt lgkmcnt(7)
    v_mfma_f32_16x16x32_bf16 v[160:163], v[108:111], v[48:51], v[160:163]
    ds_read_b128 v[140:143], v240 offset:56320
    s_waitcnt lgkmcnt(7)
    v_mfma_f32_16x16x32_bf16 v[164:167], v[112:115], v[48:51], v[164:167]
    ds_read_b128 v[144:147], v240 offset:57344
    s_waitcnt lgkmcnt(7)
    v_mfma_f32_16x16x32_bf16 v[148:151], v[116:119], v[52:55], v[148:151]
    ds_read_b128 v[100:103], v240 offset:58368
    s_waitcnt lgkmcnt(7)
    v_mfma_f32_16x16x32_bf16 v[152:155], v[120:123], v[52:55], v[152:155]
    ds_read_b128 v[104:107], v240 offset:59392
    s_waitcnt lgkmcnt(7)
    v_mfma_f32_16x16x32_bf16 v[156:159], v[124:127], v[52:55], v[156:159]
    ds_read_b128 v[108:111], v241 offset:0
    s_waitcnt lgkmcnt(7)
    v_mfma_f32_16x16x32_bf16 v[160:163], v[128:131], v[52:55], v[160:163]
    ds_read_b128 v[112:115], v241 offset:1024
    s_waitcnt lgkmcnt(7)
    v_mfma_f32_16x16x32_bf16 v[164:167], v[132:135], v[52:55], v[164:167]
    ds_read_b128 v[116:119], v241 offset:2048
    s_waitcnt lgkmcnt(7)
    v_mfma_f32_16x16x32_bf16 v[148:151], v[136:139], v[56:59], v[148:151]
    ds_read_b128 v[120:123], v241 offset:3072
    s_waitcnt lgkmcnt(7)
    v_mfma_f32_16x16x32_bf16 v[152:155], v[140:143], v[56:59], v[152:155]
    ds_read_b128 v[124:127], v241 offset:4096
    s_waitcnt lgkmcnt(7)
    v_mfma_f32_16x16x32_bf16 v[156:159], v[144:147], v[56:59], v[156:159]
    ds_read_b128 v[128:131], v241 offset:6144
    s_waitcnt lgkmcnt(7)
    v_mfma_f32_16x16x32_bf16 v[160:163], v[100:103], v[56:59], v[160:163]
    ds_read_b128 v[132:135], v241 offset:7168
    s_waitcnt lgkmcnt(7)
    v_mfma_f32_16x16x32_bf16 v[164:167], v[104:107], v[56:59], v[164:167]
    ds_read_b128 v[136:139], v241 offset:8192
    s_waitcnt lgkmcnt(7)
    v_mfma_f32_16x16x32_bf16 v[148:151], v[108:111], v[60:63], v[148:151]
    ds_read_b128 v[140:143], v241 offset:9216
    s_waitcnt lgkmcnt(7)
    v_mfma_f32_16x16x32_bf16 v[152:155], v[112:115], v[60:63], v[152:155]
    ds_read_b128 v[144:147], v241 offset:10240
    s_waitcnt lgkmcnt(7)
    v_mfma_f32_16x16x32_bf16 v[156:159], v[116:119], v[60:63], v[156:159]
    s_waitcnt lgkmcnt(6)
    v_mfma_f32_16x16x32_bf16 v[160:163], v[120:123], v[60:63], v[160:163]
    s_waitcnt lgkmcnt(5)
    v_mfma_f32_16x16x32_bf16 v[164:167], v[124:127], v[60:63], v[164:167]
    s_waitcnt lgkmcnt(4)
    v_mfma_f32_16x16x32_bf16 v[148:151], v[128:131], v[64:67], v[148:151]
    s_waitcnt lgkmcnt(3)
    v_mfma_f32_16x16x32_bf16 v[152:155], v[132:135], v[64:67], v[152:155]
    s_waitcnt lgkmcnt(2)
    v_mfma_f32_16x16x32_bf16 v[156:159], v[136:139], v[64:67], v[156:159]
    s_waitcnt lgkmcnt(1)
    v_mfma_f32_16x16x32_bf16 v[160:163], v[140:143], v[64:67], v[160:163]
    s_waitcnt lgkmcnt(0)
    v_mfma_f32_16x16x32_bf16 v[164:167], v[144:147], v[64:67], v[164:167]
    s_waitcnt vmcnt(0)
    s_barrier
    v_add_u32 v7, 162112, v1
    s_mov_b64 exec, 0xfffff
    ds_read_b128 v[216:219], v7 offset:0
    ds_read_b128 v[220:223], v7 offset:384
    ds_read_b128 v[224:227], v7 offset:768
    ds_read_b128 v[228:231], v7 offset:1152
    s_waitcnt lgkmcnt(0)
    v_add_f32 v216, v216, v220
    v_add_f32 v217, v217, v221
    v_add_f32 v218, v218, v222
    v_add_f32 v219, v219, v223
    v_add_f32 v224, v224, v228
    v_add_f32 v225, v225, v229
    v_add_f32 v226, v226, v230
    v_add_f32 v227, v227, v231
    v_add_f32 v216, v216, v224
    v_add_f32 v217, v217, v225
    v_add_f32 v218, v218, v226
    v_add_f32 v219, v219, v227
    v_add_u32 v7, 160640, v1
    ds_write_b128 v7, v[216:219]
    s_mov_b64 exec, -1
    s_waitcnt lgkmcnt(0)
    ds_read_b128 v[100:103], v241 offset:12288
    ds_read_b128 v[104:107], v241 offset:13312
    ds_read_b128 v[108:111], v241 offset:14336
    ds_read_b128 v[112:115], v241 offset:15360
    ds_read_b128 v[116:119], v241 offset:16384
    ds_read_b128 v[120:123], v241 offset:18432
    ds_read_b128 v[124:127], v241 offset:19456
    ds_read_b128 v[128:131], v241 offset:20480
    s_waitcnt lgkmcnt(7)
    v_mfma_f32_16x16x32_bf16 v[148:151], v[100:103], v[68:71], v[148:151]
    ds_read_b128 v[132:135], v241 offset:21504
    s_waitcnt lgkmcnt(7)
    v_mfma_f32_16x16x32_bf16 v[152:155], v[104:107], v[68:71], v[152:155]
    ds_read_b128 v[136:139], v241 offset:22528
    s_waitcnt lgkmcnt(7)
    v_mfma_f32_16x16x32_bf16 v[156:159], v[108:111], v[68:71], v[156:159]
    ds_read_b128 v[140:143], v241 offset:24576
    s_waitcnt lgkmcnt(7)
    v_mfma_f32_16x16x32_bf16 v[160:163], v[112:115], v[68:71], v[160:163]
    ds_read_b128 v[144:147], v241 offset:25600
    s_waitcnt lgkmcnt(7)
    v_mfma_f32_16x16x32_bf16 v[164:167], v[116:119], v[68:71], v[164:167]
    ds_read_b128 v[100:103], v241 offset:26624
    s_waitcnt lgkmcnt(7)
    v_mfma_f32_16x16x32_bf16 v[148:151], v[120:123], v[72:75], v[148:151]
    ds_read_b128 v[104:107], v241 offset:27648
    s_waitcnt lgkmcnt(7)
    v_mfma_f32_16x16x32_bf16 v[152:155], v[124:127], v[72:75], v[152:155]
    ds_read_b128 v[108:111], v241 offset:28672
    s_waitcnt lgkmcnt(7)
    v_mfma_f32_16x16x32_bf16 v[156:159], v[128:131], v[72:75], v[156:159]
    ds_read_b128 v[112:115], v241 offset:30720
    s_waitcnt lgkmcnt(7)
    v_mfma_f32_16x16x32_bf16 v[160:163], v[132:135], v[72:75], v[160:163]
    ds_read_b128 v[116:119], v241 offset:31744
    s_waitcnt lgkmcnt(7)
    v_mfma_f32_16x16x32_bf16 v[164:167], v[136:139], v[72:75], v[164:167]
    ds_read_b128 v[120:123], v241 offset:32768
    s_waitcnt lgkmcnt(7)
    v_mfma_f32_16x16x32_bf16 v[148:151], v[140:143], v[76:79], v[148:151]
    ds_read_b128 v[124:127], v241 offset:33792
    s_waitcnt lgkmcnt(7)
    v_mfma_f32_16x16x32_bf16 v[152:155], v[144:147], v[76:79], v[152:155]
    ds_read_b128 v[128:131], v241 offset:34816
    s_waitcnt lgkmcnt(7)
    v_mfma_f32_16x16x32_bf16 v[156:159], v[100:103], v[76:79], v[156:159]
    ds_read_b128 v[132:135], v241 offset:36864
    s_waitcnt lgkmcnt(7)
    v_mfma_f32_16x16x32_bf16 v[160:163], v[104:107], v[76:79], v[160:163]
    ds_read_b128 v[136:139], v241 offset:37888
    s_waitcnt lgkmcnt(7)
    v_mfma_f32_16x16x32_bf16 v[164:167], v[108:111], v[76:79], v[164:167]
    ds_read_b128 v[140:143], v241 offset:38912
    s_waitcnt lgkmcnt(7)
    v_mfma_f32_16x16x32_bf16 v[148:151], v[112:115], v[80:83], v[148:151]
    ds_read_b128 v[144:147], v241 offset:39936
    s_waitcnt lgkmcnt(7)
    v_mfma_f32_16x16x32_bf16 v[152:155], v[116:119], v[80:83], v[152:155]
    ds_read_b128 v[100:103], v241 offset:40960
    s_waitcnt lgkmcnt(7)
    v_mfma_f32_16x16x32_bf16 v[156:159], v[120:123], v[80:83], v[156:159]
    ds_read_b128 v[104:107], v241 offset:43008
    s_waitcnt lgkmcnt(7)
    v_mfma_f32_16x16x32_bf16 v[160:163], v[124:127], v[80:83], v[160:163]
    ds_read_b128 v[108:111], v241 offset:44032
    s_waitcnt lgkmcnt(7)
    v_mfma_f32_16x16x32_bf16 v[164:167], v[128:131], v[80:83], v[164:167]
    ds_read_b128 v[112:115], v241 offset:45056
    s_waitcnt lgkmcnt(7)
    v_mfma_f32_16x16x32_bf16 v[148:151], v[132:135], v[84:87], v[148:151]
    ds_read_b128 v[116:119], v241 offset:46080
    s_waitcnt lgkmcnt(7)
    v_mfma_f32_16x16x32_bf16 v[152:155], v[136:139], v[84:87], v[152:155]
    ds_read_b128 v[120:123], v241 offset:47104
    s_waitcnt lgkmcnt(7)
    v_mfma_f32_16x16x32_bf16 v[156:159], v[140:143], v[84:87], v[156:159]
    ds_read_b128 v[124:127], v241 offset:49152
    s_waitcnt lgkmcnt(7)
    v_mfma_f32_16x16x32_bf16 v[160:163], v[144:147], v[84:87], v[160:163]
    ds_read_b128 v[128:131], v241 offset:50176
    s_waitcnt lgkmcnt(7)
    v_mfma_f32_16x16x32_bf16 v[164:167], v[100:103], v[84:87], v[164:167]
    ds_read_b128 v[132:135], v241 offset:51200
    s_waitcnt lgkmcnt(7)
    v_mfma_f32_16x16x32_bf16 v[148:151], v[104:107], v[88:91], v[148:151]
    ds_read_b128 v[136:139], v241 offset:52224
    s_waitcnt lgkmcnt(7)
    v_mfma_f32_16x16x32_bf16 v[152:155], v[108:111], v[88:91], v[152:155]
    ds_read_b128 v[140:143], v241 offset:53248
    s_waitcnt lgkmcnt(7)
    v_mfma_f32_16x16x32_bf16 v[156:159], v[112:115], v[88:91], v[156:159]
    ds_read_b128 v[144:147], v241 offset:55296
    s_waitcnt lgkmcnt(7)
    v_mfma_f32_16x16x32_bf16 v[160:163], v[116:119], v[88:91], v[160:163]
    ds_read_b128 v[100:103], v241 offset:56320
    s_waitcnt lgkmcnt(7)
    v_mfma_f32_16x16x32_bf16 v[164:167], v[120:123], v[88:91], v[164:167]
    ds_read_b128 v[104:107], v241 offset:57344
    s_waitcnt lgkmcnt(7)
    v_mfma_f32_16x16x32_bf16 v[148:151], v[124:127], v[92:95], v[148:151]
    ds_read_b128 v[108:111], v241 offset:58368
    s_waitcnt lgkmcnt(7)
    v_mfma_f32_16x16x32_bf16 v[152:155], v[128:131], v[92:95], v[152:155]
    ds_read_b128 v[112:115], v241 offset:59392
    s_waitcnt lgkmcnt(7)
    v_mfma_f32_16x16x32_bf16 v[156:159], v[132:135], v[92:95], v[156:159]
    s_waitcnt lgkmcnt(6)
    v_mfma_f32_16x16x32_bf16 v[160:163], v[136:139], v[92:95], v[160:163]
    s_waitcnt lgkmcnt(5)
    v_mfma_f32_16x16x32_bf16 v[164:167], v[140:143], v[92:95], v[164:167]
    s_waitcnt lgkmcnt(4)
    v_mfma_f32_16x16x32_bf16 v[148:151], v[144:147], v[96:99], v[148:151]
    s_waitcnt lgkmcnt(3)
    v_mfma_f32_16x16x32_bf16 v[152:155], v[100:103], v[96:99], v[152:155]
    s_waitcnt lgkmcnt(2)
    v_mfma_f32_16x16x32_bf16 v[156:159], v[104:107], v[96:99], v[156:159]
    s_waitcnt lgkmcnt(1)
    v_mfma_f32_16x16x32_bf16 v[160:163], v[108:111], v[96:99], v[160:163]
    s_waitcnt lgkmcnt(0)
    v_mfma_f32_16x16x32_bf16 v[164:167], v[112:115], v[96:99], v[164:167]
    v_lshlrev_b32 v6, 4, v4
    v_add_u32 v6, 160640, v6
    ds_read_b128 v[216:219], v6 offset:0
    ds_read_b128 v[220:223], v6 offset:64
    ds_read_b128 v[224:227], v6 offset:128
    ds_read_b128 v[228:231], v6 offset:192
    ds_read_b128 v[232:235], v6 offset:256
    s_waitcnt lgkmcnt(0)
    v_mul_f32 v214, 0x3ea52b5c, v213
    v_pk_fma_f32 v[148:149], v[212:213], v[216:217], v[148:149] op_sel_hi:[0,1,1]
    v_pk_fma_f32 v[150:151], v[212:213], v[218:219], v[150:151] op_sel_hi:[0,1,1]
    v_pk_fma_f32 v[152:153], v[212:213], v[220:221], v[152:153] op_sel_hi:[0,1,1]
    v_pk_fma_f32 v[154:155], v[212:213], v[222:223], v[154:155] op_sel_hi:[0,1,1]
    v_pk_fma_f32 v[156:157], v[212:213], v[224:225], v[156:157] op_sel_hi:[0,1,1]
    v_pk_fma_f32 v[158:159], v[212:213], v[226:227], v[158:159] op_sel_hi:[0,1,1]
    v_pk_fma_f32 v[160:161], v[212:213], v[228:229], v[160:161] op_sel_hi:[0,1,1]
    v_pk_fma_f32 v[162:163], v[212:213], v[230:231], v[162:163] op_sel_hi:[0,1,1]
    v_pk_fma_f32 v[164:165], v[212:213], v[232:233], v[164:165] op_sel_hi:[0,1,1]
    v_pk_fma_f32 v[166:167], v[212:213], v[234:235], v[166:167] op_sel_hi:[0,1,1]
    v_pk_mul_f32 v[148:149], v[214:215], v[148:149] op_sel_hi:[0,1]
    v_pk_mul_f32 v[150:151], v[214:215], v[150:151] op_sel_hi:[0,1]
    v_pk_mul_f32 v[152:153], v[214:215], v[152:153] op_sel_hi:[0,1]
    v_pk_mul_f32 v[154:155], v[214:215], v[154:155] op_sel_hi:[0,1]
    v_pk_mul_f32 v[156:157], v[214:215], v[156:157] op_sel_hi:[0,1]
    v_pk_mul_f32 v[158:159], v[214:215], v[158:159] op_sel_hi:[0,1]
    v_pk_mul_f32 v[160:161], v[214:215], v[160:161] op_sel_hi:[0,1]
    v_pk_mul_f32 v[162:163], v[214:215], v[162:163] op_sel_hi:[0,1]
    v_pk_mul_f32 v[164:165], v[214:215], v[164:165] op_sel_hi:[0,1]
    v_pk_mul_f32 v[166:167], v[214:215], v[166:167] op_sel_hi:[0,1]
    v_cvt_pk_bf16_f32 v176, v148, v149
    v_cvt_pk_bf16_f32 v177, v150, v151
    v_cvt_pk_bf16_f32 v178, v152, v153
    v_cvt_pk_bf16_f32 v179, v154, v155
    v_cvt_pk_bf16_f32 v180, v156, v157
    v_cvt_pk_bf16_f32 v181, v158, v159
    v_cvt_pk_bf16_f32 v182, v160, v161
    v_cvt_pk_bf16_f32 v183, v162, v163
    v_cvt_pk_bf16_f32 v184, v164, v165
    v_mov_b32 v185, 0
    v_cvt_pk_bf16_f32 v186, v166, v167
    v_mov_b32 v187, 0
    s_lshr_b32 s36, s20, 1
    s_mul_i32 s36, s36, 1536
    s_add_u32 s36, s36, 147456
    s_and_b32 s37, s20, 1
    s_lshl_b32 s37, s37, 4
    v_add_u32 v6, s37, v3
    v_mul_u32_u24 v7, 3072, v4
    v_add_u32 v7, s36, v7
    v_lshl_add_u32 v5, v6, 4, v7
    v_lshl_add_u32 v6, v6, 3, v7
    ds_write_b128 v5, v[176:179]
    ds_write_b128 v5, v[180:183] offset:512
    ds_write_b64 v6, v[184:185] offset:1024
    ds_write_b64 v6, v[186:187] offset:1280
    s_waitcnt lgkmcnt(0)
    s_barrier
    s_waitcnt vmcnt(0)
    s_cmp_eq_u32 s69, 0
    s_cbranch_scc1 L_pf0_16
    s_cmp_eq_u32 s69, 7
    s_cbranch_scc1 L_pf7_14
    v_lshrrev_b32 v5, 2, v0
    v_and_b32 v6, 3, v0
    v_mul_u32_u24 v5, 160, v5
    v_lshl_add_u32 v5, v6, 3, v5
    v_add_u32 v5, s72, v5
    ds_read_b64_tr_b16 v[160:161], v5 offset:0
    ds_read_b64_tr_b16 v[162:163], v5 offset:2560
    ds_read_b64_tr_b16 v[164:165], v5 offset:32
    ds_read_b64_tr_b16 v[166:167], v5 offset:2592
    ds_read_b64_tr_b16 v[168:169], v5 offset:64
    ds_read_b64_tr_b16 v[170:171], v5 offset:2624
    ds_read_b64_tr_b16 v[172:173], v5 offset:96
    ds_read_b64_tr_b16 v[174:175], v5 offset:2656
    ds_read_b64_tr_b16 v[176:177], v5 offset:128
    ds_read_b64_tr_b16 v[178:179], v5 offset:2688
    s_add_u32 s72, s70, 4096
    s_mov_b32 s69, 1073741824
    s_mov_b32 s71, 1073741824
    s_branch L_pfe_15
L_pf0_16:
    s_mov_b32 s70, 1073741824
    s_mov_b32 s72, 1073741824
    s_mov_b32 s69, 1073741824
    s_mov_b32 s71, 1073741824
    s_branch L_pfe_15
L_pf7_14:
    v_lshrrev_b32 v5, 2, v0
    v_and_b32 v6, 3, v0
    v_mul_u32_u24 v5, 224, v5
    v_lshl_add_u32 v5, v6, 3, v5
    v_add_u32 v5, s72, v5
    ds_read_b64_tr_b16 v[160:161], v5 offset:0
    ds_read_b64_tr_b16 v[162:163], v5 offset:3584
    ds_read_b64_tr_b16 v[164:165], v5 offset:32
    ds_read_b64_tr_b16 v[166:167], v5 offset:3616
    ds_read_b64_tr_b16 v[168:169], v5 offset:64
    ds_read_b64_tr_b16 v[170:171], v5 offset:3648
    ds_read_b64_tr_b16 v[172:173], v5 offset:96
    ds_read_b64_tr_b16 v[174:175], v5 offset:3680
    ds_read_b64_tr_b16 v[176:177], v5 offset:128
    ds_read_b64_tr_b16 v[178:179], v5 offset:3712
    ds_read_b64_tr_b16 v[180:181], v5 offset:160
    ds_read_b64_tr_b16 v[182:183], v5 offset:3744
    ds_read_b64_tr_b16 v[184:185], v5 offset:192
    ds_read_b64_tr_b16 v[186:187], v5 offset:3776
    s_add_u32 s72, s70, 4096
    s_mov_b32 s69, s72
    s_waitcnt lgkmcnt(0)
    v_mov_b32 v216, 0x3f803f80
    v_mov_b32 v217, 0x3f803f80
    v_mov_b32 v218, 0x3f803f80
    v_mov_b32 v219, 0x3f803f80
    s_nop 1
    v_mfma_f32_16x16x32_bf16 v[188:191], v[160:163], v[216:219], 0
    v_mfma_f32_16x16x32_bf16 v[192:195], v[164:167], v[216:219], 0
    v_mfma_f32_16x16x32_bf16 v[196:199], v[168:171], v[216:219], 0
    v_mfma_f32_16x16x32_bf16 v[200:203], v[172:175], v[216:219], 0
    v_mfma_f32_16x16x32_bf16 v[204:207], v[176:179], v[216:219], 0
    v_mfma_f32_16x16x32_bf16 v[208:211], v[180:183], v[216:219], 0
    v_mfma_f32_16x16x32_bf16 v[212:215], v[184:187], v[216:219], 0
    s_mov_b32 exec_lo, 0x20002
    s_mov_b32 exec_hi, 0x20002
    s_nop 0
    v_mov_b32 v188, v192
    v_mov_b32 v189, v193
    v_mov_b32 v190, v194
    v_mov_b32 v191, v195
    s_mov_b32 exec_lo, 0x40004
    s_mov_b32 exec_hi, 0x40004
    v_mov_b32 v188, v196
    v_mov_b32 v189, v197
    v_mov_b32 v190, v198
    v_mov_b32 v191, v199
    s_mov_b32 exec_lo, 0x80008
    s_mov_b32 exec_hi, 0x80008
    v_mov_b32 v188, v200
    v_mov_b32 v189, v201
    v_mov_b32 v190, v202
    v_mov_b32 v191, v203
    s_mov_b32 exec_lo, 0x100010
    s_mov_b32 exec_hi, 0x100010
    v_mov_b32 v188, v204
    v_mov_b32 v189, v205
    v_mov_b32 v190, v206
    v_mov_b32 v191, v207
    s_mov_b32 exec_lo, 0x200020
    s_mov_b32 exec_hi, 0x200020
    v_mov_b32 v188, v208
    v_mov_b32 v189, v209
    v_mov_b32 v190, v210
    v_mov_b32 v191, v211
    s_mov_b32 exec_lo, 0x400040
    s_mov_b32 exec_hi, 0x400040
    v_mov_b32 v188, v212
    v_mov_b32 v189, v213
    v_mov_b32 v190, v214
    v_mov_b32 v191, v215
    s_mov_b64 exec, -1
L_pfe_15:
    v_lshlrev_b32 v220, 6, v3
    v_lshl_add_u32 v220, v4, 4, v220
    v_mov_b32 v5, 1073741824
    v_cmp_lt_u32 vcc, 6, v3
    s_nop 1
    v_cndmask_b32 v220, v220, v5, vcc
    s_waitcnt lgkmcnt(0)
L_layer:
    s_mov_b32 s57, 0
L_att:
    s_add_u32 s31, s28, 7053312
    s_cmp_lg_u32 s20, 0
    s_cbranch_scc1 L_kvp0_17
    buffer_load_dwordx4 v[156:159], v1, s[4:7], s31 offen sc1
L_kvp0_17:
    s_mov_b32 s59, 384
    s_mov_b32 s58, 0x3f803f80
    s_add_u32 s56, s28, 6873088
    s_mul_i32 s60, s20, 45056
    s_add_u32 s60, s60, s56
    v_lshlrev_b32 v116, 4, v0
    v_and_b32 v119, 31, v0
    v_lshrrev_b32 v120, 5, v0
    v_lshlrev_b32 v117, 3, v119
    v_lshl_add_u32 v117, v120, 2, v117
    v_lshlrev_b32 v118, 4, v119
    v_mad_u32_u24 v118, v120, s59, v118
    v_cmp_lt_u32 vcc, 20, v119
    v_mov_b32 v120, 0x40000000
    s_nop 0
    v_cndmask_b32 v118, v118, v120, vcc
    s_add_u32 s63, s20, 1
    s_and_b32 s63, s63, 3
    s_mul_i32 s61, s63, 3072
    s_add_u32 s61, s61, 147456
    v_lshl_add_u32 v112, v0, 4, s61
    v_lshl_add_u32 v113, v0, 3, s61
    ds_read_b128 v[100:103], v112 offset:0
    ds_read_b64 v[108:109], v113 offset:1024
    ds_read_b128 v[104:107], v112 offset:1536
    ds_read_b64 v[110:111], v113 offset:2560
    v_accvgpr_write_b32 a193, s58
    v_accvgpr_write_b32 a195, s58
    v_accvgpr_write_b32 a197, s58
    v_accvgpr_write_b32 a199, s58
    v_accvgpr_write_b32 a201, s58
    v_accvgpr_write_b32 a203, s58
    v_accvgpr_write_b32 a205, s58
    v_accvgpr_write_b32 a207, s58
    v_accvgpr_write_b32 a209, s58
    v_accvgpr_write_b32 a211, s58
    v_accvgpr_write_b32 a213, s58
    v_accvgpr_write_b32 a215, s58
    v_accvgpr_write_b32 a217, s58
    v_accvgpr_write_b32 a219, s58
    v_accvgpr_write_b32 a221, s58
    v_accvgpr_write_b32 a223, s58
    s_cmp_lg_u32 s20, 0
    s_cbranch_scc1 L_kvp_18
    s_mov_b32 s35, 0
    s_branch L_polle_21
L_poll_19:
    buffer_load_dwordx4 v[156:159], v1, s[4:7], s31 offen sc1
L_polle_21:
    s_add_u32 s35, s35, 1
    s_cmp_gt_u32 s35, 0x40000
    s_cbranch_scc1 L_pollx_20
    s_waitcnt vmcnt(0)
    v_xor_b32 v156, s75, v156
    v_xor_b32 v157, s75, v157
    v_xor_b32 v158, s75, v158
    v_xor_b32 v159, s75, v159
    v_or3_b32 v156, v156, v157, v158
    v_or_b32 v156, v156, v159
    v_cmp_lt_u32 vcc, 7, v156
    s_nop 4
    s_cbranch_vccnz L_poll_19
L_pollx_20:
    s_waitcnt vmcnt(0)
    v_cmp_ne_u32 vcc, 0, v156
    s_lshl_b32 s36, s21, 3
    v_mov_b32 v6, 161028
    s_lshr_b64 s[64:65], vcc, s36
    s_and_b32 s64, s64, 0xff
    s_cselect_b32 s64, 1, 0
    v_mov_b32 v7, s64
    ds_write_b32 v6, v7
    s_waitcnt lgkmcnt(0)
L_kvp_18:
    s_barrier
    buffer_load_dwordx4 a[0:3], v116, s[4:7], s60 offen sc1
    buffer_load_dword a192, v117, s[4:7], s60 offen offset:1024 sc1
    buffer_load_dwordx4 a[4:7], v118, s[4:7], s60 offen offset:1280 sc1
    buffer_load_dwordx4 a[8:11], v118, s[4:7], s60 offen offset:2048 sc1
    s_add_u32 s60, s60, 2816
    buffer_load_dwordx4 a[12:15], v116, s[4:7], s60 offen sc1
    buffer_load_dword a194, v117, s[4:7], s60 offen offset:1024 sc1
    buffer_load_dwordx4 a[16:19], v118, s[4:7], s60 offen offset:1280 sc1
    buffer_load_dwordx4 a[20:23], v118, s[4:7], s60 offen offset:2048 sc1
    s_add_u32 s60, s60, 2816
    buffer_load_dwordx4 a[24:27], v116, s[4:7], s60 offen sc1
    buffer_load_dword a196, v117, s[4:7], s60 offen offset:1024 sc1
    buffer_load_dwordx4 a[28:31], v118, s[4:7], s60 offen offset:1280 sc1
    buffer_load_dwordx4 a[32:35], v118, s[4:7], s60 offen offset:2048 sc1
    s_add_u32 s60, s60, 2816
    s_waitcnt vmcnt(8)
    s_waitcnt lgkmcnt(0)
    v_mfma_f32_32x32x16_bf16 v[20:35], a[0:3], v[100:103], 0
    v_mfma_f32_32x32x8_bf16 v[20:35], a[192:193], v[108:109], v[20:35]
    s_nop 7
    s_nop 2
    v_mfma_f32_32x32x16_bf16 v[36:51], a[0:3], v[104:107], 0
    buffer_load_dwordx4 a[36:39], v116, s[4:7], s60 offen sc1
    v_exp_f32 v20, v20
    v_exp_f32 v21, v21
    v_exp_f32 v22, v22
    v_exp_f32 v23, v23
    v_mfma_f32_32x32x8_bf16 v[36:51], a[192:193], v[110:111], v[36:51]
    buffer_load_dword a198, v117, s[4:7], s60 offen offset:1024 sc1
    v_exp_f32 v24, v24
    v_exp_f32 v25, v25
    v_exp_f32 v26, v26
    v_exp_f32 v27, v27
    v_cvt_pk_bf16_f32 v84, v20, v21
    v_cvt_pk_bf16_f32 v85, v22, v23
    buffer_load_dwordx4 a[40:43], v118, s[4:7], s60 offen offset:1280 sc1
    v_cvt_pk_bf16_f32 v86, v24, v25
    v_cvt_pk_bf16_f32 v87, v26, v27
    v_exp_f32 v28, v28
    v_exp_f32 v29, v29
    v_exp_f32 v30, v30
    v_exp_f32 v31, v31
    v_mfma_f32_32x32x16_bf16 v[52:67], a[4:7], v[84:87], 0
    buffer_load_dwordx4 a[44:47], v118, s[4:7], s60 offen offset:2048 sc1
    v_exp_f32 v32, v32
    v_exp_f32 v33, v33
    v_exp_f32 v34, v34
    v_exp_f32 v35, v35
    v_cvt_pk_bf16_f32 v88, v28, v29
    v_cvt_pk_bf16_f32 v89, v30, v31
    v_cvt_pk_bf16_f32 v90, v32, v33
    v_cvt_pk_bf16_f32 v91, v34, v35
    s_waitcnt vmcnt(8)
    v_mfma_f32_32x32x16_bf16 v[20:35], a[12:15], v[100:103], 0
    s_add_u32 s60, s60, 2816
    v_exp_f32 v36, v36
    v_exp_f32 v37, v37
    v_exp_f32 v38, v38
    v_exp_f32 v39, v39
    v_mfma_f32_32x32x8_bf16 v[20:35], a[194:195], v[108:109], v[20:35]
    v_exp_f32 v40, v40
    v_exp_f32 v41, v41
    v_exp_f32 v42, v42
    v_exp_f32 v43, v43
    v_cvt_pk_bf16_f32 v92, v36, v37
    v_cvt_pk_bf16_f32 v93, v38, v39
    v_mfma_f32_32x32x16_bf16 v[52:67], a[8:11], v[88:91], v[52:67]
    s_mul_i32 s46, s2, 4
    v_cvt_pk_bf16_f32 v94, v40, v41
    v_cvt_pk_bf16_f32 v95, v42, v43
    v_exp_f32 v44, v44
    v_exp_f32 v45, v45
    v_exp_f32 v46, v46
    v_exp_f32 v47, v47
    v_mfma_f32_32x32x16_bf16 v[68:83], a[4:7], v[92:95], 0
    buffer_store_dwordx4 v[160:163], v1, s[4:7], s70 offen offset:0 sc1
    v_exp_f32 v48, v48
    v_exp_f32 v49, v49
    v_exp_f32 v50, v50
    v_exp_f32 v51, v51
    v_cvt_pk_bf16_f32 v96, v44, v45
    v_cvt_pk_bf16_f32 v97, v46, v47
    v_cvt_pk_bf16_f32 v98, v48, v49
    v_cvt_pk_bf16_f32 v99, v50, v51
    v_mfma_f32_32x32x16_bf16 v[36:51], a[12:15], v[104:107], 0
    buffer_load_dwordx4 a[48:51], v116, s[4:7], s60 offen sc1
    v_exp_f32 v20, v20
    v_exp_f32 v21, v21
    v_exp_f32 v22, v22
    v_exp_f32 v23, v23
    v_mfma_f32_32x32x8_bf16 v[36:51], a[194:195], v[110:111], v[36:51]
    buffer_load_dword a200, v117, s[4:7], s60 offen offset:1024 sc1
    v_exp_f32 v24, v24
    v_exp_f32 v25, v25
    v_exp_f32 v26, v26
    v_exp_f32 v27, v27
    v_cvt_pk_bf16_f32 v84, v20, v21
    v_cvt_pk_bf16_f32 v85, v22, v23
    v_mfma_f32_32x32x16_bf16 v[68:83], a[8:11], v[96:99], v[68:83]
    buffer_load_dwordx4 a[52:55], v118, s[4:7], s60 offen offset:1280 sc1
    v_cvt_pk_bf16_f32 v86, v24, v25
    v_cvt_pk_bf16_f32 v87, v26, v27
    v_exp_f32 v28, v28
    v_exp_f32 v29, v29
    v_exp_f32 v30, v30
    v_exp_f32 v31, v31
    v_mfma_f32_32x32x16_bf16 v[52:67], a[16:19], v[84:87], v[52:67]
    buffer_load_dwordx4 a[56:59], v118, s[4:7], s60 offen offset:2048 sc1
    v_exp_f32 v32, v32
    v_exp_f32 v33, v33
    v_exp_f32 v34, v34
    v_exp_f32 v35, v35
    v_cvt_pk_bf16_f32 v88, v28, v29
    v_cvt_pk_bf16_f32 v89, v30, v31
    v_cvt_pk_bf16_f32 v90, v32, v33
    v_cvt_pk_bf16_f32 v91, v34, v35
    s_waitcnt vmcnt(9)
    v_mfma_f32_32x32x16_bf16 v[20:35], a[24:27], v[100:103], 0
    s_add_u32 s60, s60, 2816
    v_exp_f32 v36, v36
    v_exp_f32 v37, v37
    v_exp_f32 v38, v38
    v_exp_f32 v39, v39
    v_mfma_f32_32x32x8_bf16 v[20:35], a[196:197], v[108:109], v[20:35]
    v_exp_f32 v40, v40
    v_exp_f32 v41, v41
    v_exp_f32 v42, v42
    v_exp_f32 v43, v43
    v_cvt_pk_bf16_f32 v92, v36, v37
    v_cvt_pk_bf16_f32 v93, v38, v39
    v_mfma_f32_32x32x16_bf16 v[52:67], a[20:23], v[88:91], v[52:67]
    s_add_u32 s46, s46, 8192
    v_cvt_pk_bf16_f32 v94, v40, v41
    v_cvt_pk_bf16_f32 v95, v42, v43
    v_exp_f32 v44, v44
    v_exp_f32 v45, v45
    v_exp_f32 v46, v46
    v_exp_f32 v47, v47
    v_mfma_f32_32x32x16_bf16 v[68:83], a[16:19], v[92:95], v[68:83]
    buffer_store_dwordx4 v[164:167], v1, s[4:7], s70 offen offset:1024 sc1
    v_exp_f32 v48, v48
    v_exp_f32 v49, v49
    v_exp_f32 v50, v50
    v_exp_f32 v51, v51
    v_cvt_pk_bf16_f32 v96, v44, v45
    v_cvt_pk_bf16_f32 v97, v46, v47
    v_cvt_pk_bf16_f32 v98, v48, v49
    v_cvt_pk_bf16_f32 v99, v50, v51
    v_mfma_f32_32x32x16_bf16 v[36:51], a[24:27], v[104:107], 0
    buffer_load_dwordx4 a[60:63], v116, s[4:7], s60 offen sc1
    v_exp_f32 v20, v20
    v_exp_f32 v21, v21
    v_exp_f32 v22, v22
    v_exp_f32 v23, v23
    v_mfma_f32_32x32x8_bf16 v[36:51], a[196:197], v[110:111], v[36:51]
    buffer_load_dword a202, v117, s[4:7], s60 offen offset:1024 sc1
    v_exp_f32 v24, v24
    v_exp_f32 v25, v25
    v_exp_f32 v26, v26
    v_exp_f32 v27, v27
    v_cvt_pk_bf16_f32 v84, v20, v21
    v_cvt_pk_bf16_f32 v85, v22, v23
    v_mfma_f32_32x32x16_bf16 v[68:83], a[20:23], v[96:99], v[68:83]
    buffer_load_dwordx4 a[64:67], v118, s[4:7], s60 offen offset:1280 sc1
    v_cvt_pk_bf16_f32 v86, v24, v25
    v_cvt_pk_bf16_f32 v87, v26, v27
    v_exp_f32 v28, v28
    v_exp_f32 v29, v29
    v_exp_f32 v30, v30
    v_exp_f32 v31, v31
    v_mfma_f32_32x32x16_bf16 v[52:67], a[28:31], v[84:87], v[52:67]
    buffer_load_dwordx4 a[68:71], v118, s[4:7], s60 offen offset:2048 sc1
    v_exp_f32 v32, v32
    v_exp_f32 v33, v33
    v_exp_f32 v34, v34
    v_exp_f32 v35, v35
    v_cvt_pk_bf16_f32 v88, v28, v29
    v_cvt_pk_bf16_f32 v89, v30, v31
    v_cvt_pk_bf16_f32 v90, v32, v33
    v_cvt_pk_bf16_f32 v91, v34, v35
    s_waitcnt vmcnt(10)
    v_mfma_f32_32x32x16_bf16 v[20:35], a[36:39], v[100:103], 0
    s_add_u32 s60, s60, 2816
    v_exp_f32 v36, v36
    v_exp_f32 v37, v37
    v_exp_f32 v38, v38
    v_exp_f32 v39, v39
    v_mfma_f32_32x32x8_bf16 v[20:35], a[198:199], v[108:109], v[20:35]
    v_exp_f32 v40, v40
    v_exp_f32 v41, v41
    v_exp_f32 v42, v42
    v_exp_f32 v43, v43
    v_cvt_pk_bf16_f32 v92, v36, v37
    v_cvt_pk_bf16_f32 v93, v38, v39
    v_mfma_f32_32x32x16_bf16 v[52:67], a[32:35], v[88:91], v[52:67]
    s_mul_i32 s47, s21, 1703936
    v_cvt_pk_bf16_f32 v94, v40, v41
    v_cvt_pk_bf16_f32 v95, v42, v43
    v_exp_f32 v44, v44
    v_exp_f32 v45, v45
    v_exp_f32 v46, v46
    v_exp_f32 v47, v47
    v_mfma_f32_32x32x16_bf16 v[68:83], a[28:31], v[92:95], v[68:83]
    buffer_store_dwordx4 v[168:171], v1, s[4:7], s70 offen offset:2048 sc1
    v_exp_f32 v48, v48
    v_exp_f32 v49, v49
    v_exp_f32 v50, v50
    v_exp_f32 v51, v51
    v_cvt_pk_bf16_f32 v96, v44, v45
    v_cvt_pk_bf16_f32 v97, v46, v47
    v_cvt_pk_bf16_f32 v98, v48, v49
    v_cvt_pk_bf16_f32 v99, v50, v51
    v_mfma_f32_32x32x16_bf16 v[36:51], a[36:39], v[104:107], 0
    buffer_load_dwordx4 a[72:75], v116, s[4:7], s60 offen sc1
    v_exp_f32 v20, v20
    v_exp_f32 v21, v21
    v_exp_f32 v22, v22
    v_exp_f32 v23, v23
    v_mfma_f32_32x32x8_bf16 v[36:51], a[198:199], v[110:111], v[36:51]
    buffer_load_dword a204, v117, s[4:7], s60 offen offset:1024 sc1
    v_exp_f32 v24, v24
    v_exp_f32 v25, v25
    v_exp_f32 v26, v26
    v_exp_f32 v27, v27
    v_cvt_pk_bf16_f32 v84, v20, v21
    v_cvt_pk_bf16_f32 v85, v22, v23
    v_mfma_f32_32x32x16_bf16 v[68:83], a[32:35], v[96:99], v[68:83]
    buffer_load_dwordx4 a[76:79], v118, s[4:7], s60 offen offset:1280 sc1
    v_cvt_pk_bf16_f32 v86, v24, v25
    v_cvt_pk_bf16_f32 v87, v26, v27
    v_exp_f32 v28, v28
    v_exp_f32 v29, v29
    v_exp_f32 v30, v30
    v_exp_f32 v31, v31
    v_mfma_f32_32x32x16_bf16 v[52:67], a[40:43], v[84:87], v[52:67]
    buffer_load_dwordx4 a[80:83], v118, s[4:7], s60 offen offset:2048 sc1
    v_exp_f32 v32, v32
    v_exp_f32 v33, v33
    v_exp_f32 v34, v34
    v_exp_f32 v35, v35
    v_cvt_pk_bf16_f32 v88, v28, v29
    v_cvt_pk_bf16_f32 v89, v30, v31
    v_cvt_pk_bf16_f32 v90, v32, v33
    v_cvt_pk_bf16_f32 v91, v34, v35
    s_waitcnt vmcnt(10)
    v_mfma_f32_32x32x16_bf16 v[20:35], a[48:51], v[100:103], 0
    s_add_u32 s60, s60, 2816
    v_exp_f32 v36, v36
    v_exp_f32 v37, v37
    v_exp_f32 v38, v38
    v_exp_f32 v39, v39
    v_mfma_f32_32x32x8_bf16 v[20:35], a[200:201], v[108:109], v[20:35]
    v_exp_f32 v40, v40
    v_exp_f32 v41, v41
    v_exp_f32 v42, v42
    v_exp_f32 v43, v43
    v_cvt_pk_bf16_f32 v92, v36, v37
    v_cvt_pk_bf16_f32 v93, v38, v39
    v_mfma_f32_32x32x16_bf16 v[52:67], a[44:47], v[88:91], v[52:67]
    s_mul_i32 s36, s22, 8192
    v_cvt_pk_bf16_f32 v94, v40, v41
    v_cvt_pk_bf16_f32 v95, v42, v43
    v_exp_f32 v44, v44
    v_exp_f32 v45, v45
    v_exp_f32 v46, v46
    v_exp_f32 v47, v47
    v_mfma_f32_32x32x16_bf16 v[68:83], a[40:43], v[92:95], v[68:83]
    buffer_store_dwordx4 v[172:175], v1, s[4:7], s70 offen offset:3072 sc1
    v_exp_f32 v48, v48
    v_exp_f32 v49, v49
    v_exp_f32 v50, v50
    v_exp_f32 v51, v51
    v_cvt_pk_bf16_f32 v96, v44, v45
    v_cvt_pk_bf16_f32 v97, v46, v47
    v_cvt_pk_bf16_f32 v98, v48, v49
    v_cvt_pk_bf16_f32 v99, v50, v51
    v_mfma_f32_32x32x16_bf16 v[36:51], a[48:51], v[104:107], 0
    buffer_load_dwordx4 a[84:87], v116, s[4:7], s60 offen sc1
    v_exp_f32 v20, v20
    v_exp_f32 v21, v21
    v_exp_f32 v22, v22
    v_exp_f32 v23, v23
    v_mfma_f32_32x32x8_bf16 v[36:51], a[200:201], v[110:111], v[36:51]
    buffer_load_dword a206, v117, s[4:7], s60 offen offset:1024 sc1
    v_exp_f32 v24, v24
    v_exp_f32 v25, v25
    v_exp_f32 v26, v26
    v_exp_f32 v27, v27
    v_cvt_pk_bf16_f32 v84, v20, v21
    v_cvt_pk_bf16_f32 v85, v22, v23
    v_mfma_f32_32x32x16_bf16 v[68:83], a[44:47], v[96:99], v[68:83]
    buffer_load_dwordx4 a[88:91], v118, s[4:7], s60 offen offset:1280 sc1
    v_cvt_pk_bf16_f32 v86, v24, v25
    v_cvt_pk_bf16_f32 v87, v26, v27
    v_exp_f32 v28, v28
    v_exp_f32 v29, v29
    v_exp_f32 v30, v30
    v_exp_f32 v31, v31
    v_mfma_f32_32x32x16_bf16 v[52:67], a[52:55], v[84:87], v[52:67]
    buffer_load_dwordx4 a[92:95], v118, s[4:7], s60 offen offset:2048 sc1
    v_exp_f32 v32, v32
    v_exp_f32 v33, v33
    v_exp_f32 v34, v34
    v_exp_f32 v35, v35
    v_cvt_pk_bf16_f32 v88, v28, v29
    v_cvt_pk_bf16_f32 v89, v30, v31
    v_cvt_pk_bf16_f32 v90, v32, v33
    v_cvt_pk_bf16_f32 v91, v34, v35
    s_waitcnt vmcnt(10)
    v_mfma_f32_32x32x16_bf16 v[20:35], a[60:63], v[100:103], 0
    s_add_u32 s60, s60, 2816
    v_exp_f32 v36, v36
    v_exp_f32 v37, v37
    v_exp_f32 v38, v38
    v_exp_f32 v39, v39
    v_mfma_f32_32x32x8_bf16 v[20:35], a[202:203], v[108:109], v[20:35]
    v_exp_f32 v40, v40
    v_exp_f32 v41, v41
    v_exp_f32 v42, v42
    v_exp_f32 v43, v43
    v_cvt_pk_bf16_f32 v92, v36, v37
    v_cvt_pk_bf16_f32 v93, v38, v39
    v_mfma_f32_32x32x16_bf16 v[52:67], a[56:59], v[88:91], v[52:67]
    s_add_u32 s47, s47, s36
    v_cvt_pk_bf16_f32 v94, v40, v41
    v_cvt_pk_bf16_f32 v95, v42, v43
    v_exp_f32 v44, v44
    v_exp_f32 v45, v45
    v_exp_f32 v46, v46
    v_exp_f32 v47, v47
    v_mfma_f32_32x32x16_bf16 v[68:83], a[52:55], v[92:95], v[68:83]
    buffer_store_dwordx4 v[176:179], v1, s[4:7], s72 offen offset:0 sc1
    v_exp_f32 v48, v48
    v_exp_f32 v49, v49
    v_exp_f32 v50, v50
    v_exp_f32 v51, v51
    v_cvt_pk_bf16_f32 v96, v44, v45
    v_cvt_pk_bf16_f32 v97, v46, v47
    v_cvt_pk_bf16_f32 v98, v48, v49
    v_cvt_pk_bf16_f32 v99, v50, v51
    v_mfma_f32_32x32x16_bf16 v[36:51], a[60:63], v[104:107], 0
    buffer_load_dwordx4 a[96:99], v116, s[4:7], s60 offen sc1
    v_exp_f32 v20, v20
    v_exp_f32 v21, v21
    v_exp_f32 v22, v22
    v_exp_f32 v23, v23
    v_mfma_f32_32x32x8_bf16 v[36:51], a[202:203], v[110:111], v[36:51]
    buffer_load_dword a208, v117, s[4:7], s60 offen offset:1024 sc1
    v_exp_f32 v24, v24
    v_exp_f32 v25, v25
    v_exp_f32 v26, v26
    v_exp_f32 v27, v27
    v_cvt_pk_bf16_f32 v84, v20, v21
    v_cvt_pk_bf16_f32 v85, v22, v23
    v_mfma_f32_32x32x16_bf16 v[68:83], a[56:59], v[96:99], v[68:83]
    buffer_load_dwordx4 a[100:103], v118, s[4:7], s60 offen offset:1280 sc1
    v_cvt_pk_bf16_f32 v86, v24, v25
    v_cvt_pk_bf16_f32 v87, v26, v27
    v_exp_f32 v28, v28
    v_exp_f32 v29, v29
    v_exp_f32 v30, v30
    v_exp_f32 v31, v31
    v_mfma_f32_32x32x16_bf16 v[52:67], a[64:67], v[84:87], v[52:67]
    buffer_load_dwordx4 a[104:107], v118, s[4:7], s60 offen offset:2048 sc1
    v_exp_f32 v32, v32
    v_exp_f32 v33, v33
    v_exp_f32 v34, v34
    v_exp_f32 v35, v35
    v_cvt_pk_bf16_f32 v88, v28, v29
    v_cvt_pk_bf16_f32 v89, v30, v31
    v_cvt_pk_bf16_f32 v90, v32, v33
    v_cvt_pk_bf16_f32 v91, v34, v35
    s_waitcnt vmcnt(10)
    v_mfma_f32_32x32x16_bf16 v[20:35], a[72:75], v[100:103], 0
    s_add_u32 s60, s60, 2816
    v_exp_f32 v36, v36
    v_exp_f32 v37, v37
    v_exp_f32 v38, v38
    v_exp_f32 v39, v39
    v_mfma_f32_32x32x8_bf16 v[20:35], a[204:205], v[108:109], v[20:35]
    v_exp_f32 v40, v40
    v_exp_f32 v41, v41
    v_exp_f32 v42, v42
    v_exp_f32 v43, v43
    v_cvt_pk_bf16_f32 v92, v36, v37
    v_cvt_pk_bf16_f32 v93, v38, v39
    v_mfma_f32_32x32x16_bf16 v[52:67], a[68:71], v[88:91], v[52:67]
    s_mul_i32 s36, s20, 2048
    v_cvt_pk_bf16_f32 v94, v40, v41
    v_cvt_pk_bf16_f32 v95, v42, v43
    v_exp_f32 v44, v44
    v_exp_f32 v45, v45
    v_exp_f32 v46, v46
    v_exp_f32 v47, v47
    v_mfma_f32_32x32x16_bf16 v[68:83], a[64:67], v[92:95], v[68:83]
    buffer_store_dwordx4 v[180:183], v1, s[4:7], s69 offen offset:1024 sc1
    v_exp_f32 v48, v48
    v_exp_f32 v49, v49
    v_exp_f32 v50, v50
    v_exp_f32 v51, v51
    v_cvt_pk_bf16_f32 v96, v44, v45
    v_cvt_pk_bf16_f32 v97, v46, v47
    v_cvt_pk_bf16_f32 v98, v48, v49
    v_cvt_pk_bf16_f32 v99, v50, v51
    v_mfma_f32_32x32x16_bf16 v[36:51], a[72:75], v[104:107], 0
    buffer_load_dwordx4 a[108:111], v116, s[4:7], s60 offen sc1
    v_exp_f32 v20, v20
    v_exp_f32 v21, v21
    v_exp_f32 v22, v22
    v_exp_f32 v23, v23
    v_mfma_f32_32x32x8_bf16 v[36:51], a[204:205], v[110:111], v[36:51]
    buffer_load_dword a210, v117, s[4:7], s60 offen offset:1024 sc1
    v_exp_f32 v24, v24
    v_exp_f32 v25, v25
    v_exp_f32 v26, v26
    v_exp_f32 v27, v27
    v_cvt_pk_bf16_f32 v84, v20, v21
    v_cvt_pk_bf16_f32 v85, v22, v23
    v_mfma_f32_32x32x16_bf16 v[68:83], a[68:71], v[96:99], v[68:83]
    buffer_load_dwordx4 a[112:115], v118, s[4:7], s60 offen offset:1280 sc1
    v_cvt_pk_bf16_f32 v86, v24, v25
    v_cvt_pk_bf16_f32 v87, v26, v27
    v_exp_f32 v28, v28
    v_exp_f32 v29, v29
    v_exp_f32 v30, v30
    v_exp_f32 v31, v31
    v_mfma_f32_32x32x16_bf16 v[52:67], a[76:79], v[84:87], v[52:67]
    buffer_load_dwordx4 a[116:119], v118, s[4:7], s60 offen offset:2048 sc1
    v_exp_f32 v32, v32
    v_exp_f32 v33, v33
    v_exp_f32 v34, v34
    v_exp_f32 v35, v35
    v_cvt_pk_bf16_f32 v88, v28, v29
    v_cvt_pk_bf16_f32 v89, v30, v31
    v_cvt_pk_bf16_f32 v90, v32, v33
    v_cvt_pk_bf16_f32 v91, v34, v35
    s_waitcnt vmcnt(10)
    v_mfma_f32_32x32x16_bf16 v[20:35], a[84:87], v[100:103], 0
    s_add_u32 s60, s60, 2816
    v_exp_f32 v36, v36
    v_exp_f32 v37, v37
    v_exp_f32 v38, v38
    v_exp_f32 v39, v39
    v_mfma_f32_32x32x8_bf16 v[20:35], a[206:207], v[108:109], v[20:35]
    v_exp_f32 v40, v40
    v_exp_f32 v41, v41
    v_exp_f32 v42, v42
    v_exp_f32 v43, v43
    v_cvt_pk_bf16_f32 v92, v36, v37
    v_cvt_pk_bf16_f32 v93, v38, v39
    v_mfma_f32_32x32x16_bf16 v[52:67], a[80:83], v[88:91], v[52:67]
    s_add_u32 s47, s47, s36
    v_cvt_pk_bf16_f32 v94, v40, v41
    v_cvt_pk_bf16_f32 v95, v42, v43
    v_exp_f32 v44, v44
    v_exp_f32 v45, v45
    v_exp_f32 v46, v46
    v_exp_f32 v47, v47
    v_mfma_f32_32x32x16_bf16 v[68:83], a[76:79], v[92:95], v[68:83]
    buffer_store_dwordx4 v[184:187], v1, s[4:7], s69 offen offset:2048 sc1
    v_exp_f32 v48, v48
    v_exp_f32 v49, v49
    v_exp_f32 v50, v50
    v_exp_f32 v51, v51
    v_cvt_pk_bf16_f32 v96, v44, v45
    v_cvt_pk_bf16_f32 v97, v46, v47
    v_cvt_pk_bf16_f32 v98, v48, v49
    v_cvt_pk_bf16_f32 v99, v50, v51
    v_mfma_f32_32x32x16_bf16 v[36:51], a[84:87], v[104:107], 0
    buffer_load_dwordx4 a[120:123], v116, s[4:7], s60 offen sc1
    v_exp_f32 v20, v20
    v_exp_f32 v21, v21
    v_exp_f32 v22, v22
    v_exp_f32 v23, v23
    v_mfma_f32_32x32x8_bf16 v[36:51], a[206:207], v[110:111], v[36:51]
    buffer_load_dword a212, v117, s[4:7], s60 offen offset:1024 sc1
    v_exp_f32 v24, v24
    v_exp_f32 v25, v25
    v_exp_f32 v26, v26
    v_exp_f32 v27, v27
    v_cvt_pk_bf16_f32 v84, v20, v21
    v_cvt_pk_bf16_f32 v85, v22, v23
    v_mfma_f32_32x32x16_bf16 v[68:83], a[80:83], v[96:99], v[68:83]
    buffer_load_dwordx4 a[124:127], v118, s[4:7], s60 offen offset:1280 sc1
    v_cvt_pk_bf16_f32 v86, v24, v25
    v_cvt_pk_bf16_f32 v87, v26, v27
    v_exp_f32 v28, v28
    v_exp_f32 v29, v29
    v_exp_f32 v30, v30
    v_exp_f32 v31, v31
    v_mfma_f32_32x32x16_bf16 v[52:67], a[88:91], v[84:87], v[52:67]
    buffer_load_dwordx4 a[128:131], v118, s[4:7], s60 offen offset:2048 sc1
    v_exp_f32 v32, v32
    v_exp_f32 v33, v33
    v_exp_f32 v34, v34
    v_exp_f32 v35, v35
    v_cvt_pk_bf16_f32 v88, v28, v29
    v_cvt_pk_bf16_f32 v89, v30, v31
    v_cvt_pk_bf16_f32 v90, v32, v33
    v_cvt_pk_bf16_f32 v91, v34, v35
    s_waitcnt vmcnt(10)
    v_mfma_f32_32x32x16_bf16 v[20:35], a[96:99], v[100:103], 0
    s_add_u32 s60, s60, 2816
    v_exp_f32 v36, v36
    v_exp_f32 v37, v37
    v_exp_f32 v38, v38
    v_exp_f32 v39, v39
    v_mfma_f32_32x32x8_bf16 v[20:35], a[208:209], v[108:109], v[20:35]
    v_exp_f32 v40, v40
    v_exp_f32 v41, v41
    v_exp_f32 v42, v42
    v_exp_f32 v43, v43
    v_cvt_pk_bf16_f32 v92, v36, v37
    v_cvt_pk_bf16_f32 v93, v38, v39
    v_mfma_f32_32x32x16_bf16 v[52:67], a[92:95], v[88:91], v[52:67]
    s_add_u32 s47, s47, 7274496
    v_cvt_pk_bf16_f32 v94, v40, v41
    v_cvt_pk_bf16_f32 v95, v42, v43
    v_exp_f32 v44, v44
    v_exp_f32 v45, v45
    v_exp_f32 v46, v46
    v_exp_f32 v47, v47
    v_mfma_f32_32x32x16_bf16 v[68:83], a[88:91], v[92:95], v[68:83]
    buffer_store_dwordx4 v[188:191], v220, s[4:7], s71 offen sc1
    v_exp_f32 v48, v48
    v_exp_f32 v49, v49
    v_exp_f32 v50, v50
    v_exp_f32 v51, v51
    v_cvt_pk_bf16_f32 v96, v44, v45
    v_cvt_pk_bf16_f32 v97, v46, v47
    v_cvt_pk_bf16_f32 v98, v48, v49
    v_cvt_pk_bf16_f32 v99, v50, v51
    v_mfma_f32_32x32x16_bf16 v[36:51], a[96:99], v[104:107], 0
    buffer_load_dwordx4 a[132:135], v116, s[4:7], s60 offen sc1
    v_exp_f32 v20, v20
    v_exp_f32 v21, v21
    v_exp_f32 v22, v22
    v_exp_f32 v23, v23
    v_mfma_f32_32x32x8_bf16 v[36:51], a[208:209], v[110:111], v[36:51]
    buffer_load_dword a214, v117, s[4:7], s60 offen offset:1024 sc1
    v_exp_f32 v24, v24
    v_exp_f32 v25, v25
    v_exp_f32 v26, v26
    v_exp_f32 v27, v27
    v_cvt_pk_bf16_f32 v84, v20, v21
    v_cvt_pk_bf16_f32 v85, v22, v23
    v_mfma_f32_32x32x16_bf16 v[68:83], a[92:95], v[96:99], v[68:83]
    buffer_load_dwordx4 a[136:139], v118, s[4:7], s60 offen offset:1280 sc1
    v_cvt_pk_bf16_f32 v86, v24, v25
    v_cvt_pk_bf16_f32 v87, v26, v27
    v_exp_f32 v28, v28
    v_exp_f32 v29, v29
    v_exp_f32 v30, v30
    v_exp_f32 v31, v31
    v_mfma_f32_32x32x16_bf16 v[52:67], a[100:103], v[84:87], v[52:67]
    buffer_load_dwordx4 a[140:143], v118, s[4:7], s60 offen offset:2048 sc1
    v_exp_f32 v32, v32
    v_exp_f32 v33, v33
    v_exp_f32 v34, v34
    v_exp_f32 v35, v35
    v_cvt_pk_bf16_f32 v88, v28, v29
    v_cvt_pk_bf16_f32 v89, v30, v31
    v_cvt_pk_bf16_f32 v90, v32, v33
    v_cvt_pk_bf16_f32 v91, v34, v35
    s_waitcnt vmcnt(10)
    v_mfma_f32_32x32x16_bf16 v[20:35], a[108:111], v[100:103], 0
    s_add_u32 s60, s60, 2816
    v_exp_f32 v36, v36
    v_exp_f32 v37, v37
    v_exp_f32 v38, v38
    v_exp_f32 v39, v39
    v_mfma_f32_32x32x8_bf16 v[20:35], a[210:211], v[108:109], v[20:35]
    v_exp_f32 v40, v40
    v_exp_f32 v41, v41
    v_exp_f32 v42, v42
    v_exp_f32 v43, v43
    v_cvt_pk_bf16_f32 v92, v36, v37
    v_cvt_pk_bf16_f32 v93, v38, v39
    v_mfma_f32_32x32x16_bf16 v[52:67], a[104:107], v[88:91], v[52:67]
    s_cmp_eq_u32 s28, 0
    s_cselect_b32 s47, s47, 1073741824
    v_cvt_pk_bf16_f32 v94, v40, v41
    v_cvt_pk_bf16_f32 v95, v42, v43
    v_exp_f32 v44, v44
    v_exp_f32 v45, v45
    v_exp_f32 v46, v46
    v_exp_f32 v47, v47
    v_mfma_f32_32x32x16_bf16 v[68:83], a[100:103], v[92:95], v[68:83]
    v_lshrrev_b32 v6, 1, v0
    v_exp_f32 v48, v48
    v_exp_f32 v49, v49
    v_exp_f32 v50, v50
    v_exp_f32 v51, v51
    v_cvt_pk_bf16_f32 v96, v44, v45
    v_cvt_pk_bf16_f32 v97, v46, v47
    v_cvt_pk_bf16_f32 v98, v48, v49
    v_cvt_pk_bf16_f32 v99, v50, v51
    v_mfma_f32_32x32x16_bf16 v[36:51], a[108:111], v[104:107], 0
    buffer_load_dwordx4 a[144:147], v116, s[4:7], s60 offen sc1
    v_exp_f32 v20, v20
    v_exp_f32 v21, v21
    v_exp_f32 v22, v22
    v_exp_f32 v23, v23
    v_mfma_f32_32x32x8_bf16 v[36:51], a[210:211], v[110:111], v[36:51]
    buffer_load_dword a216, v117, s[4:7], s60 offen offset:1024 sc1
    v_exp_f32 v24, v24
    v_exp_f32 v25, v25
    v_exp_f32 v26, v26
    v_exp_f32 v27, v27
    v_cvt_pk_bf16_f32 v84, v20, v21
    v_cvt_pk_bf16_f32 v85, v22, v23
    v_mfma_f32_32x32x16_bf16 v[68:83], a[104:107], v[96:99], v[68:83]
    buffer_load_dwordx4 a[148:151], v118, s[4:7], s60 offen offset:1280 sc1
    v_cvt_pk_bf16_f32 v86, v24, v25
    v_cvt_pk_bf16_f32 v87, v26, v27
    v_exp_f32 v28, v28
    v_exp_f32 v29, v29
    v_exp_f32 v30, v30
    v_exp_f32 v31, v31
    v_mfma_f32_32x32x16_bf16 v[52:67], a[112:115], v[84:87], v[52:67]
    buffer_load_dwordx4 a[152:155], v118, s[4:7], s60 offen offset:2048 sc1
    v_exp_f32 v32, v32
    v_exp_f32 v33, v33
    v_exp_f32 v34, v34
    v_exp_f32 v35, v35
    v_cvt_pk_bf16_f32 v88, v28, v29
    v_cvt_pk_bf16_f32 v89, v30, v31
    v_cvt_pk_bf16_f32 v90, v32, v33
    v_cvt_pk_bf16_f32 v91, v34, v35
    s_waitcnt vmcnt(9)
    v_mfma_f32_32x32x16_bf16 v[20:35], a[120:123], v[100:103], 0
    s_add_u32 s60, s60, 2816
    v_exp_f32 v36, v36
    v_exp_f32 v37, v37
    v_exp_f32 v38, v38
    v_exp_f32 v39, v39
    v_mfma_f32_32x32x8_bf16 v[20:35], a[212:213], v[108:109], v[20:35]
    v_exp_f32 v40, v40
    v_exp_f32 v41, v41
    v_exp_f32 v42, v42
    v_exp_f32 v43, v43
    v_cvt_pk_bf16_f32 v92, v36, v37
    v_cvt_pk_bf16_f32 v93, v38, v39
    v_mfma_f32_32x32x16_bf16 v[52:67], a[116:119], v[88:91], v[52:67]
    v_lshlrev_b32 v6, 6, v6
    v_cvt_pk_bf16_f32 v94, v40, v41
    v_cvt_pk_bf16_f32 v95, v42, v43
    v_exp_f32 v44, v44
    v_exp_f32 v45, v45
    v_exp_f32 v46, v46
    v_exp_f32 v47, v47
    v_mfma_f32_32x32x16_bf16 v[68:83], a[112:115], v[92:95], v[68:83]
    v_and_b32 v7, 1, v0
    v_exp_f32 v48, v48
    v_exp_f32 v49, v49
    v_exp_f32 v50, v50
    v_exp_f32 v51, v51
    v_cvt_pk_bf16_f32 v96, v44, v45
    v_cvt_pk_bf16_f32 v97, v46, v47
    v_cvt_pk_bf16_f32 v98, v48, v49
    v_cvt_pk_bf16_f32 v99, v50, v51
    v_mfma_f32_32x32x16_bf16 v[36:51], a[120:123], v[104:107], 0
    buffer_load_dwordx4 a[156:159], v116, s[4:7], s60 offen sc1
    v_exp_f32 v20, v20
    v_exp_f32 v21, v21
    v_exp_f32 v22, v22
    v_exp_f32 v23, v23
    v_mfma_f32_32x32x8_bf16 v[36:51], a[212:213], v[110:111], v[36:51]
    buffer_load_dword a218, v117, s[4:7], s60 offen offset:1024 sc1
    v_exp_f32 v24, v24
    v_exp_f32 v25, v25
    v_exp_f32 v26, v26
    v_exp_f32 v27, v27
    v_cvt_pk_bf16_f32 v84, v20, v21
    v_cvt_pk_bf16_f32 v85, v22, v23
    v_mfma_f32_32x32x16_bf16 v[68:83], a[116:119], v[96:99], v[68:83]
    buffer_load_dwordx4 a[160:163], v118, s[4:7], s60 offen offset:1280 sc1
    v_cvt_pk_bf16_f32 v86, v24, v25
    v_cvt_pk_bf16_f32 v87, v26, v27
    v_exp_f32 v28, v28
    v_exp_f32 v29, v29
    v_exp_f32 v30, v30
    v_exp_f32 v31, v31
    v_mfma_f32_32x32x16_bf16 v[52:67], a[124:127], v[84:87], v[52:67]
    buffer_load_dwordx4 a[164:167], v118, s[4:7], s60 offen offset:2048 sc1
    v_exp_f32 v32, v32
    v_exp_f32 v33, v33
    v_exp_f32 v34, v34
    v_exp_f32 v35, v35
    v_cvt_pk_bf16_f32 v88, v28, v29
    v_cvt_pk_bf16_f32 v89, v30, v31
    v_cvt_pk_bf16_f32 v90, v32, v33
    v_cvt_pk_bf16_f32 v91, v34, v35
    s_waitcnt vmcnt(8)
    v_mfma_f32_32x32x16_bf16 v[20:35], a[132:135], v[100:103], 0
    s_add_u32 s60, s60, 2816
    v_exp_f32 v36, v36
    v_exp_f32 v37, v37
    v_exp_f32 v38, v38
    v_exp_f32 v39, v39
    v_mfma_f32_32x32x8_bf16 v[20:35], a[214:215], v[108:109], v[20:35]
    v_exp_f32 v40, v40
    v_exp_f32 v41, v41
    v_exp_f32 v42, v42
    v_exp_f32 v43, v43
    v_cvt_pk_bf16_f32 v92, v36, v37
    v_cvt_pk_bf16_f32 v93, v38, v39
    v_mfma_f32_32x32x16_bf16 v[52:67], a[128:131], v[88:91], v[52:67]
    v_lshl_add_u32 v121, v7, 2, v6
    v_cvt_pk_bf16_f32 v94, v40, v41
    v_cvt_pk_bf16_f32 v95, v42, v43
    v_exp_f32 v44, v44
    v_exp_f32 v45, v45
    v_exp_f32 v46, v46
    v_exp_f32 v47, v47
    v_mfma_f32_32x32x16_bf16 v[68:83], a[124:127], v[92:95], v[68:83]
    s_mov_b32 s48, 8192
    v_exp_f32 v48, v48
    v_exp_f32 v49, v49
    v_exp_f32 v50, v50
    v_exp_f32 v51, v51
    v_cvt_pk_bf16_f32 v96, v44, v45
    v_cvt_pk_bf16_f32 v97, v46, v47
    v_cvt_pk_bf16_f32 v98, v48, v49
    v_cvt_pk_bf16_f32 v99, v50, v51
    v_mfma_f32_32x32x16_bf16 v[36:51], a[132:135], v[104:107], 0
    buffer_load_dwordx4 a[168:171], v116, s[4:7], s60 offen sc1
    v_exp_f32 v20, v20
    v_exp_f32 v21, v21
    v_exp_f32 v22, v22
    v_exp_f32 v23, v23
    v_mfma_f32_32x32x8_bf16 v[36:51], a[214:215], v[110:111], v[36:51]
    buffer_load_dword a220, v117, s[4:7], s60 offen offset:1024 sc1
    v_exp_f32 v24, v24
    v_exp_f32 v25, v25
    v_exp_f32 v26, v26
    v_exp_f32 v27, v27
    v_cvt_pk_bf16_f32 v84, v20, v21
    v_cvt_pk_bf16_f32 v85, v22, v23
    v_mfma_f32_32x32x16_bf16 v[68:83], a[128:131], v[96:99], v[68:83]
    buffer_load_dwordx4 a[172:175], v118, s[4:7], s60 offen offset:1280 sc1
    v_cvt_pk_bf16_f32 v86, v24, v25
    v_cvt_pk_bf16_f32 v87, v26, v27
    v_exp_f32 v28, v28
    v_exp_f32 v29, v29
    v_exp_f32 v30, v30
    v_exp_f32 v31, v31
    v_mfma_f32_32x32x16_bf16 v[52:67], a[136:139], v[84:87], v[52:67]
    buffer_load_dwordx4 a[176:179], v118, s[4:7], s60 offen offset:2048 sc1
    v_exp_f32 v32, v32
    v_exp_f32 v33, v33
    v_exp_f32 v34, v34
    v_exp_f32 v35, v35
    v_cvt_pk_bf16_f32 v88, v28, v29
    v_cvt_pk_bf16_f32 v89, v30, v31
    v_cvt_pk_bf16_f32 v90, v32, v33
    v_cvt_pk_bf16_f32 v91, v34, v35
    s_waitcnt vmcnt(8)
    v_mfma_f32_32x32x16_bf16 v[20:35], a[144:147], v[100:103], 0
    s_add_u32 s60, s60, 2816
    v_exp_f32 v36, v36
    v_exp_f32 v37, v37
    v_exp_f32 v38, v38
    v_exp_f32 v39, v39
    v_mfma_f32_32x32x8_bf16 v[20:35], a[216:217], v[108:109], v[20:35]
    v_exp_f32 v40, v40
    v_exp_f32 v41, v41
    v_exp_f32 v42, v42
    v_exp_f32 v43, v43
    v_cvt_pk_bf16_f32 v92, v36, v37
    v_cvt_pk_bf16_f32 v93, v38, v39
    v_mfma_f32_32x32x16_bf16 v[52:67], a[140:143], v[88:91], v[52:67]
    s_mul_i32 s50, s24, 286720
    v_cvt_pk_bf16_f32 v94, v40, v41
    v_cvt_pk_bf16_f32 v95, v42, v43
    v_exp_f32 v44, v44
    v_exp_f32 v45, v45
    v_exp_f32 v46, v46
    v_exp_f32 v47, v47
    v_mfma_f32_32x32x16_bf16 v[68:83], a[136:139], v[92:95], v[68:83]
    s_mul_i32 s54, s20, 71680
    v_exp_f32 v48, v48
    v_exp_f32 v49, v49
    v_exp_f32 v50, v50
    v_exp_f32 v51, v51
    v_cvt_pk_bf16_f32 v96, v44, v45
    v_cvt_pk_bf16_f32 v97, v46, v47
    v_cvt_pk_bf16_f32 v98, v48, v49
    v_cvt_pk_bf16_f32 v99, v50, v51
    v_mfma_f32_32x32x16_bf16 v[36:51], a[144:147], v[104:107], 0
    buffer_load_dwordx4 a[180:183], v116, s[4:7], s60 offen sc1
    v_exp_f32 v20, v20
    v_exp_f32 v21, v21
    v_exp_f32 v22, v22
    v_exp_f32 v23, v23
    v_mfma_f32_32x32x8_bf16 v[36:51], a[216:217], v[110:111], v[36:51]
    buffer_load_dword a222, v117, s[4:7], s60 offen offset:1024 sc1
    v_exp_f32 v24, v24
    v_exp_f32 v25, v25
    v_exp_f32 v26, v26
    v_exp_f32 v27, v27
    v_cvt_pk_bf16_f32 v84, v20, v21
    v_cvt_pk_bf16_f32 v85, v22, v23
    v_mfma_f32_32x32x16_bf16 v[68:83], a[140:143], v[96:99], v[68:83]
    buffer_load_dwordx4 a[184:187], v118, s[4:7], s60 offen offset:1280 sc1
    v_cvt_pk_bf16_f32 v86, v24, v25
    v_cvt_pk_bf16_f32 v87, v26, v27
    v_exp_f32 v28, v28
    v_exp_f32 v29, v29
    v_exp_f32 v30, v30
    v_exp_f32 v31, v31
    v_mfma_f32_32x32x16_bf16 v[52:67], a[148:151], v[84:87], v[52:67]
    buffer_load_dwordx4 a[188:191], v118, s[4:7], s60 offen offset:2048 sc1
    v_exp_f32 v32, v32
    v_exp_f32 v33, v33
    v_exp_f32 v34, v34
    v_exp_f32 v35, v35
    v_cvt_pk_bf16_f32 v88, v28, v29
    v_cvt_pk_bf16_f32 v89, v30, v31
    v_cvt_pk_bf16_f32 v90, v32, v33
    v_cvt_pk_bf16_f32 v91, v34, v35
    s_waitcnt vmcnt(8)
    v_mfma_f32_32x32x16_bf16 v[20:35], a[156:159], v[100:103], 0
    s_add_u32 s60, s60, 2816
    v_exp_f32 v36, v36
    v_exp_f32 v37, v37
    v_exp_f32 v38, v38
    v_exp_f32 v39, v39
    v_mfma_f32_32x32x8_bf16 v[20:35], a[218:219], v[108:109], v[20:35]
    v_exp_f32 v40, v40
    v_exp_f32 v41, v41
    v_exp_f32 v42, v42
    v_exp_f32 v43, v43
    v_cvt_pk_bf16_f32 v92, v36, v37
    v_cvt_pk_bf16_f32 v93, v38, v39
    v_mfma_f32_32x32x16_bf16 v[52:67], a[152:155], v[88:91], v[52:67]
    s_add_u32 s50, s50, s54
    v_cvt_pk_bf16_f32 v94, v40, v41
    v_cvt_pk_bf16_f32 v95, v42, v43
    v_exp_f32 v44, v44
    v_exp_f32 v45, v45
    v_exp_f32 v46, v46
    v_exp_f32 v47, v47
    v_mfma_f32_32x32x16_bf16 v[68:83], a[148:151], v[92:95], v[68:83]
    s_add_u32 s50, s50, 1880064
    v_exp_f32 v48, v48
    v_exp_f32 v49, v49
    v_exp_f32 v50, v50
    v_exp_f32 v51, v51
    v_cvt_pk_bf16_f32 v96, v44, v45
    v_cvt_pk_bf16_f32 v97, v46, v47
    v_cvt_pk_bf16_f32 v98, v48, v49
    v_cvt_pk_bf16_f32 v99, v50, v51
    v_mfma_f32_32x32x16_bf16 v[36:51], a[156:159], v[104:107], 0
    s_mul_i32 s53, s20, 25600
    v_exp_f32 v20, v20
    v_exp_f32 v21, v21
    v_exp_f32 v22, v22
    v_exp_f32 v23, v23
    v_mfma_f32_32x32x8_bf16 v[36:51], a[218:219], v[110:111], v[36:51]
    v_exp_f32 v24, v24
    v_exp_f32 v25, v25
    v_exp_f32 v26, v26
    v_exp_f32 v27, v27
    v_cvt_pk_bf16_f32 v84, v20, v21
    v_cvt_pk_bf16_f32 v85, v22, v23
    v_mfma_f32_32x32x16_bf16 v[68:83], a[152:155], v[96:99], v[68:83]
    s_mul_i32 s52, s24, 102400
    v_cvt_pk_bf16_f32 v86, v24, v25
    v_cvt_pk_bf16_f32 v87, v26, v27
    v_exp_f32 v28, v28
    v_exp_f32 v29, v29
    v_exp_f32 v30, v30
    v_exp_f32 v31, v31
    v_mfma_f32_32x32x16_bf16 v[52:67], a[160:163], v[84:87], v[52:67]
    s_add_u32 s52, s52, s53
    v_exp_f32 v32, v32
    v_exp_f32 v33, v33
    v_exp_f32 v34, v34
    v_exp_f32 v35, v35
    v_cvt_pk_bf16_f32 v88, v28, v29
    v_cvt_pk_bf16_f32 v89, v30, v31
    v_cvt_pk_bf16_f32 v90, v32, v33
    v_cvt_pk_bf16_f32 v91, v34, v35
    s_waitcnt vmcnt(4)
    v_mfma_f32_32x32x16_bf16 v[20:35], a[168:171], v[100:103], 0
    s_add_u32 s52, s52, 1060864
    v_exp_f32 v36, v36
    v_exp_f32 v37, v37
    v_exp_f32 v38, v38
    v_exp_f32 v39, v39
    v_mfma_f32_32x32x8_bf16 v[20:35], a[220:221], v[108:109], v[20:35]
    v_exp_f32 v40, v40
    v_exp_f32 v41, v41
    v_exp_f32 v42, v42
    v_exp_f32 v43, v43
    v_cvt_pk_bf16_f32 v92, v36, v37
    v_cvt_pk_bf16_f32 v93, v38, v39
    v_mfma_f32_32x32x16_bf16 v[52:67], a[164:167], v[88:91], v[52:67]
    s_mul_i32 s51, s26, 143360
    v_cvt_pk_bf16_f32 v94, v40, v41
    v_cvt_pk_bf16_f32 v95, v42, v43
    v_exp_f32 v44, v44
    v_exp_f32 v45, v45
    v_exp_f32 v46, v46
    v_exp_f32 v47, v47
    v_mfma_f32_32x32x16_bf16 v[68:83], a[160:163], v[92:95], v[68:83]
    s_cmp_lg_u32 s28, 0
    s_cbranch_scc1 L_l1skip_25
    s_waitcnt vmcnt(0)
    s_barrier
    s_cmp_lg_u32 s20, 0
    s_cbranch_scc1 L_pfl_22
    v_mov_b32 v5, s75
    s_mov_b64 exec, 1
    buffer_store_dword v5, off, s[4:7], s46 sc1
    s_mov_b64 exec, -1
L_pfl_22:
L_l1skip_25:
    v_exp_f32 v48, v48
    v_exp_f32 v49, v49
    v_exp_f32 v50, v50
    v_exp_f32 v51, v51
    v_cvt_pk_bf16_f32 v96, v44, v45
    v_cvt_pk_bf16_f32 v97, v46, v47
    v_cvt_pk_bf16_f32 v98, v48, v49
    v_cvt_pk_bf16_f32 v99, v50, v51
    v_mfma_f32_32x32x16_bf16 v[36:51], a[168:171], v[104:107], 0
    s_lshr_b32 s36, s22, 4
    v_exp_f32 v20, v20
    v_exp_f32 v21, v21
    v_exp_f32 v22, v22
    v_exp_f32 v23, v23
    v_mfma_f32_32x32x8_bf16 v[36:51], a[220:221], v[110:111], v[36:51]
    v_exp_f32 v24, v24
    v_exp_f32 v25, v25
    v_exp_f32 v26, v26
    v_exp_f32 v27, v27
    v_cvt_pk_bf16_f32 v84, v20, v21
    v_cvt_pk_bf16_f32 v85, v22, v23
    v_mfma_f32_32x32x16_bf16 v[68:83], a[164:167], v[96:99], v[68:83]
    s_mul_i32 s61, s63, 6144
    s_add_u32 s61, s61, 122880
    v_cvt_pk_bf16_f32 v86, v24, v25
    v_cvt_pk_bf16_f32 v87, v26, v27
    v_exp_f32 v28, v28
    v_exp_f32 v29, v29
    v_exp_f32 v30, v30
    v_exp_f32 v31, v31
    v_mfma_f32_32x32x16_bf16 v[52:67], a[172:175], v[84:87], v[52:67]
    v_lshl_add_u32 v114, v0, 4, s61
    s_add_u32 s63, s63, 1
    v_exp_f32 v32, v32
    v_exp_f32 v33, v33
    v_exp_f32 v34, v34
    v_exp_f32 v35, v35
    v_cvt_pk_bf16_f32 v88, v28, v29
    v_cvt_pk_bf16_f32 v89, v30, v31
    v_cvt_pk_bf16_f32 v90, v32, v33
    v_cvt_pk_bf16_f32 v91, v34, v35
    s_waitcnt vmcnt(0)
    v_mfma_f32_32x32x16_bf16 v[20:35], a[180:183], v[100:103], 0
    s_and_b32 s63, s63, 3
    s_mul_i32 s61, s63, 3072
    s_add_u32 s47, s47, 262144
    v_exp_f32 v36, v36
    v_exp_f32 v37, v37
    v_exp_f32 v38, v38
    v_exp_f32 v39, v39
    v_mfma_f32_32x32x8_bf16 v[20:35], a[222:223], v[108:109], v[20:35]
    s_add_u32 s61, s61, 147456
    v_lshl_add_u32 v112, v0, 4, s61
    v_exp_f32 v40, v40
    v_exp_f32 v41, v41
    v_exp_f32 v42, v42
    v_exp_f32 v43, v43
    v_cvt_pk_bf16_f32 v92, v36, v37
    v_cvt_pk_bf16_f32 v93, v38, v39
    v_mfma_f32_32x32x16_bf16 v[52:67], a[176:179], v[88:91], v[52:67]
    v_lshl_add_u32 v113, v0, 3, s61
    buffer_load_dword v5, v121, s[4:7], s47 offen
    v_cvt_pk_bf16_f32 v94, v40, v41
    v_cvt_pk_bf16_f32 v95, v42, v43
    v_exp_f32 v44, v44
    v_exp_f32 v45, v45
    v_exp_f32 v46, v46
    v_exp_f32 v47, v47
    v_mfma_f32_32x32x16_bf16 v[68:83], a[172:175], v[92:95], v[68:83]
    s_and_b32 s36, s36, 1
    v_exp_f32 v48, v48
    v_exp_f32 v49, v49
    v_exp_f32 v50, v50
    v_exp_f32 v51, v51
    v_cvt_pk_bf16_f32 v96, v44, v45
    v_cvt_pk_bf16_f32 v97, v46, v47
    v_cvt_pk_bf16_f32 v98, v48, v49
    v_cvt_pk_bf16_f32 v99, v50, v51
    v_mfma_f32_32x32x16_bf16 v[36:51], a[180:183], v[104:107], 0
    ds_read_b128 v[100:103], v112 offset:0
    v_exp_f32 v20, v20
    v_exp_f32 v21, v21
    v_exp_f32 v22, v22
    v_exp_f32 v23, v23
    v_mfma_f32_32x32x8_bf16 v[36:51], a[222:223], v[110:111], v[36:51]
    ds_read_b64 v[108:109], v113 offset:1024
    v_exp_f32 v24, v24
    v_exp_f32 v25, v25
    v_exp_f32 v26, v26
    v_exp_f32 v27, v27
    v_cvt_pk_bf16_f32 v84, v20, v21
    v_cvt_pk_bf16_f32 v85, v22, v23
    v_mfma_f32_32x32x16_bf16 v[68:83], a[176:179], v[96:99], v[68:83]
    ds_read_b128 v[104:107], v112 offset:1536
    v_cvt_pk_bf16_f32 v86, v24, v25
    v_cvt_pk_bf16_f32 v87, v26, v27
    v_exp_f32 v28, v28
    v_exp_f32 v29, v29
    v_exp_f32 v30, v30
    v_exp_f32 v31, v31
    v_mfma_f32_32x32x16_bf16 v[52:67], a[184:187], v[84:87], v[52:67]
    ds_read_b64 v[110:111], v113 offset:2560
    v_exp_f32 v32, v32
    v_exp_f32 v33, v33
    v_exp_f32 v34, v34
    v_exp_f32 v35, v35
    v_cvt_pk_bf16_f32 v88, v28, v29
    v_cvt_pk_bf16_f32 v89, v30, v31
    v_cvt_pk_bf16_f32 v90, v32, v33
    v_cvt_pk_bf16_f32 v91, v34, v35
    s_waitcnt lgkmcnt(2)
    v_mfma_f32_32x32x16_bf16 v[20:35], a[0:3], v[100:103], 0
    s_mul_i32 s36, s36, 40960
    v_exp_f32 v36, v36
    v_exp_f32 v37, v37
    v_exp_f32 v38, v38
    v_exp_f32 v39, v39
    v_mfma_f32_32x32x8_bf16 v[20:35], a[192:193], v[108:109], v[20:35]
    v_exp_f32 v40, v40
    v_exp_f32 v41, v41
    v_exp_f32 v42, v42
    v_exp_f32 v43, v43
    v_cvt_pk_bf16_f32 v92, v36, v37
    v_cvt_pk_bf16_f32 v93, v38, v39
    v_mfma_f32_32x32x16_bf16 v[52:67], a[188:191], v[88:91], v[52:67]
    s_add_u32 s51, s51, s36
    v_cvt_pk_bf16_f32 v94, v40, v41
    v_cvt_pk_bf16_f32 v95, v42, v43
    v_exp_f32 v44, v44
    v_exp_f32 v45, v45
    v_exp_f32 v46, v46
    v_exp_f32 v47, v47
    v_mfma_f32_32x32x16_bf16 v[68:83], a[184:187], v[92:95], v[68:83]
    s_mul_i32 s36, s20, 10240
    v_exp_f32 v48, v48
    v_exp_f32 v49, v49
    v_exp_f32 v50, v50
    v_exp_f32 v51, v51
    v_cvt_pk_bf16_f32 v96, v44, v45
    v_cvt_pk_bf16_f32 v97, v46, v47
    v_cvt_pk_bf16_f32 v98, v48, v49
    v_cvt_pk_bf16_f32 v99, v50, v51
    s_waitcnt lgkmcnt(0)
    v_mfma_f32_32x32x16_bf16 v[36:51], a[0:3], v[104:107], 0
    ds_write_b128 v114, v[52:55] offset:0
    v_exp_f32 v20, v20
    v_exp_f32 v21, v21
    v_exp_f32 v22, v22
    v_exp_f32 v23, v23
    v_mfma_f32_32x32x8_bf16 v[36:51], a[192:193], v[110:111], v[36:51]
    ds_write_b128 v114, v[56:59] offset:1024
    v_exp_f32 v24, v24
    v_exp_f32 v25, v25
    v_exp_f32 v26, v26
    v_exp_f32 v27, v27
    v_cvt_pk_bf16_f32 v84, v20, v21
    v_cvt_pk_bf16_f32 v85, v22, v23
    v_mfma_f32_32x32x16_bf16 v[68:83], a[188:191], v[96:99], v[68:83]
    ds_write_b128 v114, v[60:63] offset:2048
    v_cvt_pk_bf16_f32 v86, v24, v25
    v_cvt_pk_bf16_f32 v87, v26, v27
    v_exp_f32 v28, v28
    v_exp_f32 v29, v29
    v_exp_f32 v30, v30
    v_exp_f32 v31, v31
    v_mfma_f32_32x32x16_bf16 v[52:67], a[4:7], v[84:87], 0
    s_add_u32 s51, s51, s36
    v_exp_f32 v32, v32
    v_exp_f32 v33, v33
    v_exp_f32 v34, v34
    v_exp_f32 v35, v35
    v_cvt_pk_bf16_f32 v88, v28, v29
    v_cvt_pk_bf16_f32 v89, v30, v31
    v_cvt_pk_bf16_f32 v90, v32, v33
    v_cvt_pk_bf16_f32 v91, v34, v35
    v_mfma_f32_32x32x16_bf16 v[20:35], a[12:15], v[100:103], 0
    ds_write_b128 v114, v[68:71] offset:3072
    v_exp_f32 v36, v36
    v_exp_f32 v37, v37
    v_exp_f32 v38, v38
    v_exp_f32 v39, v39
    v_mfma_f32_32x32x8_bf16 v[20:35], a[194:195], v[108:109], v[20:35]
    ds_write_b128 v114, v[72:75] offset:4096
    v_exp_f32 v40, v40
    v_exp_f32 v41, v41
    v_exp_f32 v42, v42
    v_exp_f32 v43, v43
    v_cvt_pk_bf16_f32 v92, v36, v37
    v_cvt_pk_bf16_f32 v93, v38, v39
    v_mfma_f32_32x32x16_bf16 v[52:67], a[8:11], v[88:91], v[52:67]
    ds_write_b128 v114, v[76:79] offset:5120
    v_cvt_pk_bf16_f32 v94, v40, v41
    v_cvt_pk_bf16_f32 v95, v42, v43
    v_exp_f32 v44, v44
    v_exp_f32 v45, v45
    v_exp_f32 v46, v46
    v_exp_f32 v47, v47
    v_mfma_f32_32x32x16_bf16 v[68:83], a[4:7], v[92:95], 0
    s_add_u32 s51, s51, 4194304
    v_exp_f32 v48, v48
    v_exp_f32 v49, v49
    v_exp_f32 v50, v50
    v_exp_f32 v51, v51
    v_cvt_pk_bf16_f32 v96, v44, v45
    v_cvt_pk_bf16_f32 v97, v46, v47
    v_cvt_pk_bf16_f32 v98, v48, v49
    v_cvt_pk_bf16_f32 v99, v50, v51
    v_mfma_f32_32x32x16_bf16 v[36:51], a[12:15], v[104:107], 0
    s_getpc_b64 s[42:43]
L_pc1:
    v_exp_f32 v20, v20
    v_exp_f32 v21, v21
    v_exp_f32 v22, v22
    v_exp_f32 v23, v23
    v_mfma_f32_32x32x8_bf16 v[36:51], a[194:195], v[110:111], v[36:51]
    s_mul_i32 s36, s22, 4
    v_exp_f32 v24, v24
    v_exp_f32 v25, v25
    v_exp_f32 v26, v26
    v_exp_f32 v27, v27
    v_cvt_pk_bf16_f32 v84, v20, v21
    v_cvt_pk_bf16_f32 v85, v22, v23
    v_mfma_f32_32x32x16_bf16 v[68:83], a[8:11], v[96:99], v[68:83]
    s_add_u32 s36, s36, s20
    v_cvt_pk_bf16_f32 v86, v24, v25
    v_cvt_pk_bf16_f32 v87, v26, v27
    v_exp_f32 v28, v28
    v_exp_f32 v29, v29
    v_exp_f32 v30, v30
    v_exp_f32 v31, v31
    v_mfma_f32_32x32x16_bf16 v[52:67], a[16:19], v[84:87], v[52:67]
    s_and_b32 s36, s36, 15
    v_exp_f32 v32, v32
    v_exp_f32 v33, v33
    v_exp_f32 v34, v34
    v_exp_f32 v35, v35
    v_cvt_pk_bf16_f32 v88, v28, v29
    v_cvt_pk_bf16_f32 v89, v30, v31
    v_cvt_pk_bf16_f32 v90, v32, v33
    v_cvt_pk_bf16_f32 v91, v34, v35
    v_mfma_f32_32x32x16_bf16 v[20:35], a[24:27], v[100:103], 0
    s_lshl_b32 s36, s36, 11
    v_exp_f32 v36, v36
    v_exp_f32 v37, v37
    v_exp_f32 v38, v38
    v_exp_f32 v39, v39
    v_mfma_f32_32x32x8_bf16 v[20:35], a[196:197], v[108:109], v[20:35]
    s_add_u32 s36, s36, L_chain-L_pc1
    v_exp_f32 v40, v40
    v_exp_f32 v41, v41
    v_exp_f32 v42, v42
    v_exp_f32 v43, v43
    v_cvt_pk_bf16_f32 v92, v36, v37
    v_cvt_pk_bf16_f32 v93, v38, v39
    v_mfma_f32_32x32x16_bf16 v[52:67], a[20:23], v[88:91], v[52:67]
    v_add_u32 v115, s36, v121
    v_cvt_pk_bf16_f32 v94, v40, v41
    v_cvt_pk_bf16_f32 v95, v42, v43
    v_exp_f32 v44, v44
    v_exp_f32 v45, v45
    v_exp_f32 v46, v46
    v_exp_f32 v47, v47
    v_mfma_f32_32x32x16_bf16 v[68:83], a[16:19], v[92:95], v[68:83]
    v_min_u32 v115, L_end-L_pc1, v115
    v_exp_f32 v48, v48
    v_exp_f32 v49, v49
    v_exp_f32 v50, v50
    v_exp_f32 v51, v51
    v_cvt_pk_bf16_f32 v96, v44, v45
    v_cvt_pk_bf16_f32 v97, v46, v47
    v_cvt_pk_bf16_f32 v98, v48, v49
    v_cvt_pk_bf16_f32 v99, v50, v51
    v_mfma_f32_32x32x16_bf16 v[36:51], a[24:27], v[104:107], 0
    s_waitcnt lgkmcnt(0)
    s_barrier
    v_exp_f32 v20, v20
    v_exp_f32 v21, v21
    v_exp_f32 v22, v22
    v_exp_f32 v23, v23
    v_mfma_f32_32x32x8_bf16 v[36:51], a[196:197], v[110:111], v[36:51]
    s_mul_i32 s44, s21, 1703936
    v_exp_f32 v24, v24
    v_exp_f32 v25, v25
    v_exp_f32 v26, v26
    v_exp_f32 v27, v27
    v_cvt_pk_bf16_f32 v84, v20, v21
    v_cvt_pk_bf16_f32 v85, v22, v23
    v_mfma_f32_32x32x16_bf16 v[68:83], a[20:23], v[96:99], v[68:83]
    s_and_b32 s36, s23, 3
    v_cvt_pk_bf16_f32 v86, v24, v25
    v_cvt_pk_bf16_f32 v87, v26, v27
    v_exp_f32 v28, v28
    v_exp_f32 v29, v29
    v_exp_f32 v30, v30
    v_exp_f32 v31, v31
    v_mfma_f32_32x32x16_bf16 v[52:67], a[28:31], v[84:87], v[52:67]
    s_mul_i32 s36, s36, 81920
    v_exp_f32 v32, v32
    v_exp_f32 v33, v33
    v_exp_f32 v34, v34
    v_exp_f32 v35, v35
    v_cvt_pk_bf16_f32 v88, v28, v29
    v_cvt_pk_bf16_f32 v89, v30, v31
    v_cvt_pk_bf16_f32 v90, v32, v33
    v_cvt_pk_bf16_f32 v91, v34, v35
    v_mfma_f32_32x32x16_bf16 v[20:35], a[36:39], v[100:103], 0
    s_add_u32 s47, s47, 262144
    v_exp_f32 v36, v36
    v_exp_f32 v37, v37
    v_exp_f32 v38, v38
    v_exp_f32 v39, v39
    v_mfma_f32_32x32x8_bf16 v[20:35], a[198:199], v[108:109], v[20:35]
    s_add_u32 s44, s44, s36
    v_exp_f32 v40, v40
    v_exp_f32 v41, v41
    v_exp_f32 v42, v42
    v_exp_f32 v43, v43
    v_cvt_pk_bf16_f32 v92, v36, v37
    v_cvt_pk_bf16_f32 v93, v38, v39
    v_mfma_f32_32x32x16_bf16 v[52:67], a[32:35], v[88:91], v[52:67]
    buffer_load_dword v5, v121, s[4:7], s47 offen
    v_cvt_pk_bf16_f32 v94, v40, v41
    v_cvt_pk_bf16_f32 v95, v42, v43
    v_exp_f32 v44, v44
    v_exp_f32 v45, v45
    v_exp_f32 v46, v46
    v_exp_f32 v47, v47
    v_mfma_f32_32x32x16_bf16 v[68:83], a[28:31], v[92:95], v[68:83]
    s_lshr_b32 s36, s24, 1
    v_exp_f32 v48, v48
    v_exp_f32 v49, v49
    v_exp_f32 v50, v50
    v_exp_f32 v51, v51
    v_cvt_pk_bf16_f32 v96, v44, v45
    v_cvt_pk_bf16_f32 v97, v46, v47
    v_cvt_pk_bf16_f32 v98, v48, v49
    v_cvt_pk_bf16_f32 v99, v50, v51
    v_mfma_f32_32x32x16_bf16 v[36:51], a[36:39], v[104:107], 0
    s_mul_i32 s36, s36, 5120
    v_exp_f32 v20, v20
    v_exp_f32 v21, v21
    v_exp_f32 v22, v22
    v_exp_f32 v23, v23
    v_mfma_f32_32x32x8_bf16 v[36:51], a[198:199], v[110:111], v[36:51]
    s_add_u32 s44, s44, s36
    v_exp_f32 v24, v24
    v_exp_f32 v25, v25
    v_exp_f32 v26, v26
    v_exp_f32 v27, v27
    v_cvt_pk_bf16_f32 v84, v20, v21
    v_cvt_pk_bf16_f32 v85, v22, v23
    v_mfma_f32_32x32x16_bf16 v[68:83], a[32:35], v[96:99], v[68:83]
    s_add_u32 s44, s44, 7274496
    v_cvt_pk_bf16_f32 v86, v24, v25
    v_cvt_pk_bf16_f32 v87, v26, v27
    v_exp_f32 v28, v28
    v_exp_f32 v29, v29
    v_exp_f32 v30, v30
    v_exp_f32 v31, v31
    v_mfma_f32_32x32x16_bf16 v[52:67], a[40:43], v[84:87], v[52:67]
    s_and_b32 s45, s24, 1
    v_exp_f32 v32, v32
    v_exp_f32 v33, v33
    v_exp_f32 v34, v34
    v_exp_f32 v35, v35
    v_cvt_pk_bf16_f32 v88, v28, v29
    v_cvt_pk_bf16_f32 v89, v30, v31
    v_cvt_pk_bf16_f32 v90, v32, v33
    v_cvt_pk_bf16_f32 v91, v34, v35
    v_mfma_f32_32x32x16_bf16 v[20:35], a[48:51], v[100:103], 0
    s_mul_i32 s45, s45, 8
    v_exp_f32 v36, v36
    v_exp_f32 v37, v37
    v_exp_f32 v38, v38
    v_exp_f32 v39, v39
    v_mfma_f32_32x32x8_bf16 v[20:35], a[200:201], v[108:109], v[20:35]
    s_mul_i32 s36, s20, 256
    v_exp_f32 v40, v40
    v_exp_f32 v41, v41
    v_exp_f32 v42, v42
    v_exp_f32 v43, v43
    v_cvt_pk_bf16_f32 v92, v36, v37
    v_cvt_pk_bf16_f32 v93, v38, v39
    v_mfma_f32_32x32x16_bf16 v[52:67], a[44:47], v[88:91], v[52:67]
    s_add_u32 s45, s45, s36
    v_cvt_pk_bf16_f32 v94, v40, v41
    v_cvt_pk_bf16_f32 v95, v42, v43
    v_exp_f32 v44, v44
    v_exp_f32 v45, v45
    v_exp_f32 v46, v46
    v_exp_f32 v47, v47
    v_mfma_f32_32x32x16_bf16 v[68:83], a[40:43], v[92:95], v[68:83]
    s_add_u32 s45, s45, s44
    v_exp_f32 v48, v48
    v_exp_f32 v49, v49
    v_exp_f32 v50, v50
    v_exp_f32 v51, v51
    v_cvt_pk_bf16_f32 v96, v44, v45
    v_cvt_pk_bf16_f32 v97, v46, v47
    v_cvt_pk_bf16_f32 v98, v48, v49
    v_cvt_pk_bf16_f32 v99, v50, v51
    v_mfma_f32_32x32x16_bf16 v[36:51], a[48:51], v[104:107], 0
    s_add_u32 s45, s45, 2048
    v_exp_f32 v20, v20
    v_exp_f32 v21, v21
    v_exp_f32 v22, v22
    v_exp_f32 v23, v23
    v_mfma_f32_32x32x8_bf16 v[36:51], a[200:201], v[110:111], v[36:51]
    v_bfe_u32 v6, v0, 4, 1
    v_exp_f32 v24, v24
    v_exp_f32 v25, v25
    v_exp_f32 v26, v26
    v_exp_f32 v27, v27
    v_cvt_pk_bf16_f32 v84, v20, v21
    v_cvt_pk_bf16_f32 v85, v22, v23
    v_mfma_f32_32x32x16_bf16 v[68:83], a[44:47], v[96:99], v[68:83]
    v_lshrrev_b32 v119, 5, v0
    v_cvt_pk_bf16_f32 v86, v24, v25
    v_cvt_pk_bf16_f32 v87, v26, v27
    v_exp_f32 v28, v28
    v_exp_f32 v29, v29
    v_exp_f32 v30, v30
    v_exp_f32 v31, v31
    v_mfma_f32_32x32x16_bf16 v[52:67], a[52:55], v[84:87], v[52:67]
    v_mul_u32_u24 v6, 20480, v6
    v_exp_f32 v32, v32
    v_exp_f32 v33, v33
    v_exp_f32 v34, v34
    v_exp_f32 v35, v35
    v_cvt_pk_bf16_f32 v88, v28, v29
    v_cvt_pk_bf16_f32 v89, v30, v31
    v_cvt_pk_bf16_f32 v90, v32, v33
    v_cvt_pk_bf16_f32 v91, v34, v35
    v_mfma_f32_32x32x16_bf16 v[20:35], a[60:63], v[100:103], 0
    v_lshlrev_b32 v120, 4, v3
    v_exp_f32 v36, v36
    v_exp_f32 v37, v37
    v_exp_f32 v38, v38
    v_exp_f32 v39, v39
    v_mfma_f32_32x32x8_bf16 v[20:35], a[202:203], v[108:109], v[20:35]
    v_add3_u32 v120, v120, v6, s45
    v_exp_f32 v40, v40
    v_exp_f32 v41, v41
    v_exp_f32 v42, v42
    v_exp_f32 v43, v43
    v_cvt_pk_bf16_f32 v92, v36, v37
    v_cvt_pk_bf16_f32 v93, v38, v39
    v_mfma_f32_32x32x16_bf16 v[52:67], a[56:59], v[88:91], v[52:67]
    s_and_b32 s45, s24, 1
    v_cvt_pk_bf16_f32 v94, v40, v41
    v_cvt_pk_bf16_f32 v95, v42, v43
    v_exp_f32 v44, v44
    v_exp_f32 v45, v45
    v_exp_f32 v46, v46
    v_exp_f32 v47, v47
    v_mfma_f32_32x32x16_bf16 v[68:83], a[52:55], v[92:95], v[68:83]
    s_mul_i32 s45, s45, 3072
    v_exp_f32 v48, v48
    v_exp_f32 v49, v49
    v_exp_f32 v50, v50
    v_exp_f32 v51, v51
    v_cvt_pk_bf16_f32 v96, v44, v45
    v_cvt_pk_bf16_f32 v97, v46, v47
    v_cvt_pk_bf16_f32 v98, v48, v49
    v_cvt_pk_bf16_f32 v99, v50, v51
    v_mfma_f32_32x32x16_bf16 v[36:51], a[60:63], v[104:107], 0
    s_lshr_b32 s36, s20, 1
    v_exp_f32 v20, v20
    v_exp_f32 v21, v21
    v_exp_f32 v22, v22
    v_exp_f32 v23, v23
    v_mfma_f32_32x32x8_bf16 v[36:51], a[202:203], v[110:111], v[36:51]
    s_mul_i32 s36, s36, 1024
    v_exp_f32 v24, v24
    v_exp_f32 v25, v25
    v_exp_f32 v26, v26
    v_exp_f32 v27, v27
    v_cvt_pk_bf16_f32 v84, v20, v21
    v_cvt_pk_bf16_f32 v85, v22, v23
    v_mfma_f32_32x32x16_bf16 v[68:83], a[56:59], v[96:99], v[68:83]
    s_add_u32 s45, s45, s36
    v_cvt_pk_bf16_f32 v86, v24, v25
    v_cvt_pk_bf16_f32 v87, v26, v27
    v_exp_f32 v28, v28
    v_exp_f32 v29, v29
    v_exp_f32 v30, v30
    v_exp_f32 v31, v31
    v_mfma_f32_32x32x16_bf16 v[52:67], a[64:67], v[84:87], v[52:67]
    s_and_b32 s36, s20, 1
    v_exp_f32 v32, v32
    v_exp_f32 v33, v33
    v_exp_f32 v34, v34
    v_exp_f32 v35, v35
    v_cvt_pk_bf16_f32 v88, v28, v29
    v_cvt_pk_bf16_f32 v89, v30, v31
    v_cvt_pk_bf16_f32 v90, v32, v33
    v_cvt_pk_bf16_f32 v91, v34, v35
    v_mfma_f32_32x32x16_bf16 v[20:35], a[72:75], v[100:103], 0
    s_mul_i32 s36, s36, 512
    v_exp_f32 v36, v36
    v_exp_f32 v37, v37
    v_exp_f32 v38, v38
    v_exp_f32 v39, v39
    v_mfma_f32_32x32x8_bf16 v[20:35], a[204:205], v[108:109], v[20:35]
    s_add_u32 s45, s45, s36
    v_exp_f32 v40, v40
    v_exp_f32 v41, v41
    v_exp_f32 v42, v42
    v_exp_f32 v43, v43
    v_cvt_pk_bf16_f32 v92, v36, v37
    v_cvt_pk_bf16_f32 v93, v38, v39
    v_mfma_f32_32x32x16_bf16 v[52:67], a[68:71], v[88:91], v[52:67]
    s_add_u32 s45, s45, s44
    v_cvt_pk_bf16_f32 v94, v40, v41
    v_cvt_pk_bf16_f32 v95, v42, v43
    v_exp_f32 v44, v44
    v_exp_f32 v45, v45
    v_exp_f32 v46, v46
    v_exp_f32 v47, v47
    v_mfma_f32_32x32x16_bf16 v[68:83], a[64:67], v[92:95], v[68:83]
    v_lshlrev_b32 v119, 8, v119
    v_exp_f32 v48, v48
    v_exp_f32 v49, v49
    v_exp_f32 v50, v50
    v_exp_f32 v51, v51
    v_cvt_pk_bf16_f32 v96, v44, v45
    v_cvt_pk_bf16_f32 v97, v46, v47
    v_cvt_pk_bf16_f32 v98, v48, v49
    v_cvt_pk_bf16_f32 v99, v50, v51
    v_mfma_f32_32x32x16_bf16 v[36:51], a[72:75], v[104:107], 0
    v_lshl_add_u32 v119, v3, 4, v119
    v_exp_f32 v20, v20
    v_exp_f32 v21, v21
    v_exp_f32 v22, v22
    v_exp_f32 v23, v23
    v_mfma_f32_32x32x8_bf16 v[36:51], a[204:205], v[110:111], v[36:51]
    v_add3_u32 v119, v119, v6, s45
    v_exp_f32 v24, v24
    v_exp_f32 v25, v25
    v_exp_f32 v26, v26
    v_exp_f32 v27, v27
    v_cvt_pk_bf16_f32 v84, v20, v21
    v_cvt_pk_bf16_f32 v85, v22, v23
    v_mfma_f32_32x32x16_bf16 v[68:83], a[68:71], v[96:99], v[68:83]
    s_mul_i32 s49, s23, 128
    v_cvt_pk_bf16_f32 v86, v24, v25
    v_cvt_pk_bf16_f32 v87, v26, v27
    v_exp_f32 v28, v28
    v_exp_f32 v29, v29
    v_exp_f32 v30, v30
    v_exp_f32 v31, v31
    v_mfma_f32_32x32x16_bf16 v[52:67], a[76:79], v[84:87], v[52:67]
    s_lshr_b32 s36, s24, 1
    v_exp_f32 v32, v32
    v_exp_f32 v33, v33
    v_exp_f32 v34, v34
    v_exp_f32 v35, v35
    v_cvt_pk_bf16_f32 v88, v28, v29
    v_cvt_pk_bf16_f32 v89, v30, v31
    v_cvt_pk_bf16_f32 v90, v32, v33
    v_cvt_pk_bf16_f32 v91, v34, v35
    v_mfma_f32_32x32x16_bf16 v[20:35], a[84:87], v[100:103], 0
    s_mul_i32 s36, s36, 32
    v_exp_f32 v36, v36
    v_exp_f32 v37, v37
    v_exp_f32 v38, v38
    v_exp_f32 v39, v39
    v_mfma_f32_32x32x8_bf16 v[20:35], a[206:207], v[108:109], v[20:35]
    s_add_u32 s49, s49, s36
    v_exp_f32 v40, v40
    v_exp_f32 v41, v41
    v_exp_f32 v42, v42
    v_exp_f32 v43, v43
    v_cvt_pk_bf16_f32 v92, v36, v37
    v_cvt_pk_bf16_f32 v93, v38, v39
    v_mfma_f32_32x32x16_bf16 v[52:67], a[80:83], v[88:91], v[52:67]
    s_mul_i32 s36, s20, 8
    v_cvt_pk_bf16_f32 v94, v40, v41
    v_cvt_pk_bf16_f32 v95, v42, v43
    v_exp_f32 v44, v44
    v_exp_f32 v45, v45
    v_exp_f32 v46, v46
    v_exp_f32 v47, v47
    v_mfma_f32_32x32x16_bf16 v[68:83], a[76:79], v[92:95], v[68:83]
    s_add_u32 s49, s49, s36
    v_exp_f32 v48, v48
    v_exp_f32 v49, v49
    v_exp_f32 v50, v50
    v_exp_f32 v51, v51
    v_cvt_pk_bf16_f32 v96, v44, v45
    v_cvt_pk_bf16_f32 v97, v46, v47
    v_cvt_pk_bf16_f32 v98, v48, v49
    v_cvt_pk_bf16_f32 v99, v50, v51
    v_mfma_f32_32x32x16_bf16 v[36:51], a[84:87], v[104:107], 0
    s_and_b32 s36, s24, 1
    v_exp_f32 v20, v20
    v_exp_f32 v21, v21
    v_exp_f32 v22, v22
    v_exp_f32 v23, v23
    v_mfma_f32_32x32x8_bf16 v[36:51], a[206:207], v[110:111], v[36:51]
    s_mul_i32 s36, s36, 4
    v_exp_f32 v24, v24
    v_exp_f32 v25, v25
    v_exp_f32 v26, v26
    v_exp_f32 v27, v27
    v_cvt_pk_bf16_f32 v84, v20, v21
    v_cvt_pk_bf16_f32 v85, v22, v23
    v_mfma_f32_32x32x16_bf16 v[68:83], a[80:83], v[96:99], v[68:83]
    s_add_u32 s49, s49, s36
    v_cvt_pk_bf16_f32 v86, v24, v25
    v_cvt_pk_bf16_f32 v87, v26, v27
    v_exp_f32 v28, v28
    v_exp_f32 v29, v29
    v_exp_f32 v30, v30
    v_exp_f32 v31, v31
    v_mfma_f32_32x32x16_bf16 v[52:67], a[88:91], v[84:87], v[52:67]
    s_add_u32 s49, s49, s28
    v_exp_f32 v32, v32
    v_exp_f32 v33, v33
    v_exp_f32 v34, v34
    v_exp_f32 v35, v35
    v_cvt_pk_bf16_f32 v88, v28, v29
    v_cvt_pk_bf16_f32 v89, v30, v31
    v_cvt_pk_bf16_f32 v90, v32, v33
    v_cvt_pk_bf16_f32 v91, v34, v35
    v_mfma_f32_32x32x16_bf16 v[20:35], a[96:99], v[100:103], 0
    s_add_u32 s49, s49, 7057408
    v_exp_f32 v36, v36
    v_exp_f32 v37, v37
    v_exp_f32 v38, v38
    v_exp_f32 v39, v39
    v_mfma_f32_32x32x8_bf16 v[20:35], a[208:209], v[108:109], v[20:35]
    s_mov_b32 s62, 0x21800000
    v_exp_f32 v40, v40
    v_exp_f32 v41, v41
    v_exp_f32 v42, v42
    v_exp_f32 v43, v43
    v_cvt_pk_bf16_f32 v92, v36, v37
    v_cvt_pk_bf16_f32 v93, v38, v39
    v_mfma_f32_32x32x16_bf16 v[52:67], a[92:95], v[88:91], v[52:67]
    v_mov_b32 v123, 0x5d800000
    v_cvt_pk_bf16_f32 v94, v40, v41
    v_cvt_pk_bf16_f32 v95, v42, v43
    v_exp_f32 v44, v44
    v_exp_f32 v45, v45
    v_exp_f32 v46, v46
    v_exp_f32 v47, v47
    v_mfma_f32_32x32x16_bf16 v[68:83], a[88:91], v[92:95], v[68:83]
    buffer_load_dwordx4 v[156:159], v1, s[4:7], s48 offen sc1
    v_exp_f32 v48, v48
    v_exp_f32 v49, v49
    v_exp_f32 v50, v50
    v_exp_f32 v51, v51
    v_cvt_pk_bf16_f32 v96, v44, v45
    v_cvt_pk_bf16_f32 v97, v46, v47
    v_cvt_pk_bf16_f32 v98, v48, v49
    v_cvt_pk_bf16_f32 v99, v50, v51
    v_mfma_f32_32x32x16_bf16 v[36:51], a[96:99], v[104:107], 0
    v_mov_b32 v122, 0x203
    v_exp_f32 v20, v20
    v_exp_f32 v21, v21
    v_exp_f32 v22, v22
    v_exp_f32 v23, v23
    v_mfma_f32_32x32x8_bf16 v[36:51], a[208:209], v[110:111], v[36:51]
    s_mul_i32 s30, s21, 1703936
    v_exp_f32 v24, v24
    v_exp_f32 v25, v25
    v_exp_f32 v26, v26
    v_exp_f32 v27, v27
    v_cvt_pk_bf16_f32 v84, v20, v21
    v_cvt_pk_bf16_f32 v85, v22, v23
    v_mfma_f32_32x32x16_bf16 v[68:83], a[92:95], v[96:99], v[68:83]
    s_and_b32 s36, s23, 3
    v_cvt_pk_bf16_f32 v86, v24, v25
    v_cvt_pk_bf16_f32 v87, v26, v27
    v_exp_f32 v28, v28
    v_exp_f32 v29, v29
    v_exp_f32 v30, v30
    v_exp_f32 v31, v31
    v_mfma_f32_32x32x16_bf16 v[52:67], a[100:103], v[84:87], v[52:67]
    s_mul_i32 s36, s36, 81920
    v_exp_f32 v32, v32
    v_exp_f32 v33, v33
    v_exp_f32 v34, v34
    v_exp_f32 v35, v35
    v_cvt_pk_bf16_f32 v88, v28, v29
    v_cvt_pk_bf16_f32 v89, v30, v31
    v_cvt_pk_bf16_f32 v90, v32, v33
    v_cvt_pk_bf16_f32 v91, v34, v35
    v_mfma_f32_32x32x16_bf16 v[20:35], a[108:111], v[100:103], 0
    s_add_u32 s30, s30, s36
    v_exp_f32 v36, v36
    v_exp_f32 v37, v37
    v_exp_f32 v38, v38
    v_exp_f32 v39, v39
    v_mfma_f32_32x32x8_bf16 v[20:35], a[210:211], v[108:109], v[20:35]
    s_mul_i32 s36, s20, 20480
    v_exp_f32 v40, v40
    v_exp_f32 v41, v41
    v_exp_f32 v42, v42
    v_exp_f32 v43, v43
    v_cvt_pk_bf16_f32 v92, v36, v37
    v_cvt_pk_bf16_f32 v93, v38, v39
    v_mfma_f32_32x32x16_bf16 v[52:67], a[104:107], v[88:91], v[52:67]
    s_add_u32 s30, s30, s36
    v_cvt_pk_bf16_f32 v94, v40, v41
    v_cvt_pk_bf16_f32 v95, v42, v43
    v_exp_f32 v44, v44
    v_exp_f32 v45, v45
    v_exp_f32 v46, v46
    v_exp_f32 v47, v47
    v_mfma_f32_32x32x16_bf16 v[68:83], a[100:103], v[92:95], v[68:83]
    s_add_u32 s30, s30, 7274496
    v_exp_f32 v48, v48
    v_exp_f32 v49, v49
    v_exp_f32 v50, v50
    v_exp_f32 v51, v51
    v_cvt_pk_bf16_f32 v96, v44, v45
    v_cvt_pk_bf16_f32 v97, v46, v47
    v_cvt_pk_bf16_f32 v98, v48, v49
    v_cvt_pk_bf16_f32 v99, v50, v51
    v_mfma_f32_32x32x16_bf16 v[36:51], a[108:111], v[104:107], 0
    s_mul_i32 s38, s21, 1703936
    v_exp_f32 v20, v20
    v_exp_f32 v21, v21
    v_exp_f32 v22, v22
    v_exp_f32 v23, v23
    v_mfma_f32_32x32x8_bf16 v[36:51], a[210:211], v[110:111], v[36:51]
    s_and_b32 s36, s23, 3
    v_exp_f32 v24, v24
    v_exp_f32 v25, v25
    v_exp_f32 v26, v26
    v_exp_f32 v27, v27
    v_cvt_pk_bf16_f32 v84, v20, v21
    v_cvt_pk_bf16_f32 v85, v22, v23
    v_mfma_f32_32x32x16_bf16 v[68:83], a[104:107], v[96:99], v[68:83]
    s_mul_i32 s36, s36, 81920
    v_cvt_pk_bf16_f32 v86, v24, v25
    v_cvt_pk_bf16_f32 v87, v26, v27
    v_exp_f32 v28, v28
    v_exp_f32 v29, v29
    v_exp_f32 v30, v30
    v_exp_f32 v31, v31
    v_mfma_f32_32x32x16_bf16 v[52:67], a[112:115], v[84:87], v[52:67]
    s_add_u32 s38, s38, s36
    v_exp_f32 v32, v32
    v_exp_f32 v33, v33
    v_exp_f32 v34, v34
    v_exp_f32 v35, v35
    v_cvt_pk_bf16_f32 v88, v28, v29
    v_cvt_pk_bf16_f32 v89, v30, v31
    v_cvt_pk_bf16_f32 v90, v32, v33
    v_cvt_pk_bf16_f32 v91, v34, v35
    v_mfma_f32_32x32x16_bf16 v[20:35], a[120:123], v[100:103], 0
    s_mul_i32 s36, s20, 20480
    v_exp_f32 v36, v36
    v_exp_f32 v37, v37
    v_exp_f32 v38, v38
    v_exp_f32 v39, v39
    v_mfma_f32_32x32x8_bf16 v[20:35], a[212:213], v[108:109], v[20:35]
    s_add_u32 s38, s38, s36
    v_exp_f32 v40, v40
    v_exp_f32 v41, v41
    v_exp_f32 v42, v42
    v_exp_f32 v43, v43
    v_cvt_pk_bf16_f32 v92, v36, v37
    v_cvt_pk_bf16_f32 v93, v38, v39
    v_mfma_f32_32x32x16_bf16 v[52:67], a[116:119], v[88:91], v[52:67]
    s_lshr_b32 s36, s24, 1
    v_cvt_pk_bf16_f32 v94, v40, v41
    v_cvt_pk_bf16_f32 v95, v42, v43
    v_exp_f32 v44, v44
    v_exp_f32 v45, v45
    v_exp_f32 v46, v46
    v_exp_f32 v47, v47
    v_mfma_f32_32x32x16_bf16 v[68:83], a[112:115], v[92:95], v[68:83]
    s_cmp_lg_u32 s28, 0
    s_cbranch_scc1 L_l1skip_26
    s_mov_b32 s35, 0
L_prepagain_24:
    s_waitcnt vmcnt(0)
    v_xor_b32 v156, s75, v156
    v_xor_b32 v157, s75, v157
    v_xor_b32 v158, s75, v158
    v_xor_b32 v159, s75, v159
    v_or3_b32 v156, v156, v157, v158
    v_or_b32 v156, v156, v159
    v_cmp_lt_u32 vcc, 7, v156
    s_add_u32 s35, s35, 1
    s_cmp_gt_u32 s35, 0x40000
    s_cbranch_scc1 L_prepok_23
    s_nop 1
    s_cbranch_vccz L_prepok_23
    buffer_load_dwordx4 v[156:159], v1, s[4:7], s48 offen sc1
    s_branch L_prepagain_24
L_prepok_23:
L_l1skip_26:
    v_exp_f32 v48, v48
    v_exp_f32 v49, v49
    v_exp_f32 v50, v50
    v_exp_f32 v51, v51
    v_cvt_pk_bf16_f32 v96, v44, v45
    v_cvt_pk_bf16_f32 v97, v46, v47
    v_cvt_pk_bf16_f32 v98, v48, v49
    v_cvt_pk_bf16_f32 v99, v50, v51
    v_mfma_f32_32x32x16_bf16 v[36:51], a[120:123], v[104:107], 0
    buffer_load_dwordx4 v[156:159], v1, s[4:7], s50 offen offset:0
    v_exp_f32 v20, v20
    v_exp_f32 v21, v21
    v_exp_f32 v22, v22
    v_exp_f32 v23, v23
    v_mfma_f32_32x32x8_bf16 v[36:51], a[212:213], v[110:111], v[36:51]
    s_mul_i32 s36, s36, 5120
    v_exp_f32 v24, v24
    v_exp_f32 v25, v25
    v_exp_f32 v26, v26
    v_exp_f32 v27, v27
    v_cvt_pk_bf16_f32 v84, v20, v21
    v_cvt_pk_bf16_f32 v85, v22, v23
    v_mfma_f32_32x32x16_bf16 v[68:83], a[116:119], v[96:99], v[68:83]
    s_mov_b32 m0, s53
    v_cvt_pk_bf16_f32 v86, v24, v25
    v_cvt_pk_bf16_f32 v87, v26, v27
    v_exp_f32 v28, v28
    v_exp_f32 v29, v29
    v_exp_f32 v30, v30
    v_exp_f32 v31, v31
    v_mfma_f32_32x32x16_bf16 v[52:67], a[124:127], v[84:87], v[52:67]
    buffer_load_dwordx4 v1, s[4:7], s52 offen offset:0 lds
    v_exp_f32 v32, v32
    v_exp_f32 v33, v33
    v_exp_f32 v34, v34
    v_exp_f32 v35, v35
    v_cvt_pk_bf16_f32 v88, v28, v29
    v_cvt_pk_bf16_f32 v89, v30, v31
    v_cvt_pk_bf16_f32 v90, v32, v33
    v_cvt_pk_bf16_f32 v91, v34, v35
    v_mfma_f32_32x32x16_bf16 v[20:35], a[132:135], v[100:103], 0
    s_add_u32 s47, s47, 262144
    buffer_load_dwordx4 v[160:163], v1, s[4:7], s50 offen offset:1024
    v_exp_f32 v36, v36
    v_exp_f32 v37, v37
    v_exp_f32 v38, v38
    v_exp_f32 v39, v39
    v_mfma_f32_32x32x8_bf16 v[20:35], a[214:215], v[108:109], v[20:35]
    s_add_u32 s38, s38, s36
    v_exp_f32 v40, v40
    v_exp_f32 v41, v41
    v_exp_f32 v42, v42
    v_exp_f32 v43, v43
    v_cvt_pk_bf16_f32 v92, v36, v37
    v_cvt_pk_bf16_f32 v93, v38, v39
    v_mfma_f32_32x32x16_bf16 v[52:67], a[128:131], v[88:91], v[52:67]
    buffer_load_dword v5, v121, s[4:7], s47 offen
    v_cvt_pk_bf16_f32 v94, v40, v41
    v_cvt_pk_bf16_f32 v95, v42, v43
    v_exp_f32 v44, v44
    v_exp_f32 v45, v45
    v_exp_f32 v46, v46
    v_exp_f32 v47, v47
    v_mfma_f32_32x32x16_bf16 v[68:83], a[124:127], v[92:95], v[68:83]
    s_add_u32 s38, s38, 7602176
    v_exp_f32 v48, v48
    v_exp_f32 v49, v49
    v_exp_f32 v50, v50
    v_exp_f32 v51, v51
    v_cvt_pk_bf16_f32 v96, v44, v45
    v_cvt_pk_bf16_f32 v97, v46, v47
    v_cvt_pk_bf16_f32 v98, v48, v49
    v_cvt_pk_bf16_f32 v99, v50, v51
    v_mfma_f32_32x32x16_bf16 v[36:51], a[132:135], v[104:107], 0
    s_mov_b32 m0, s53
    v_exp_f32 v20, v20
    v_exp_f32 v21, v21
    v_exp_f32 v22, v22
    v_exp_f32 v23, v23
    v_mfma_f32_32x32x8_bf16 v[36:51], a[214:215], v[110:111], v[36:51]
    s_and_b32 s39, s24, 1
    v_exp_f32 v24, v24
    v_exp_f32 v25, v25
    v_exp_f32 v26, v26
    v_exp_f32 v27, v27
    v_cvt_pk_bf16_f32 v84, v20, v21
    v_cvt_pk_bf16_f32 v85, v22, v23
    v_mfma_f32_32x32x16_bf16 v[68:83], a[128:131], v[96:99], v[68:83]
    buffer_load_dwordx4 v1, s[4:7], s52 offen offset:1024 lds
    v_cvt_pk_bf16_f32 v86, v24, v25
    v_cvt_pk_bf16_f32 v87, v26, v27
    v_exp_f32 v28, v28
    v_exp_f32 v29, v29
    v_exp_f32 v30, v30
    v_exp_f32 v31, v31
    v_mfma_f32_32x32x16_bf16 v[52:67], a[136:139], v[84:87], v[52:67]
    buffer_load_dwordx4 v[164:167], v1, s[4:7], s50 offen offset:2048
    v_exp_f32 v32, v32
    v_exp_f32 v33, v33
    v_exp_f32 v34, v34
    v_exp_f32 v35, v35
    v_cvt_pk_bf16_f32 v88, v28, v29
    v_cvt_pk_bf16_f32 v89, v30, v31
    v_cvt_pk_bf16_f32 v90, v32, v33
    v_cvt_pk_bf16_f32 v91, v34, v35
    v_mfma_f32_32x32x16_bf16 v[20:35], a[144:147], v[100:103], 0
    s_mov_b32 m0, s53
    v_exp_f32 v36, v36
    v_exp_f32 v37, v37
    v_exp_f32 v38, v38
    v_exp_f32 v39, v39
    v_mfma_f32_32x32x8_bf16 v[20:35], a[216:217], v[108:109], v[20:35]
    s_mul_i32 s39, s39, 3072
    v_exp_f32 v40, v40
    v_exp_f32 v41, v41
    v_exp_f32 v42, v42
    v_exp_f32 v43, v43
    v_cvt_pk_bf16_f32 v92, v36, v37
    v_cvt_pk_bf16_f32 v93, v38, v39
    v_mfma_f32_32x32x16_bf16 v[52:67], a[140:143], v[88:91], v[52:67]
    buffer_load_dwordx4 v1, s[4:7], s52 offen offset:2048 lds
    v_cvt_pk_bf16_f32 v94, v40, v41
    v_cvt_pk_bf16_f32 v95, v42, v43
    v_exp_f32 v44, v44
    v_exp_f32 v45, v45
    v_exp_f32 v46, v46
    v_exp_f32 v47, v47
    v_mfma_f32_32x32x16_bf16 v[68:83], a[136:139], v[92:95], v[68:83]
    s_add_u32 s39, s39, s38
    v_exp_f32 v48, v48
    v_exp_f32 v49, v49
    v_exp_f32 v50, v50
    v_exp_f32 v51, v51
    v_cvt_pk_bf16_f32 v96, v44, v45
    v_cvt_pk_bf16_f32 v97, v46, v47
    v_cvt_pk_bf16_f32 v98, v48, v49
    v_cvt_pk_bf16_f32 v99, v50, v51
    v_mfma_f32_32x32x16_bf16 v[36:51], a[144:147], v[104:107], 0
    buffer_load_dwordx4 v[168:171], v1, s[4:7], s50 offen offset:3072
    v_exp_f32 v20, v20
    v_exp_f32 v21, v21
    v_exp_f32 v22, v22
    v_exp_f32 v23, v23
    v_mfma_f32_32x32x8_bf16 v[36:51], a[216:217], v[110:111], v[36:51]
    s_and_b32 s36, s24, 1
    v_exp_f32 v24, v24
    v_exp_f32 v25, v25
    v_exp_f32 v26, v26
    v_exp_f32 v27, v27
    v_cvt_pk_bf16_f32 v84, v20, v21
    v_cvt_pk_bf16_f32 v85, v22, v23
    v_mfma_f32_32x32x16_bf16 v[68:83], a[140:143], v[96:99], v[68:83]
    s_mov_b32 m0, s53
    v_cvt_pk_bf16_f32 v86, v24, v25
    v_cvt_pk_bf16_f32 v87, v26, v27
    v_exp_f32 v28, v28
    v_exp_f32 v29, v29
    v_exp_f32 v30, v30
    v_exp_f32 v31, v31
    v_mfma_f32_32x32x16_bf16 v[52:67], a[148:151], v[84:87], v[52:67]
    buffer_load_dwordx4 v1, s[4:7], s52 offen offset:3072 lds
    v_exp_f32 v32, v32
    v_exp_f32 v33, v33
    v_exp_f32 v34, v34
    v_exp_f32 v35, v35
    v_cvt_pk_bf16_f32 v88, v28, v29
    v_cvt_pk_bf16_f32 v89, v30, v31
    v_cvt_pk_bf16_f32 v90, v32, v33
    v_cvt_pk_bf16_f32 v91, v34, v35
    v_mfma_f32_32x32x16_bf16 v[20:35], a[156:159], v[100:103], 0
    s_add_u32 s50, s50, 4096
    v_exp_f32 v36, v36
    v_exp_f32 v37, v37
    v_exp_f32 v38, v38
    v_exp_f32 v39, v39
    v_mfma_f32_32x32x8_bf16 v[20:35], a[218:219], v[108:109], v[20:35]
    s_lshl_b32 s36, s36, 3
    v_exp_f32 v40, v40
    v_exp_f32 v41, v41
    v_exp_f32 v42, v42
    v_exp_f32 v43, v43
    v_cvt_pk_bf16_f32 v92, v36, v37
    v_cvt_pk_bf16_f32 v93, v38, v39
    v_mfma_f32_32x32x16_bf16 v[52:67], a[152:155], v[88:91], v[52:67]
    buffer_load_dwordx4 v[172:175], v1, s[4:7], s50 offen offset:0
    v_cvt_pk_bf16_f32 v94, v40, v41
    v_cvt_pk_bf16_f32 v95, v42, v43
    v_exp_f32 v44, v44
    v_exp_f32 v45, v45
    v_exp_f32 v46, v46
    v_exp_f32 v47, v47
    v_mfma_f32_32x32x16_bf16 v[68:83], a[148:151], v[92:95], v[68:83]
    s_add_u32 s38, s38, s36
    v_exp_f32 v48, v48
    v_exp_f32 v49, v49
    v_exp_f32 v50, v50
    v_exp_f32 v51, v51
    v_cvt_pk_bf16_f32 v96, v44, v45
    v_cvt_pk_bf16_f32 v97, v46, v47
    v_cvt_pk_bf16_f32 v98, v48, v49
    v_cvt_pk_bf16_f32 v99, v50, v51
    v_mfma_f32_32x32x16_bf16 v[36:51], a[156:159], v[104:107], 0
    s_add_u32 s52, s52, 4096
    v_exp_f32 v20, v20
    v_exp_f32 v21, v21
    v_exp_f32 v22, v22
    v_exp_f32 v23, v23
    v_mfma_f32_32x32x8_bf16 v[36:51], a[218:219], v[110:111], v[36:51]
    s_add_u32 s53, s53, 4096
    v_exp_f32 v24, v24
    v_exp_f32 v25, v25
    v_exp_f32 v26, v26
    v_exp_f32 v27, v27
    v_cvt_pk_bf16_f32 v84, v20, v21
    v_cvt_pk_bf16_f32 v85, v22, v23
    v_mfma_f32_32x32x16_bf16 v[68:83], a[152:155], v[96:99], v[68:83]
    s_mov_b32 m0, s53
    v_cvt_pk_bf16_f32 v86, v24, v25
    v_cvt_pk_bf16_f32 v87, v26, v27
    v_exp_f32 v28, v28
    v_exp_f32 v29, v29
    v_exp_f32 v30, v30
    v_exp_f32 v31, v31
    v_mfma_f32_32x32x16_bf16 v[52:67], a[160:163], v[84:87], v[52:67]
    buffer_load_dwordx4 v1, s[4:7], s52 offen offset:0 lds
    v_exp_f32 v32, v32
    v_exp_f32 v33, v33
    v_exp_f32 v34, v34
    v_exp_f32 v35, v35
    v_cvt_pk_bf16_f32 v88, v28, v29
    v_cvt_pk_bf16_f32 v89, v30, v31
    v_cvt_pk_bf16_f32 v90, v32, v33
    v_cvt_pk_bf16_f32 v91, v34, v35
    v_mfma_f32_32x32x16_bf16 v[20:35], a[168:171], v[100:103], 0
    buffer_load_dwordx4 v[176:179], v1, s[4:7], s50 offen offset:1024
    v_exp_f32 v36, v36
    v_exp_f32 v37, v37
    v_exp_f32 v38, v38
    v_exp_f32 v39, v39
    v_mfma_f32_32x32x8_bf16 v[20:35], a[220:221], v[108:109], v[20:35]
    s_mov_b32 m0, s53
    v_exp_f32 v40, v40
    v_exp_f32 v41, v41
    v_exp_f32 v42, v42
    v_exp_f32 v43, v43
    v_cvt_pk_bf16_f32 v92, v36, v37
    v_cvt_pk_bf16_f32 v93, v38, v39
    v_mfma_f32_32x32x16_bf16 v[52:67], a[164:167], v[88:91], v[52:67]
    buffer_load_dwordx4 v1, s[4:7], s52 offen offset:1024 lds
    v_cvt_pk_bf16_f32 v94, v40, v41
    v_cvt_pk_bf16_f32 v95, v42, v43
    v_exp_f32 v44, v44
    v_exp_f32 v45, v45
    v_exp_f32 v46, v46
    v_exp_f32 v47, v47
    v_mfma_f32_32x32x16_bf16 v[68:83], a[160:163], v[92:95], v[68:83]
    s_mul_i32 s41, s21, 1703936
    v_exp_f32 v48, v48
    v_exp_f32 v49, v49
    v_exp_f32 v50, v50
    v_exp_f32 v51, v51
    v_cvt_pk_bf16_f32 v96, v44, v45
    v_cvt_pk_bf16_f32 v97, v46, v47
    v_cvt_pk_bf16_f32 v98, v48, v49
    v_cvt_pk_bf16_f32 v99, v50, v51
    v_mfma_f32_32x32x16_bf16 v[36:51], a[168:171], v[104:107], 0
    s_and_b32 s36, s23, 3
    v_exp_f32 v20, v20
    v_exp_f32 v21, v21
    v_exp_f32 v22, v22
    v_exp_f32 v23, v23
    v_mfma_f32_32x32x8_bf16 v[36:51], a[220:221], v[110:111], v[36:51]
    s_mul_i32 s36, s36, 16384
    v_exp_f32 v24, v24
    v_exp_f32 v25, v25
    v_exp_f32 v26, v26
    v_exp_f32 v27, v27
    v_cvt_pk_bf16_f32 v84, v20, v21
    v_cvt_pk_bf16_f32 v85, v22, v23
    v_mfma_f32_32x32x16_bf16 v[68:83], a[164:167], v[96:99], v[68:83]
    s_mul_i32 s61, s63, 6144
    s_add_u32 s61, s61, 122880
    v_cvt_pk_bf16_f32 v86, v24, v25
    v_cvt_pk_bf16_f32 v87, v26, v27
    v_exp_f32 v28, v28
    v_exp_f32 v29, v29
    v_exp_f32 v30, v30
    v_exp_f32 v31, v31
    v_mfma_f32_32x32x16_bf16 v[52:67], a[172:175], v[84:87], v[52:67]
    v_lshl_add_u32 v114, v0, 4, s61
    s_add_u32 s63, s63, 1
    v_exp_f32 v32, v32
    v_exp_f32 v33, v33
    v_exp_f32 v34, v34
    v_exp_f32 v35, v35
    v_cvt_pk_bf16_f32 v88, v28, v29
    v_cvt_pk_bf16_f32 v89, v30, v31
    v_cvt_pk_bf16_f32 v90, v32, v33
    v_cvt_pk_bf16_f32 v91, v34, v35
    v_mfma_f32_32x32x16_bf16 v[20:35], a[180:183], v[100:103], 0
    s_and_b32 s63, s63, 3
    s_mul_i32 s61, s63, 3072
    v_exp_f32 v36, v36
    v_exp_f32 v37, v37
    v_exp_f32 v38, v38
    v_exp_f32 v39, v39
    v_mfma_f32_32x32x8_bf16 v[20:35], a[222:223], v[108:109], v[20:35]
    s_add_u32 s61, s61, 147456
    v_lshl_add_u32 v112, v0, 4, s61
    v_exp_f32 v40, v40
    v_exp_f32 v41, v41
    v_exp_f32 v42, v42
    v_exp_f32 v43, v43
    v_cvt_pk_bf16_f32 v92, v36, v37
    v_cvt_pk_bf16_f32 v93, v38, v39
    v_mfma_f32_32x32x16_bf16 v[52:67], a[176:179], v[88:91], v[52:67]
    v_lshl_add_u32 v113, v0, 3, s61
    v_cvt_pk_bf16_f32 v94, v40, v41
    v_cvt_pk_bf16_f32 v95, v42, v43
    v_exp_f32 v44, v44
    v_exp_f32 v45, v45
    v_exp_f32 v46, v46
    v_exp_f32 v47, v47
    v_mfma_f32_32x32x16_bf16 v[68:83], a[172:175], v[92:95], v[68:83]
    s_add_u32 s41, s41, s36
    v_exp_f32 v48, v48
    v_exp_f32 v49, v49
    v_exp_f32 v50, v50
    v_exp_f32 v51, v51
    v_cvt_pk_bf16_f32 v96, v44, v45
    v_cvt_pk_bf16_f32 v97, v46, v47
    v_cvt_pk_bf16_f32 v98, v48, v49
    v_cvt_pk_bf16_f32 v99, v50, v51
    v_mfma_f32_32x32x16_bf16 v[36:51], a[180:183], v[104:107], 0
    ds_read_b128 v[100:103], v112 offset:0
    v_exp_f32 v20, v20
    v_exp_f32 v21, v21
    v_exp_f32 v22, v22
    v_exp_f32 v23, v23
    v_mfma_f32_32x32x8_bf16 v[36:51], a[222:223], v[110:111], v[36:51]
    ds_read_b64 v[108:109], v113 offset:1024
    v_exp_f32 v24, v24
    v_exp_f32 v25, v25
    v_exp_f32 v26, v26
    v_exp_f32 v27, v27
    v_cvt_pk_bf16_f32 v84, v20, v21
    v_cvt_pk_bf16_f32 v85, v22, v23
    v_mfma_f32_32x32x16_bf16 v[68:83], a[176:179], v[96:99], v[68:83]
    ds_read_b128 v[104:107], v112 offset:1536
    v_cvt_pk_bf16_f32 v86, v24, v25
    v_cvt_pk_bf16_f32 v87, v26, v27
    v_exp_f32 v28, v28
    v_exp_f32 v29, v29
    v_exp_f32 v30, v30
    v_exp_f32 v31, v31
    v_mfma_f32_32x32x16_bf16 v[52:67], a[184:187], v[84:87], v[52:67]
    ds_read_b64 v[110:111], v113 offset:2560
    v_exp_f32 v32, v32
    v_exp_f32 v33, v33
    v_exp_f32 v34, v34
    v_exp_f32 v35, v35
    v_cvt_pk_bf16_f32 v88, v28, v29
    v_cvt_pk_bf16_f32 v89, v30, v31
    v_cvt_pk_bf16_f32 v90, v32, v33
    v_cvt_pk_bf16_f32 v91, v34, v35
    s_waitcnt lgkmcnt(2)
    v_mfma_f32_32x32x16_bf16 v[20:35], a[0:3], v[100:103], 0
    ds_read_b128 v[124:127], v114 offset:0
    v_exp_f32 v36, v36
    v_exp_f32 v37, v37
    v_exp_f32 v38, v38
    v_exp_f32 v39, v39
    v_mfma_f32_32x32x8_bf16 v[20:35], a[192:193], v[108:109], v[20:35]
    ds_read_b128 v[128:131], v114 offset:1024
    v_exp_f32 v40, v40
    v_exp_f32 v41, v41
    v_exp_f32 v42, v42
    v_exp_f32 v43, v43
    v_cvt_pk_bf16_f32 v92, v36, v37
    v_cvt_pk_bf16_f32 v93, v38, v39
    v_mfma_f32_32x32x16_bf16 v[52:67], a[188:191], v[88:91], v[52:67]
    ds_read_b128 v[132:135], v114 offset:2048
    ds_read_b128 v[136:139], v114 offset:3072
    v_cvt_pk_bf16_f32 v94, v40, v41
    v_cvt_pk_bf16_f32 v95, v42, v43
    v_exp_f32 v44, v44
    v_exp_f32 v45, v45
    v_exp_f32 v46, v46
    v_exp_f32 v47, v47
    v_mfma_f32_32x32x16_bf16 v[68:83], a[184:187], v[92:95], v[68:83]
    ds_read_b128 v[140:143], v114 offset:4096
    ds_read_b128 v[144:147], v114 offset:5120
    v_exp_f32 v48, v48
    v_exp_f32 v49, v49
    v_exp_f32 v50, v50
    v_exp_f32 v51, v51
    v_cvt_pk_bf16_f32 v96, v44, v45
    v_cvt_pk_bf16_f32 v97, v46, v47
    v_cvt_pk_bf16_f32 v98, v48, v49
    v_cvt_pk_bf16_f32 v99, v50, v51
    s_waitcnt lgkmcnt(0)
    v_mfma_f32_32x32x16_bf16 v[36:51], a[0:3], v[104:107], 0
    v_add_f32 v124, v124, v52
    v_add_f32 v125, v125, v53
    v_add_f32 v126, v126, v54
    v_add_f32 v127, v127, v55
    ds_write_b128 v114, v[124:127] offset:0
    v_exp_f32 v20, v20
    v_exp_f32 v21, v21
    v_exp_f32 v22, v22
    v_exp_f32 v23, v23
    v_mfma_f32_32x32x8_bf16 v[36:51], a[192:193], v[110:111], v[36:51]
    v_add_f32 v128, v128, v56
    v_add_f32 v129, v129, v57
    v_add_f32 v130, v130, v58
    v_add_f32 v131, v131, v59
    ds_write_b128 v114, v[128:131] offset:1024
    v_exp_f32 v24, v24
    v_exp_f32 v25, v25
    v_exp_f32 v26, v26
    v_exp_f32 v27, v27
    v_cvt_pk_bf16_f32 v84, v20, v21
    v_cvt_pk_bf16_f32 v85, v22, v23
    v_mfma_f32_32x32x16_bf16 v[68:83], a[188:191], v[96:99], v[68:83]
    v_add_f32 v132, v132, v60
    v_add_f32 v133, v133, v61
    v_add_f32 v134, v134, v62
    v_add_f32 v135, v135, v63
    ds_write_b128 v114, v[132:135] offset:2048
    v_cvt_pk_bf16_f32 v86, v24, v25
    v_cvt_pk_bf16_f32 v87, v26, v27
    v_exp_f32 v28, v28
    v_exp_f32 v29, v29
    v_exp_f32 v30, v30
    v_exp_f32 v31, v31
    v_mfma_f32_32x32x16_bf16 v[52:67], a[4:7], v[84:87], 0
    s_mul_i32 s36, s20, 4096
    v_exp_f32 v32, v32
    v_exp_f32 v33, v33
    v_exp_f32 v34, v34
    v_exp_f32 v35, v35
    v_cvt_pk_bf16_f32 v88, v28, v29
    v_cvt_pk_bf16_f32 v89, v30, v31
    v_cvt_pk_bf16_f32 v90, v32, v33
    v_cvt_pk_bf16_f32 v91, v34, v35
    v_mfma_f32_32x32x16_bf16 v[20:35], a[12:15], v[100:103], 0
    v_add_f32 v136, v136, v68
    v_add_f32 v137, v137, v69
    v_add_f32 v138, v138, v70
    v_add_f32 v139, v139, v71
    ds_write_b128 v114, v[136:139] offset:3072
    v_exp_f32 v36, v36
    v_exp_f32 v37, v37
    v_exp_f32 v38, v38
    v_exp_f32 v39, v39
    v_mfma_f32_32x32x8_bf16 v[20:35], a[194:195], v[108:109], v[20:35]
    v_add_f32 v140, v140, v72
    v_add_f32 v141, v141, v73
    v_add_f32 v142, v142, v74
    v_add_f32 v143, v143, v75
    ds_write_b128 v114, v[140:143] offset:4096
    v_exp_f32 v40, v40
    v_exp_f32 v41, v41
    v_exp_f32 v42, v42
    v_exp_f32 v43, v43
    v_cvt_pk_bf16_f32 v92, v36, v37
    v_cvt_pk_bf16_f32 v93, v38, v39
    v_mfma_f32_32x32x16_bf16 v[52:67], a[8:11], v[88:91], v[52:67]
    v_add_f32 v144, v144, v76
    v_add_f32 v145, v145, v77
    v_add_f32 v146, v146, v78
    v_add_f32 v147, v147, v79
    ds_write_b128 v114, v[144:147] offset:5120
    v_cvt_pk_bf16_f32 v94, v40, v41
    v_cvt_pk_bf16_f32 v95, v42, v43
    v_exp_f32 v44, v44
    v_exp_f32 v45, v45
    v_exp_f32 v46, v46
    v_exp_f32 v47, v47
    v_mfma_f32_32x32x16_bf16 v[68:83], a[4:7], v[92:95], 0
    s_add_u32 s41, s41, s36
    v_exp_f32 v48, v48
    v_exp_f32 v49, v49
    v_exp_f32 v50, v50
    v_exp_f32 v51, v51
    v_cvt_pk_bf16_f32 v96, v44, v45
    v_cvt_pk_bf16_f32 v97, v46, v47
    v_cvt_pk_bf16_f32 v98, v48, v49
    v_cvt_pk_bf16_f32 v99, v50, v51
    v_mfma_f32_32x32x16_bf16 v[36:51], a[12:15], v[104:107], 0
    buffer_load_dwordx4 v[180:183], v1, s[4:7], s50 offen offset:2048
    v_exp_f32 v20, v20
    v_exp_f32 v21, v21
    v_exp_f32 v22, v22
    v_exp_f32 v23, v23
    v_mfma_f32_32x32x8_bf16 v[36:51], a[194:195], v[110:111], v[36:51]
    s_and_b32 s36, s24, 1
    v_exp_f32 v24, v24
    v_exp_f32 v25, v25
    v_exp_f32 v26, v26
    v_exp_f32 v27, v27
    v_cvt_pk_bf16_f32 v84, v20, v21
    v_cvt_pk_bf16_f32 v85, v22, v23
    v_mfma_f32_32x32x16_bf16 v[68:83], a[8:11], v[96:99], v[68:83]
    s_mov_b32 m0, s53
    v_cvt_pk_bf16_f32 v86, v24, v25
    v_cvt_pk_bf16_f32 v87, v26, v27
    v_exp_f32 v28, v28
    v_exp_f32 v29, v29
    v_exp_f32 v30, v30
    v_exp_f32 v31, v31
    v_mfma_f32_32x32x16_bf16 v[52:67], a[16:19], v[84:87], v[52:67]
    buffer_load_dwordx4 v1, s[4:7], s52 offen offset:2048 lds
    v_exp_f32 v32, v32
    v_exp_f32 v33, v33
    v_exp_f32 v34, v34
    v_exp_f32 v35, v35
    v_cvt_pk_bf16_f32 v88, v28, v29
    v_cvt_pk_bf16_f32 v89, v30, v31
    v_cvt_pk_bf16_f32 v90, v32, v33
    v_cvt_pk_bf16_f32 v91, v34, v35
    v_mfma_f32_32x32x16_bf16 v[20:35], a[24:27], v[100:103], 0
    buffer_load_dwordx4 v[184:187], v1, s[4:7], s50 offen offset:3072
    v_exp_f32 v36, v36
    v_exp_f32 v37, v37
    v_exp_f32 v38, v38
    v_exp_f32 v39, v39
    v_mfma_f32_32x32x8_bf16 v[20:35], a[196:197], v[108:109], v[20:35]
    s_mul_i32 s36, s36, 2048
    v_exp_f32 v40, v40
    v_exp_f32 v41, v41
    v_exp_f32 v42, v42
    v_exp_f32 v43, v43
    v_cvt_pk_bf16_f32 v92, v36, v37
    v_cvt_pk_bf16_f32 v93, v38, v39
    v_mfma_f32_32x32x16_bf16 v[52:67], a[20:23], v[88:91], v[52:67]
    s_add_u32 s41, s41, s36
    v_cvt_pk_bf16_f32 v94, v40, v41
    v_cvt_pk_bf16_f32 v95, v42, v43
    v_exp_f32 v44, v44
    v_exp_f32 v45, v45
    v_exp_f32 v46, v46
    v_exp_f32 v47, v47
    v_mfma_f32_32x32x16_bf16 v[68:83], a[16:19], v[92:95], v[68:83]
    s_lshr_b32 s36, s24, 1
    v_exp_f32 v48, v48
    v_exp_f32 v49, v49
    v_exp_f32 v50, v50
    v_exp_f32 v51, v51
    v_cvt_pk_bf16_f32 v96, v44, v45
    v_cvt_pk_bf16_f32 v97, v46, v47
    v_cvt_pk_bf16_f32 v98, v48, v49
    v_cvt_pk_bf16_f32 v99, v50, v51
    v_mfma_f32_32x32x16_bf16 v[36:51], a[24:27], v[104:107], 0
    s_waitcnt lgkmcnt(0)
    s_barrier
    s_mov_b32 m0, s53
    v_exp_f32 v20, v20
    v_exp_f32 v21, v21
    v_exp_f32 v22, v22
    v_exp_f32 v23, v23
    v_mfma_f32_32x32x8_bf16 v[36:51], a[196:197], v[110:111], v[36:51]
    buffer_load_dwordx4 v1, s[4:7], s52 offen offset:3072 lds
    v_exp_f32 v24, v24
    v_exp_f32 v25, v25
    v_exp_f32 v26, v26
    v_exp_f32 v27, v27
    v_cvt_pk_bf16_f32 v84, v20, v21
    v_cvt_pk_bf16_f32 v85, v22, v23
    v_mfma_f32_32x32x16_bf16 v[68:83], a[20:23], v[96:99], v[68:83]
    s_add_u32 s50, s50, 4096
    v_cvt_pk_bf16_f32 v86, v24, v25
    v_cvt_pk_bf16_f32 v87, v26, v27
    v_exp_f32 v28, v28
    v_exp_f32 v29, v29
    v_exp_f32 v30, v30
    v_exp_f32 v31, v31
    v_mfma_f32_32x32x16_bf16 v[52:67], a[28:31], v[84:87], v[52:67]
    buffer_load_dwordx4 v[188:191], v1, s[4:7], s50 offen offset:0
    v_exp_f32 v32, v32
    v_exp_f32 v33, v33
    v_exp_f32 v34, v34
    v_exp_f32 v35, v35
    v_cvt_pk_bf16_f32 v88, v28, v29
    v_cvt_pk_bf16_f32 v89, v30, v31
    v_cvt_pk_bf16_f32 v90, v32, v33
    v_cvt_pk_bf16_f32 v91, v34, v35
    v_mfma_f32_32x32x16_bf16 v[20:35], a[36:39], v[100:103], 0
    s_add_u32 s52, s52, 4096
    v_exp_f32 v36, v36
    v_exp_f32 v37, v37
    v_exp_f32 v38, v38
    v_exp_f32 v39, v39
    v_mfma_f32_32x32x8_bf16 v[20:35], a[198:199], v[108:109], v[20:35]
    s_add_u32 s53, s53, 4096
    v_exp_f32 v40, v40
    v_exp_f32 v41, v41
    v_exp_f32 v42, v42
    v_exp_f32 v43, v43
    v_cvt_pk_bf16_f32 v92, v36, v37
    v_cvt_pk_bf16_f32 v93, v38, v39
    v_mfma_f32_32x32x16_bf16 v[52:67], a[32:35], v[88:91], v[52:67]
    s_mov_b32 m0, s53
    v_cvt_pk_bf16_f32 v94, v40, v41
    v_cvt_pk_bf16_f32 v95, v42, v43
    v_exp_f32 v44, v44
    v_exp_f32 v45, v45
    v_exp_f32 v46, v46
    v_exp_f32 v47, v47
    v_mfma_f32_32x32x16_bf16 v[68:83], a[28:31], v[92:95], v[68:83]
    buffer_load_dwordx4 v1, s[4:7], s52 offen offset:0 lds
    v_exp_f32 v48, v48
    v_exp_f32 v49, v49
    v_exp_f32 v50, v50
    v_exp_f32 v51, v51
    v_cvt_pk_bf16_f32 v96, v44, v45
    v_cvt_pk_bf16_f32 v97, v46, v47
    v_cvt_pk_bf16_f32 v98, v48, v49
    v_cvt_pk_bf16_f32 v99, v50, v51
    v_mfma_f32_32x32x16_bf16 v[36:51], a[36:39], v[104:107], 0
    buffer_load_dwordx4 v[192:195], v1, s[4:7], s50 offen offset:1024
    v_exp_f32 v20, v20
    v_exp_f32 v21, v21
    v_exp_f32 v22, v22
    v_exp_f32 v23, v23
    v_mfma_f32_32x32x8_bf16 v[36:51], a[198:199], v[110:111], v[36:51]
    s_mul_i32 s36, s36, 256
    v_exp_f32 v24, v24
    v_exp_f32 v25, v25
    v_exp_f32 v26, v26
    v_exp_f32 v27, v27
    v_cvt_pk_bf16_f32 v84, v20, v21
    v_cvt_pk_bf16_f32 v85, v22, v23
    v_mfma_f32_32x32x16_bf16 v[68:83], a[32:35], v[96:99], v[68:83]
    s_mov_b32 m0, s53
    v_cvt_pk_bf16_f32 v86, v24, v25
    v_cvt_pk_bf16_f32 v87, v26, v27
    v_exp_f32 v28, v28
    v_exp_f32 v29, v29
    v_exp_f32 v30, v30
    v_exp_f32 v31, v31
    v_mfma_f32_32x32x16_bf16 v[52:67], a[40:43], v[84:87], v[52:67]
    buffer_load_dwordx4 v1, s[4:7], s52 offen offset:1024 lds
    v_exp_f32 v32, v32
    v_exp_f32 v33, v33
    v_exp_f32 v34, v34
    v_exp_f32 v35, v35
    v_cvt_pk_bf16_f32 v88, v28, v29
    v_cvt_pk_bf16_f32 v89, v30, v31
    v_cvt_pk_bf16_f32 v90, v32, v33
    v_cvt_pk_bf16_f32 v91, v34, v35
    v_mfma_f32_32x32x16_bf16 v[20:35], a[48:51], v[100:103], 0
    s_add_u32 s47, s47, 262144
    buffer_load_dwordx4 v[196:199], v1, s[4:7], s50 offen offset:2048
    v_exp_f32 v36, v36
    v_exp_f32 v37, v37
    v_exp_f32 v38, v38
    v_exp_f32 v39, v39
    v_mfma_f32_32x32x8_bf16 v[20:35], a[200:201], v[108:109], v[20:35]
    s_add_u32 s41, s41, s36
    v_exp_f32 v40, v40
    v_exp_f32 v41, v41
    v_exp_f32 v42, v42
    v_exp_f32 v43, v43
    v_cvt_pk_bf16_f32 v92, v36, v37
    v_cvt_pk_bf16_f32 v93, v38, v39
    v_mfma_f32_32x32x16_bf16 v[52:67], a[44:47], v[88:91], v[52:67]
    buffer_load_dword v5, v121, s[4:7], s47 offen
    v_cvt_pk_bf16_f32 v94, v40, v41
    v_cvt_pk_bf16_f32 v95, v42, v43
    v_exp_f32 v44, v44
    v_exp_f32 v45, v45
    v_exp_f32 v46, v46
    v_exp_f32 v47, v47
    v_mfma_f32_32x32x16_bf16 v[68:83], a[40:43], v[92:95], v[68:83]
    s_add_u32 s41, s41, 8912896
    v_exp_f32 v48, v48
    v_exp_f32 v49, v49
    v_exp_f32 v50, v50
    v_exp_f32 v51, v51
    v_cvt_pk_bf16_f32 v96, v44, v45
    v_cvt_pk_bf16_f32 v97, v46, v47
    v_cvt_pk_bf16_f32 v98, v48, v49
    v_cvt_pk_bf16_f32 v99, v50, v51
    v_mfma_f32_32x32x16_bf16 v[36:51], a[48:51], v[104:107], 0
    s_mov_b32 m0, s53
    v_exp_f32 v20, v20
    v_exp_f32 v21, v21
    v_exp_f32 v22, v22
    v_exp_f32 v23, v23
    v_mfma_f32_32x32x8_bf16 v[36:51], a[200:201], v[110:111], v[36:51]
    s_mul_i32 s40, s23, 128
    v_exp_f32 v24, v24
    v_exp_f32 v25, v25
    v_exp_f32 v26, v26
    v_exp_f32 v27, v27
    v_cvt_pk_bf16_f32 v84, v20, v21
    v_cvt_pk_bf16_f32 v85, v22, v23
    v_mfma_f32_32x32x16_bf16 v[68:83], a[44:47], v[96:99], v[68:83]
    buffer_load_dwordx4 v1, s[4:7], s52 offen offset:2048 lds
    v_cvt_pk_bf16_f32 v86, v24, v25
    v_cvt_pk_bf16_f32 v87, v26, v27
    v_exp_f32 v28, v28
    v_exp_f32 v29, v29
    v_exp_f32 v30, v30
    v_exp_f32 v31, v31
    v_mfma_f32_32x32x16_bf16 v[52:67], a[52:55], v[84:87], v[52:67]
    buffer_load_dwordx4 v[200:203], v1, s[4:7], s50 offen offset:3072
    v_exp_f32 v32, v32
    v_exp_f32 v33, v33
    v_exp_f32 v34, v34
    v_exp_f32 v35, v35
    v_cvt_pk_bf16_f32 v88, v28, v29
    v_cvt_pk_bf16_f32 v89, v30, v31
    v_cvt_pk_bf16_f32 v90, v32, v33
    v_cvt_pk_bf16_f32 v91, v34, v35
    v_mfma_f32_32x32x16_bf16 v[20:35], a[60:63], v[100:103], 0
    s_mov_b32 m0, s53
    v_exp_f32 v36, v36
    v_exp_f32 v37, v37
    v_exp_f32 v38, v38
    v_exp_f32 v39, v39
    v_mfma_f32_32x32x8_bf16 v[20:35], a[202:203], v[108:109], v[20:35]
    s_lshr_b32 s36, s24, 1
    v_exp_f32 v40, v40
    v_exp_f32 v41, v41
    v_exp_f32 v42, v42
    v_exp_f32 v43, v43
    v_cvt_pk_bf16_f32 v92, v36, v37
    v_cvt_pk_bf16_f32 v93, v38, v39
    v_mfma_f32_32x32x16_bf16 v[52:67], a[56:59], v[88:91], v[52:67]
    buffer_load_dwordx4 v1, s[4:7], s52 offen offset:3072 lds
    v_cvt_pk_bf16_f32 v94, v40, v41
    v_cvt_pk_bf16_f32 v95, v42, v43
    v_exp_f32 v44, v44
    v_exp_f32 v45, v45
    v_exp_f32 v46, v46
    v_exp_f32 v47, v47
    v_mfma_f32_32x32x16_bf16 v[68:83], a[52:55], v[92:95], v[68:83]
    s_mul_i32 s36, s36, 32
    v_exp_f32 v48, v48
    v_exp_f32 v49, v49
    v_exp_f32 v50, v50
    v_exp_f32 v51, v51
    v_cvt_pk_bf16_f32 v96, v44, v45
    v_cvt_pk_bf16_f32 v97, v46, v47
    v_cvt_pk_bf16_f32 v98, v48, v49
    v_cvt_pk_bf16_f32 v99, v50, v51
    v_mfma_f32_32x32x16_bf16 v[36:51], a[60:63], v[104:107], 0
    s_add_u32 s50, s50, 4096
    v_exp_f32 v20, v20
    v_exp_f32 v21, v21
    v_exp_f32 v22, v22
    v_exp_f32 v23, v23
    v_mfma_f32_32x32x8_bf16 v[36:51], a[202:203], v[110:111], v[36:51]
    buffer_load_dwordx4 v[204:207], v1, s[4:7], s50 offen offset:0
    v_exp_f32 v24, v24
    v_exp_f32 v25, v25
    v_exp_f32 v26, v26
    v_exp_f32 v27, v27
    v_cvt_pk_bf16_f32 v84, v20, v21
    v_cvt_pk_bf16_f32 v85, v22, v23
    v_mfma_f32_32x32x16_bf16 v[68:83], a[56:59], v[96:99], v[68:83]
    s_add_u32 s52, s52, 4096
    v_cvt_pk_bf16_f32 v86, v24, v25
    v_cvt_pk_bf16_f32 v87, v26, v27
    v_exp_f32 v28, v28
    v_exp_f32 v29, v29
    v_exp_f32 v30, v30
    v_exp_f32 v31, v31
    v_mfma_f32_32x32x16_bf16 v[52:67], a[64:67], v[84:87], v[52:67]
    s_add_u32 s53, s53, 4096
    v_exp_f32 v32, v32
    v_exp_f32 v33, v33
    v_exp_f32 v34, v34
    v_exp_f32 v35, v35
    v_cvt_pk_bf16_f32 v88, v28, v29
    v_cvt_pk_bf16_f32 v89, v30, v31
    v_cvt_pk_bf16_f32 v90, v32, v33
    v_cvt_pk_bf16_f32 v91, v34, v35
    v_mfma_f32_32x32x16_bf16 v[20:35], a[72:75], v[100:103], 0
    s_mov_b32 m0, s53
    v_exp_f32 v36, v36
    v_exp_f32 v37, v37
    v_exp_f32 v38, v38
    v_exp_f32 v39, v39
    v_mfma_f32_32x32x8_bf16 v[20:35], a[204:205], v[108:109], v[20:35]
    buffer_load_dwordx4 v1, s[4:7], s52 offen offset:0 lds
    v_exp_f32 v40, v40
    v_exp_f32 v41, v41
    v_exp_f32 v42, v42
    v_exp_f32 v43, v43
    v_cvt_pk_bf16_f32 v92, v36, v37
    v_cvt_pk_bf16_f32 v93, v38, v39
    v_mfma_f32_32x32x16_bf16 v[52:67], a[68:71], v[88:91], v[52:67]
    buffer_load_dwordx4 v[208:211], v1, s[4:7], s50 offen offset:1024
    v_cvt_pk_bf16_f32 v94, v40, v41
    v_cvt_pk_bf16_f32 v95, v42, v43
    v_exp_f32 v44, v44
    v_exp_f32 v45, v45
    v_exp_f32 v46, v46
    v_exp_f32 v47, v47
    v_mfma_f32_32x32x16_bf16 v[68:83], a[64:67], v[92:95], v[68:83]
    s_add_u32 s40, s40, s36
    v_exp_f32 v48, v48
    v_exp_f32 v49, v49
    v_exp_f32 v50, v50
    v_exp_f32 v51, v51
    v_cvt_pk_bf16_f32 v96, v44, v45
    v_cvt_pk_bf16_f32 v97, v46, v47
    v_cvt_pk_bf16_f32 v98, v48, v49
    v_cvt_pk_bf16_f32 v99, v50, v51
    v_mfma_f32_32x32x16_bf16 v[36:51], a[72:75], v[104:107], 0
    s_mov_b32 m0, s53
    v_exp_f32 v20, v20
    v_exp_f32 v21, v21
    v_exp_f32 v22, v22
    v_exp_f32 v23, v23
    v_mfma_f32_32x32x8_bf16 v[36:51], a[204:205], v[110:111], v[36:51]
    s_mul_i32 s36, s20, 8
    v_exp_f32 v24, v24
    v_exp_f32 v25, v25
    v_exp_f32 v26, v26
    v_exp_f32 v27, v27
    v_cvt_pk_bf16_f32 v84, v20, v21
    v_cvt_pk_bf16_f32 v85, v22, v23
    v_mfma_f32_32x32x16_bf16 v[68:83], a[68:71], v[96:99], v[68:83]
    buffer_load_dwordx4 v1, s[4:7], s52 offen offset:1024 lds
    v_cvt_pk_bf16_f32 v86, v24, v25
    v_cvt_pk_bf16_f32 v87, v26, v27
    v_exp_f32 v28, v28
    v_exp_f32 v29, v29
    v_exp_f32 v30, v30
    v_exp_f32 v31, v31
    v_mfma_f32_32x32x16_bf16 v[52:67], a[76:79], v[84:87], v[52:67]
    buffer_load_dwordx4 v[212:215], v1, s[4:7], s50 offen offset:2048
    v_exp_f32 v32, v32
    v_exp_f32 v33, v33
    v_exp_f32 v34, v34
    v_exp_f32 v35, v35
    v_cvt_pk_bf16_f32 v88, v28, v29
    v_cvt_pk_bf16_f32 v89, v30, v31
    v_cvt_pk_bf16_f32 v90, v32, v33
    v_cvt_pk_bf16_f32 v91, v34, v35
    v_mfma_f32_32x32x16_bf16 v[20:35], a[84:87], v[100:103], 0
    s_mov_b32 m0, s53
    v_exp_f32 v36, v36
    v_exp_f32 v37, v37
    v_exp_f32 v38, v38
    v_exp_f32 v39, v39
    v_mfma_f32_32x32x8_bf16 v[20:35], a[206:207], v[108:109], v[20:35]
    s_add_u32 s40, s40, s36
    v_exp_f32 v40, v40
    v_exp_f32 v41, v41
    v_exp_f32 v42, v42
    v_exp_f32 v43, v43
    v_cvt_pk_bf16_f32 v92, v36, v37
    v_cvt_pk_bf16_f32 v93, v38, v39
    v_mfma_f32_32x32x16_bf16 v[52:67], a[80:83], v[88:91], v[52:67]
    buffer_load_dwordx4 v1, s[4:7], s52 offen offset:2048 lds
    v_cvt_pk_bf16_f32 v94, v40, v41
    v_cvt_pk_bf16_f32 v95, v42, v43
    v_exp_f32 v44, v44
    v_exp_f32 v45, v45
    v_exp_f32 v46, v46
    v_exp_f32 v47, v47
    v_mfma_f32_32x32x16_bf16 v[68:83], a[76:79], v[92:95], v[68:83]
    s_and_b32 s36, s24, 1
    v_exp_f32 v48, v48
    v_exp_f32 v49, v49
    v_exp_f32 v50, v50
    v_exp_f32 v51, v51
    v_cvt_pk_bf16_f32 v96, v44, v45
    v_cvt_pk_bf16_f32 v97, v46, v47
    v_cvt_pk_bf16_f32 v98, v48, v49
    v_cvt_pk_bf16_f32 v99, v50, v51
    v_mfma_f32_32x32x16_bf16 v[36:51], a[84:87], v[104:107], 0
    buffer_load_dwordx4 v[216:219], v1, s[4:7], s50 offen offset:3072
    v_exp_f32 v20, v20
    v_exp_f32 v21, v21
    v_exp_f32 v22, v22
    v_exp_f32 v23, v23
    v_mfma_f32_32x32x8_bf16 v[36:51], a[206:207], v[110:111], v[36:51]
    s_mul_i32 s36, s36, 4
    v_exp_f32 v24, v24
    v_exp_f32 v25, v25
    v_exp_f32 v26, v26
    v_exp_f32 v27, v27
    v_cvt_pk_bf16_f32 v84, v20, v21
    v_cvt_pk_bf16_f32 v85, v22, v23
    v_mfma_f32_32x32x16_bf16 v[68:83], a[80:83], v[96:99], v[68:83]
    s_mov_b32 m0, s53
    v_cvt_pk_bf16_f32 v86, v24, v25
    v_cvt_pk_bf16_f32 v87, v26, v27
    v_exp_f32 v28, v28
    v_exp_f32 v29, v29
    v_exp_f32 v30, v30
    v_exp_f32 v31, v31
    v_mfma_f32_32x32x16_bf16 v[52:67], a[88:91], v[84:87], v[52:67]
    buffer_load_dwordx4 v1, s[4:7], s52 offen offset:3072 lds
    v_exp_f32 v32, v32
    v_exp_f32 v33, v33
    v_exp_f32 v34, v34
    v_exp_f32 v35, v35
    v_cvt_pk_bf16_f32 v88, v28, v29
    v_cvt_pk_bf16_f32 v89, v30, v31
    v_cvt_pk_bf16_f32 v90, v32, v33
    v_cvt_pk_bf16_f32 v91, v34, v35
    v_mfma_f32_32x32x16_bf16 v[20:35], a[96:99], v[100:103], 0
    s_add_u32 s50, s50, 4096
    v_exp_f32 v36, v36
    v_exp_f32 v37, v37
    v_exp_f32 v38, v38
    v_exp_f32 v39, v39
    v_mfma_f32_32x32x8_bf16 v[20:35], a[208:209], v[108:109], v[20:35]
    s_add_u32 s40, s40, s36
    v_exp_f32 v40, v40
    v_exp_f32 v41, v41
    v_exp_f32 v42, v42
    v_exp_f32 v43, v43
    v_cvt_pk_bf16_f32 v92, v36, v37
    v_cvt_pk_bf16_f32 v93, v38, v39
    v_mfma_f32_32x32x16_bf16 v[52:67], a[92:95], v[88:91], v[52:67]
    buffer_load_dwordx4 v[220:223], v1, s[4:7], s50 offen offset:0
    v_cvt_pk_bf16_f32 v94, v40, v41
    v_cvt_pk_bf16_f32 v95, v42, v43
    v_exp_f32 v44, v44
    v_exp_f32 v45, v45
    v_exp_f32 v46, v46
    v_exp_f32 v47, v47
    v_mfma_f32_32x32x16_bf16 v[68:83], a[88:91], v[92:95], v[68:83]
    s_add_u32 s40, s40, s28
    v_exp_f32 v48, v48
    v_exp_f32 v49, v49
    v_exp_f32 v50, v50
    v_exp_f32 v51, v51
    v_cvt_pk_bf16_f32 v96, v44, v45
    v_cvt_pk_bf16_f32 v97, v46, v47
    v_cvt_pk_bf16_f32 v98, v48, v49
    v_cvt_pk_bf16_f32 v99, v50, v51
    v_mfma_f32_32x32x16_bf16 v[36:51], a[96:99], v[104:107], 0
    s_add_u32 s52, s52, 4096
    v_exp_f32 v20, v20
    v_exp_f32 v21, v21
    v_exp_f32 v22, v22
    v_exp_f32 v23, v23
    v_mfma_f32_32x32x8_bf16 v[36:51], a[208:209], v[110:111], v[36:51]
    s_add_u32 s53, s53, 4096
    v_exp_f32 v24, v24
    v_exp_f32 v25, v25
    v_exp_f32 v26, v26
    v_exp_f32 v27, v27
    v_cvt_pk_bf16_f32 v84, v20, v21
    v_cvt_pk_bf16_f32 v85, v22, v23
    v_mfma_f32_32x32x16_bf16 v[68:83], a[92:95], v[96:99], v[68:83]
    s_mov_b32 m0, s53
    v_cvt_pk_bf16_f32 v86, v24, v25
    v_cvt_pk_bf16_f32 v87, v26, v27
    v_exp_f32 v28, v28
    v_exp_f32 v29, v29
    v_exp_f32 v30, v30
    v_exp_f32 v31, v31
    v_mfma_f32_32x32x16_bf16 v[52:67], a[100:103], v[84:87], v[52:67]
    buffer_load_dwordx4 v1, s[4:7], s52 offen offset:0 lds
    v_exp_f32 v32, v32
    v_exp_f32 v33, v33
    v_exp_f32 v34, v34
    v_exp_f32 v35, v35
    v_cvt_pk_bf16_f32 v88, v28, v29
    v_cvt_pk_bf16_f32 v89, v30, v31
    v_cvt_pk_bf16_f32 v90, v32, v33
    v_cvt_pk_bf16_f32 v91, v34, v35
    v_mfma_f32_32x32x16_bf16 v[20:35], a[108:111], v[100:103], 0
    buffer_load_dwordx4 v[224:227], v1, s[4:7], s50 offen offset:1024
    v_exp_f32 v36, v36
    v_exp_f32 v37, v37
    v_exp_f32 v38, v38
    v_exp_f32 v39, v39
    v_mfma_f32_32x32x8_bf16 v[20:35], a[210:211], v[108:109], v[20:35]
    s_mov_b32 m0, s53
    v_exp_f32 v40, v40
    v_exp_f32 v41, v41
    v_exp_f32 v42, v42
    v_exp_f32 v43, v43
    v_cvt_pk_bf16_f32 v92, v36, v37
    v_cvt_pk_bf16_f32 v93, v38, v39
    v_mfma_f32_32x32x16_bf16 v[52:67], a[104:107], v[88:91], v[52:67]
    buffer_load_dwordx4 v1, s[4:7], s52 offen offset:1024 lds
    v_cvt_pk_bf16_f32 v94, v40, v41
    v_cvt_pk_bf16_f32 v95, v42, v43
    v_exp_f32 v44, v44
    v_exp_f32 v45, v45
    v_exp_f32 v46, v46
    v_exp_f32 v47, v47
    v_mfma_f32_32x32x16_bf16 v[68:83], a[100:103], v[92:95], v[68:83]
    s_add_u32 s40, s40, 7061504
    v_exp_f32 v48, v48
    v_exp_f32 v49, v49
    v_exp_f32 v50, v50
    v_exp_f32 v51, v51
    v_cvt_pk_bf16_f32 v96, v44, v45
    v_cvt_pk_bf16_f32 v97, v46, v47
    v_cvt_pk_bf16_f32 v98, v48, v49
    v_cvt_pk_bf16_f32 v99, v50, v51
    v_mfma_f32_32x32x16_bf16 v[36:51], a[108:111], v[104:107], 0
    buffer_load_dwordx4 v[228:231], v1, s[4:7], s50 offen offset:2048
    v_exp_f32 v20, v20
    v_exp_f32 v21, v21
    v_exp_f32 v22, v22
    v_exp_f32 v23, v23
    v_mfma_f32_32x32x8_bf16 v[36:51], a[210:211], v[110:111], v[36:51]
    s_mov_b32 s66, 0x00003f80
    v_exp_f32 v24, v24
    v_exp_f32 v25, v25
    v_exp_f32 v26, v26
    v_exp_f32 v27, v27
    v_cvt_pk_bf16_f32 v84, v20, v21
    v_cvt_pk_bf16_f32 v85, v22, v23
    v_mfma_f32_32x32x16_bf16 v[68:83], a[104:107], v[96:99], v[68:83]
    s_mov_b32 m0, s53
    v_cvt_pk_bf16_f32 v86, v24, v25
    v_cvt_pk_bf16_f32 v87, v26, v27
    v_exp_f32 v28, v28
    v_exp_f32 v29, v29
    v_exp_f32 v30, v30
    v_exp_f32 v31, v31
    v_mfma_f32_32x32x16_bf16 v[52:67], a[112:115], v[84:87], v[52:67]
    buffer_load_dwordx4 v1, s[4:7], s52 offen offset:2048 lds
    v_exp_f32 v32, v32
    v_exp_f32 v33, v33
    v_exp_f32 v34, v34
    v_exp_f32 v35, v35
    v_cvt_pk_bf16_f32 v88, v28, v29
    v_cvt_pk_bf16_f32 v89, v30, v31
    v_cvt_pk_bf16_f32 v90, v32, v33
    v_cvt_pk_bf16_f32 v91, v34, v35
    v_mfma_f32_32x32x16_bf16 v[20:35], a[120:123], v[100:103], 0
    s_mov_b32 s67, 0x3f800000
    v_exp_f32 v36, v36
    v_exp_f32 v37, v37
    v_exp_f32 v38, v38
    v_exp_f32 v39, v39
    v_mfma_f32_32x32x8_bf16 v[20:35], a[212:213], v[108:109], v[20:35]
    s_mov_b32 s68, 0x3f803f80
    v_exp_f32 v40, v40
    v_exp_f32 v41, v41
    v_exp_f32 v42, v42
    v_exp_f32 v43, v43
    v_cvt_pk_bf16_f32 v92, v36, v37
    v_cvt_pk_bf16_f32 v93, v38, v39
    v_mfma_f32_32x32x16_bf16 v[52:67], a[116:119], v[88:91], v[52:67]
    v_lshrrev_b32 v18, 1, v4
    v_cvt_pk_bf16_f32 v94, v40, v41
    v_cvt_pk_bf16_f32 v95, v42, v43
    v_exp_f32 v44, v44
    v_exp_f32 v45, v45
    v_exp_f32 v46, v46
    v_exp_f32 v47, v47
    v_mfma_f32_32x32x16_bf16 v[68:83], a[112:115], v[92:95], v[68:83]
    v_lshlrev_b32 v18, 10, v18
    v_exp_f32 v48, v48
    v_exp_f32 v49, v49
    v_exp_f32 v50, v50
    v_exp_f32 v51, v51
    v_cvt_pk_bf16_f32 v96, v44, v45
    v_cvt_pk_bf16_f32 v97, v46, v47
    v_cvt_pk_bf16_f32 v98, v48, v49
    v_cvt_pk_bf16_f32 v99, v50, v51
    v_mfma_f32_32x32x16_bf16 v[36:51], a[120:123], v[104:107], 0
    buffer_load_dwordx4 v[232:235], v1, s[4:7], s50 offen offset:3072
    v_exp_f32 v20, v20
    v_exp_f32 v21, v21
    v_exp_f32 v22, v22
    v_exp_f32 v23, v23
    v_mfma_f32_32x32x8_bf16 v[36:51], a[212:213], v[110:111], v[36:51]
    v_lshl_add_u32 v18, v3, 4, v18
    v_exp_f32 v24, v24
    v_exp_f32 v25, v25
    v_exp_f32 v26, v26
    v_exp_f32 v27, v27
    v_cvt_pk_bf16_f32 v84, v20, v21
    v_cvt_pk_bf16_f32 v85, v22, v23
    v_mfma_f32_32x32x16_bf16 v[68:83], a[116:119], v[96:99], v[68:83]
    s_mov_b32 m0, s53
    v_cvt_pk_bf16_f32 v86, v24, v25
    v_cvt_pk_bf16_f32 v87, v26, v27
    v_exp_f32 v28, v28
    v_exp_f32 v29, v29
    v_exp_f32 v30, v30
    v_exp_f32 v31, v31
    v_mfma_f32_32x32x16_bf16 v[52:67], a[124:127], v[84:87], v[52:67]
    buffer_load_dwordx4 v1, s[4:7], s52 offen offset:3072 lds
    v_exp_f32 v32, v32
    v_exp_f32 v33, v33
    v_exp_f32 v34, v34
    v_exp_f32 v35, v35
    v_cvt_pk_bf16_f32 v88, v28, v29
    v_cvt_pk_bf16_f32 v89, v30, v31
    v_cvt_pk_bf16_f32 v90, v32, v33
    v_cvt_pk_bf16_f32 v91, v34, v35
    v_mfma_f32_32x32x16_bf16 v[20:35], a[132:135], v[100:103], 0
    s_add_u32 s47, s47, 262144
    v_exp_f32 v36, v36
    v_exp_f32 v37, v37
    v_exp_f32 v38, v38
    v_exp_f32 v39, v39
    v_mfma_f32_32x32x8_bf16 v[20:35], a[214:215], v[108:109], v[20:35]
    v_and_b32 v6, 1, v4
    v_exp_f32 v40, v40
    v_exp_f32 v41, v41
    v_exp_f32 v42, v42
    v_exp_f32 v43, v43
    v_cvt_pk_bf16_f32 v92, v36, v37
    v_cvt_pk_bf16_f32 v93, v38, v39
    v_mfma_f32_32x32x16_bf16 v[52:67], a[128:131], v[88:91], v[52:67]
    buffer_load_dword v5, v121, s[4:7], s47 offen
    v_cvt_pk_bf16_f32 v94, v40, v41
    v_cvt_pk_bf16_f32 v95, v42, v43
    v_exp_f32 v44, v44
    v_exp_f32 v45, v45
    v_exp_f32 v46, v46
    v_exp_f32 v47, v47
    v_mfma_f32_32x32x16_bf16 v[68:83], a[124:127], v[92:95], v[68:83]
    v_lshl_add_u32 v18, v6, 3, v18
    v_exp_f32 v48, v48
    v_exp_f32 v49, v49
    v_exp_f32 v50, v50
    v_exp_f32 v51, v51
    v_cvt_pk_bf16_f32 v96, v44, v45
    v_cvt_pk_bf16_f32 v97, v46, v47
    v_cvt_pk_bf16_f32 v98, v48, v49
    v_cvt_pk_bf16_f32 v99, v50, v51
    v_mfma_f32_32x32x16_bf16 v[36:51], a[132:135], v[104:107], 0
    s_add_u32 s50, s50, 4096
    v_exp_f32 v20, v20
    v_exp_f32 v21, v21
    v_exp_f32 v22, v22
    v_exp_f32 v23, v23
    v_mfma_f32_32x32x8_bf16 v[36:51], a[214:215], v[110:111], v[36:51]
    s_mul_i32 s33, s23, 128
    v_exp_f32 v24, v24
    v_exp_f32 v25, v25
    v_exp_f32 v26, v26
    v_exp_f32 v27, v27
    v_cvt_pk_bf16_f32 v84, v20, v21
    v_cvt_pk_bf16_f32 v85, v22, v23
    v_mfma_f32_32x32x16_bf16 v[68:83], a[128:131], v[96:99], v[68:83]
    buffer_load_dwordx4 v[236:239], v1, s[4:7], s50 offen offset:0
    v_cvt_pk_bf16_f32 v86, v24, v25
    v_cvt_pk_bf16_f32 v87, v26, v27
    v_exp_f32 v28, v28
    v_exp_f32 v29, v29
    v_exp_f32 v30, v30
    v_exp_f32 v31, v31
    v_mfma_f32_32x32x16_bf16 v[52:67], a[136:139], v[84:87], v[52:67]
    s_add_u32 s52, s52, 4096
    v_exp_f32 v32, v32
    v_exp_f32 v33, v33
    v_exp_f32 v34, v34
    v_exp_f32 v35, v35
    v_cvt_pk_bf16_f32 v88, v28, v29
    v_cvt_pk_bf16_f32 v89, v30, v31
    v_cvt_pk_bf16_f32 v90, v32, v33
    v_cvt_pk_bf16_f32 v91, v34, v35
    v_mfma_f32_32x32x16_bf16 v[20:35], a[144:147], v[100:103], 0
    s_add_u32 s53, s53, 4096
    v_exp_f32 v36, v36
    v_exp_f32 v37, v37
    v_exp_f32 v38, v38
    v_exp_f32 v39, v39
    v_mfma_f32_32x32x8_bf16 v[20:35], a[216:217], v[108:109], v[20:35]
    s_add_u32 s33, s33, s28
    v_exp_f32 v40, v40
    v_exp_f32 v41, v41
    v_exp_f32 v42, v42
    v_exp_f32 v43, v43
    v_cvt_pk_bf16_f32 v92, v36, v37
    v_cvt_pk_bf16_f32 v93, v38, v39
    v_mfma_f32_32x32x16_bf16 v[52:67], a[140:143], v[88:91], v[52:67]
    s_mov_b32 m0, s53
    v_cvt_pk_bf16_f32 v94, v40, v41
    v_cvt_pk_bf16_f32 v95, v42, v43
    v_exp_f32 v44, v44
    v_exp_f32 v45, v45
    v_exp_f32 v46, v46
    v_exp_f32 v47, v47
    v_mfma_f32_32x32x16_bf16 v[68:83], a[136:139], v[92:95], v[68:83]
    buffer_load_dwordx4 v1, s[4:7], s52 offen offset:0 lds
    v_exp_f32 v48, v48
    v_exp_f32 v49, v49
    v_exp_f32 v50, v50
    v_exp_f32 v51, v51
    v_cvt_pk_bf16_f32 v96, v44, v45
    v_cvt_pk_bf16_f32 v97, v46, v47
    v_cvt_pk_bf16_f32 v98, v48, v49
    v_cvt_pk_bf16_f32 v99, v50, v51
    v_mfma_f32_32x32x16_bf16 v[36:51], a[144:147], v[104:107], 0
    buffer_load_dwordx4 v[240:243], v1, s[4:7], s50 offen offset:1024
    v_exp_f32 v20, v20
    v_exp_f32 v21, v21
    v_exp_f32 v22, v22
    v_exp_f32 v23, v23
    v_mfma_f32_32x32x8_bf16 v[36:51], a[216:217], v[110:111], v[36:51]
    s_add_u32 s33, s33, 7057408
    v_exp_f32 v24, v24
    v_exp_f32 v25, v25
    v_exp_f32 v26, v26
    v_exp_f32 v27, v27
    v_cvt_pk_bf16_f32 v84, v20, v21
    v_cvt_pk_bf16_f32 v85, v22, v23
    v_mfma_f32_32x32x16_bf16 v[68:83], a[140:143], v[96:99], v[68:83]
    s_mov_b32 m0, s53
    v_cvt_pk_bf16_f32 v86, v24, v25
    v_cvt_pk_bf16_f32 v87, v26, v27
    v_exp_f32 v28, v28
    v_exp_f32 v29, v29
    v_exp_f32 v30, v30
    v_exp_f32 v31, v31
    v_mfma_f32_32x32x16_bf16 v[52:67], a[148:151], v[84:87], v[52:67]
    buffer_load_dwordx4 v1, s[4:7], s52 offen offset:1024 lds
    v_exp_f32 v32, v32
    v_exp_f32 v33, v33
    v_exp_f32 v34, v34
    v_exp_f32 v35, v35
    v_cvt_pk_bf16_f32 v88, v28, v29
    v_cvt_pk_bf16_f32 v89, v30, v31
    v_cvt_pk_bf16_f32 v90, v32, v33
    v_cvt_pk_bf16_f32 v91, v34, v35
    v_mfma_f32_32x32x16_bf16 v[20:35], a[156:159], v[100:103], 0
    s_and_b32 s82, s25, 1
    v_exp_f32 v36, v36
    v_exp_f32 v37, v37
    v_exp_f32 v38, v38
    v_exp_f32 v39, v39
    v_mfma_f32_32x32x8_bf16 v[20:35], a[218:219], v[108:109], v[20:35]
    s_mul_i32 s82, s82, 8
    v_exp_f32 v40, v40
    v_exp_f32 v41, v41
    v_exp_f32 v42, v42
    v_exp_f32 v43, v43
    v_cvt_pk_bf16_f32 v92, v36, v37
    v_cvt_pk_bf16_f32 v93, v38, v39
    v_mfma_f32_32x32x16_bf16 v[52:67], a[152:155], v[88:91], v[52:67]
    s_mul_i32 s36, s20, 2
    v_cvt_pk_bf16_f32 v94, v40, v41
    v_cvt_pk_bf16_f32 v95, v42, v43
    v_exp_f32 v44, v44
    v_exp_f32 v45, v45
    v_exp_f32 v46, v46
    v_exp_f32 v47, v47
    v_mfma_f32_32x32x16_bf16 v[68:83], a[148:151], v[92:95], v[68:83]
    s_add_u32 s82, s82, s36
    v_exp_f32 v48, v48
    v_exp_f32 v49, v49
    v_exp_f32 v50, v50
    v_exp_f32 v51, v51
    v_cvt_pk_bf16_f32 v96, v44, v45
    v_cvt_pk_bf16_f32 v97, v46, v47
    v_cvt_pk_bf16_f32 v98, v48, v49
    v_cvt_pk_bf16_f32 v99, v50, v51
    v_mfma_f32_32x32x16_bf16 v[36:51], a[156:159], v[104:107], 0
    buffer_load_dwordx4 v[244:247], v1, s[4:7], s50 offen offset:2048
    v_exp_f32 v20, v20
    v_exp_f32 v21, v21
    v_exp_f32 v22, v22
    v_exp_f32 v23, v23
    v_mfma_f32_32x32x8_bf16 v[36:51], a[218:219], v[110:111], v[36:51]
    s_mul_i32 s80, s82, 20480
    v_exp_f32 v24, v24
    v_exp_f32 v25, v25
    v_exp_f32 v26, v26
    v_exp_f32 v27, v27
    v_cvt_pk_bf16_f32 v84, v20, v21
    v_cvt_pk_bf16_f32 v85, v22, v23
    v_mfma_f32_32x32x16_bf16 v[68:83], a[152:155], v[96:99], v[68:83]
    s_mov_b32 m0, s53
    v_cvt_pk_bf16_f32 v86, v24, v25
    v_cvt_pk_bf16_f32 v87, v26, v27
    v_exp_f32 v28, v28
    v_exp_f32 v29, v29
    v_exp_f32 v30, v30
    v_exp_f32 v31, v31
    v_mfma_f32_32x32x16_bf16 v[52:67], a[160:163], v[84:87], v[52:67]
    buffer_load_dwordx4 v1, s[4:7], s52 offen offset:2048 lds
    v_exp_f32 v32, v32
    v_exp_f32 v33, v33
    v_exp_f32 v34, v34
    v_exp_f32 v35, v35
    v_cvt_pk_bf16_f32 v88, v28, v29
    v_cvt_pk_bf16_f32 v89, v30, v31
    v_cvt_pk_bf16_f32 v90, v32, v33
    v_cvt_pk_bf16_f32 v91, v34, v35
    v_mfma_f32_32x32x16_bf16 v[20:35], a[168:171], v[100:103], 0
    s_mul_i32 s36, s21, 1703936
    v_exp_f32 v36, v36
    v_exp_f32 v37, v37
    v_exp_f32 v38, v38
    v_exp_f32 v39, v39
    v_mfma_f32_32x32x8_bf16 v[20:35], a[220:221], v[108:109], v[20:35]
    s_add_u32 s80, s80, s36
    v_exp_f32 v40, v40
    v_exp_f32 v41, v41
    v_exp_f32 v42, v42
    v_exp_f32 v43, v43
    v_cvt_pk_bf16_f32 v92, v36, v37
    v_cvt_pk_bf16_f32 v93, v38, v39
    v_mfma_f32_32x32x16_bf16 v[52:67], a[164:167], v[88:91], v[52:67]
    s_add_u32 s80, s80, 7602176
    v_cvt_pk_bf16_f32 v94, v40, v41
    v_cvt_pk_bf16_f32 v95, v42, v43
    v_exp_f32 v44, v44
    v_exp_f32 v45, v45
    v_exp_f32 v46, v46
    v_exp_f32 v47, v47
    v_mfma_f32_32x32x16_bf16 v[68:83], a[160:163], v[92:95], v[68:83]
    s_mul_i32 s84, s82, 57344
    v_exp_f32 v48, v48
    v_exp_f32 v49, v49
    v_exp_f32 v50, v50
    v_exp_f32 v51, v51
    v_cvt_pk_bf16_f32 v96, v44, v45
    v_cvt_pk_bf16_f32 v97, v46, v47
    v_cvt_pk_bf16_f32 v98, v48, v49
    v_cvt_pk_bf16_f32 v99, v50, v51
    v_mfma_f32_32x32x16_bf16 v[36:51], a[168:171], v[104:107], 0
    s_mul_i32 s36, s21, 1703936
    v_exp_f32 v20, v20
    v_exp_f32 v21, v21
    v_exp_f32 v22, v22
    v_exp_f32 v23, v23
    v_mfma_f32_32x32x8_bf16 v[36:51], a[220:221], v[110:111], v[36:51]
    s_add_u32 s84, s84, s36
    v_exp_f32 v24, v24
    v_exp_f32 v25, v25
    v_exp_f32 v26, v26
    v_exp_f32 v27, v27
    v_cvt_pk_bf16_f32 v84, v20, v21
    v_cvt_pk_bf16_f32 v85, v22, v23
    v_mfma_f32_32x32x16_bf16 v[68:83], a[164:167], v[96:99], v[68:83]
    s_mul_i32 s61, s63, 6144
    s_add_u32 s61, s61, 122880
    v_cvt_pk_bf16_f32 v86, v24, v25
    v_cvt_pk_bf16_f32 v87, v26, v27
    v_exp_f32 v28, v28
    v_exp_f32 v29, v29
    v_exp_f32 v30, v30
    v_exp_f32 v31, v31
    v_mfma_f32_32x32x16_bf16 v[52:67], a[172:175], v[84:87], v[52:67]
    v_lshl_add_u32 v114, v0, 4, s61
    s_add_u32 s63, s63, 1
    v_exp_f32 v32, v32
    v_exp_f32 v33, v33
    v_exp_f32 v34, v34
    v_exp_f32 v35, v35
    v_cvt_pk_bf16_f32 v88, v28, v29
    v_cvt_pk_bf16_f32 v89, v30, v31
    v_cvt_pk_bf16_f32 v90, v32, v33
    v_cvt_pk_bf16_f32 v91, v34, v35
    v_mfma_f32_32x32x16_bf16 v[20:35], a[180:183], v[100:103], 0
    s_and_b32 s63, s63, 3
    s_mul_i32 s61, s63, 3072
    v_exp_f32 v36, v36
    v_exp_f32 v37, v37
    v_exp_f32 v38, v38
    v_exp_f32 v39, v39
    v_mfma_f32_32x32x8_bf16 v[20:35], a[222:223], v[108:109], v[20:35]
    s_add_u32 s61, s61, 147456
    v_lshl_add_u32 v112, v0, 4, s61
    v_exp_f32 v40, v40
    v_exp_f32 v41, v41
    v_exp_f32 v42, v42
    v_exp_f32 v43, v43
    v_cvt_pk_bf16_f32 v92, v36, v37
    v_cvt_pk_bf16_f32 v93, v38, v39
    v_mfma_f32_32x32x16_bf16 v[52:67], a[176:179], v[88:91], v[52:67]
    v_lshl_add_u32 v113, v0, 3, s61
    v_cvt_pk_bf16_f32 v94, v40, v41
    v_cvt_pk_bf16_f32 v95, v42, v43
    v_exp_f32 v44, v44
    v_exp_f32 v45, v45
    v_exp_f32 v46, v46
    v_exp_f32 v47, v47
    v_mfma_f32_32x32x16_bf16 v[68:83], a[172:175], v[92:95], v[68:83]
    s_lshr_b32 s36, s26, 1
    v_exp_f32 v48, v48
    v_exp_f32 v49, v49
    v_exp_f32 v50, v50
    v_exp_f32 v51, v51
    v_cvt_pk_bf16_f32 v96, v44, v45
    v_cvt_pk_bf16_f32 v97, v46, v47
    v_cvt_pk_bf16_f32 v98, v48, v49
    v_cvt_pk_bf16_f32 v99, v50, v51
    v_mfma_f32_32x32x16_bf16 v[36:51], a[180:183], v[104:107], 0
    ds_read_b128 v[100:103], v112 offset:0
    v_exp_f32 v20, v20
    v_exp_f32 v21, v21
    v_exp_f32 v22, v22
    v_exp_f32 v23, v23
    v_mfma_f32_32x32x8_bf16 v[36:51], a[222:223], v[110:111], v[36:51]
    ds_read_b64 v[108:109], v113 offset:1024
    v_exp_f32 v24, v24
    v_exp_f32 v25, v25
    v_exp_f32 v26, v26
    v_exp_f32 v27, v27
    v_cvt_pk_bf16_f32 v84, v20, v21
    v_cvt_pk_bf16_f32 v85, v22, v23
    v_mfma_f32_32x32x16_bf16 v[68:83], a[176:179], v[96:99], v[68:83]
    ds_read_b128 v[104:107], v112 offset:1536
    v_cvt_pk_bf16_f32 v86, v24, v25
    v_cvt_pk_bf16_f32 v87, v26, v27
    v_exp_f32 v28, v28
    v_exp_f32 v29, v29
    v_exp_f32 v30, v30
    v_exp_f32 v31, v31
    v_mfma_f32_32x32x16_bf16 v[52:67], a[184:187], v[84:87], v[52:67]
    ds_read_b64 v[110:111], v113 offset:2560
    v_exp_f32 v32, v32
    v_exp_f32 v33, v33
    v_exp_f32 v34, v34
    v_exp_f32 v35, v35
    v_cvt_pk_bf16_f32 v88, v28, v29
    v_cvt_pk_bf16_f32 v89, v30, v31
    v_cvt_pk_bf16_f32 v90, v32, v33
    v_cvt_pk_bf16_f32 v91, v34, v35
    s_waitcnt lgkmcnt(2)
    v_mfma_f32_32x32x16_bf16 v[20:35], a[0:3], v[100:103], 0
    ds_read_b128 v[124:127], v114 offset:0
    v_exp_f32 v36, v36
    v_exp_f32 v37, v37
    v_exp_f32 v38, v38
    v_exp_f32 v39, v39
    v_mfma_f32_32x32x8_bf16 v[20:35], a[192:193], v[108:109], v[20:35]
    ds_read_b128 v[128:131], v114 offset:1024
    v_exp_f32 v40, v40
    v_exp_f32 v41, v41
    v_exp_f32 v42, v42
    v_exp_f32 v43, v43
    v_cvt_pk_bf16_f32 v92, v36, v37
    v_cvt_pk_bf16_f32 v93, v38, v39
    v_mfma_f32_32x32x16_bf16 v[52:67], a[188:191], v[88:91], v[52:67]
    ds_read_b128 v[132:135], v114 offset:2048
    ds_read_b128 v[136:139], v114 offset:3072
    v_cvt_pk_bf16_f32 v94, v40, v41
    v_cvt_pk_bf16_f32 v95, v42, v43
    v_exp_f32 v44, v44
    v_exp_f32 v45, v45
    v_exp_f32 v46, v46
    v_exp_f32 v47, v47
    v_mfma_f32_32x32x16_bf16 v[68:83], a[184:187], v[92:95], v[68:83]
    ds_read_b128 v[140:143], v114 offset:4096
    ds_read_b128 v[144:147], v114 offset:5120
    v_exp_f32 v48, v48
    v_exp_f32 v49, v49
    v_exp_f32 v50, v50
    v_exp_f32 v51, v51
    v_cvt_pk_bf16_f32 v96, v44, v45
    v_cvt_pk_bf16_f32 v97, v46, v47
    v_cvt_pk_bf16_f32 v98, v48, v49
    v_cvt_pk_bf16_f32 v99, v50, v51
    s_waitcnt lgkmcnt(0)
    v_mfma_f32_32x32x16_bf16 v[36:51], a[0:3], v[104:107], 0
    v_add_f32 v124, v124, v52
    v_add_f32 v125, v125, v53
    v_add_f32 v126, v126, v54
    v_add_f32 v127, v127, v55
    ds_write_b128 v114, v[124:127] offset:0
    v_exp_f32 v20, v20
    v_exp_f32 v21, v21
    v_exp_f32 v22, v22
    v_exp_f32 v23, v23
    v_mfma_f32_32x32x8_bf16 v[36:51], a[192:193], v[110:111], v[36:51]
    v_add_f32 v128, v128, v56
    v_add_f32 v129, v129, v57
    v_add_f32 v130, v130, v58
    v_add_f32 v131, v131, v59
    ds_write_b128 v114, v[128:131] offset:1024
    v_exp_f32 v24, v24
    v_exp_f32 v25, v25
    v_exp_f32 v26, v26
    v_exp_f32 v27, v27
    v_cvt_pk_bf16_f32 v84, v20, v21
    v_cvt_pk_bf16_f32 v85, v22, v23
    v_mfma_f32_32x32x16_bf16 v[68:83], a[188:191], v[96:99], v[68:83]
    v_add_f32 v132, v132, v60
    v_add_f32 v133, v133, v61
    v_add_f32 v134, v134, v62
    v_add_f32 v135, v135, v63
    ds_write_b128 v114, v[132:135] offset:2048
    v_cvt_pk_bf16_f32 v86, v24, v25
    v_cvt_pk_bf16_f32 v87, v26, v27
    v_exp_f32 v28, v28
    v_exp_f32 v29, v29
    v_exp_f32 v30, v30
    v_exp_f32 v31, v31
    v_mfma_f32_32x32x16_bf16 v[52:67], a[4:7], v[84:87], 0
    s_mul_i32 s36, s36, 7168
    v_exp_f32 v32, v32
    v_exp_f32 v33, v33
    v_exp_f32 v34, v34
    v_exp_f32 v35, v35
    v_cvt_pk_bf16_f32 v88, v28, v29
    v_cvt_pk_bf16_f32 v89, v30, v31
    v_cvt_pk_bf16_f32 v90, v32, v33
    v_cvt_pk_bf16_f32 v91, v34, v35
    v_mfma_f32_32x32x16_bf16 v[20:35], a[12:15], v[100:103], 0
    v_add_f32 v136, v136, v68
    v_add_f32 v137, v137, v69
    v_add_f32 v138, v138, v70
    v_add_f32 v139, v139, v71
    ds_write_b128 v114, v[136:139] offset:3072
    v_exp_f32 v36, v36
    v_exp_f32 v37, v37
    v_exp_f32 v38, v38
    v_exp_f32 v39, v39
    v_mfma_f32_32x32x8_bf16 v[20:35], a[194:195], v[108:109], v[20:35]
    v_add_f32 v140, v140, v72
    v_add_f32 v141, v141, v73
    v_add_f32 v142, v142, v74
    v_add_f32 v143, v143, v75
    ds_write_b128 v114, v[140:143] offset:4096
    v_exp_f32 v40, v40
    v_exp_f32 v41, v41
    v_exp_f32 v42, v42
    v_exp_f32 v43, v43
    v_cvt_pk_bf16_f32 v92, v36, v37
    v_cvt_pk_bf16_f32 v93, v38, v39
    v_mfma_f32_32x32x16_bf16 v[52:67], a[8:11], v[88:91], v[52:67]
    v_add_f32 v144, v144, v76
    v_add_f32 v145, v145, v77
    v_add_f32 v146, v146, v78
    v_add_f32 v147, v147, v79
    ds_write_b128 v114, v[144:147] offset:5120
    v_cvt_pk_bf16_f32 v94, v40, v41
    v_cvt_pk_bf16_f32 v95, v42, v43
    v_exp_f32 v44, v44
    v_exp_f32 v45, v45
    v_exp_f32 v46, v46
    v_exp_f32 v47, v47
    v_mfma_f32_32x32x16_bf16 v[68:83], a[4:7], v[92:95], 0
    s_add_u32 s84, s84, s36
    v_exp_f32 v48, v48
    v_exp_f32 v49, v49
    v_exp_f32 v50, v50
    v_exp_f32 v51, v51
    v_cvt_pk_bf16_f32 v96, v44, v45
    v_cvt_pk_bf16_f32 v97, v46, v47
    v_cvt_pk_bf16_f32 v98, v48, v49
    v_cvt_pk_bf16_f32 v99, v50, v51
    v_mfma_f32_32x32x16_bf16 v[36:51], a[12:15], v[104:107], 0
    buffer_load_dwordx4 v[248:251], v1, s[4:7], s50 offen offset:3072
    v_exp_f32 v20, v20
    v_exp_f32 v21, v21
    v_exp_f32 v22, v22
    v_exp_f32 v23, v23
    v_mfma_f32_32x32x8_bf16 v[36:51], a[194:195], v[110:111], v[36:51]
    s_add_u32 s84, s84, 7929856
    v_exp_f32 v24, v24
    v_exp_f32 v25, v25
    v_exp_f32 v26, v26
    v_exp_f32 v27, v27
    v_cvt_pk_bf16_f32 v84, v20, v21
    v_cvt_pk_bf16_f32 v85, v22, v23
    v_mfma_f32_32x32x16_bf16 v[68:83], a[8:11], v[96:99], v[68:83]
    s_mov_b32 m0, s53
    v_cvt_pk_bf16_f32 v86, v24, v25
    v_cvt_pk_bf16_f32 v87, v26, v27
    v_exp_f32 v28, v28
    v_exp_f32 v29, v29
    v_exp_f32 v30, v30
    v_exp_f32 v31, v31
    v_mfma_f32_32x32x16_bf16 v[52:67], a[16:19], v[84:87], v[52:67]
    buffer_load_dwordx4 v1, s[4:7], s52 offen offset:3072 lds
    v_exp_f32 v32, v32
    v_exp_f32 v33, v33
    v_exp_f32 v34, v34
    v_exp_f32 v35, v35
    v_cvt_pk_bf16_f32 v88, v28, v29
    v_cvt_pk_bf16_f32 v89, v30, v31
    v_cvt_pk_bf16_f32 v90, v32, v33
    v_cvt_pk_bf16_f32 v91, v34, v35
    v_mfma_f32_32x32x16_bf16 v[20:35], a[24:27], v[100:103], 0
    s_add_u32 s47, s47, 262144
    v_exp_f32 v36, v36
    v_exp_f32 v37, v37
    v_exp_f32 v38, v38
    v_exp_f32 v39, v39
    v_mfma_f32_32x32x8_bf16 v[20:35], a[196:197], v[108:109], v[20:35]
    s_and_b32 s86, s26, 1
    v_exp_f32 v40, v40
    v_exp_f32 v41, v41
    v_exp_f32 v42, v42
    v_exp_f32 v43, v43
    v_cvt_pk_bf16_f32 v92, v36, v37
    v_cvt_pk_bf16_f32 v93, v38, v39
    v_mfma_f32_32x32x16_bf16 v[52:67], a[20:23], v[88:91], v[52:67]
    buffer_load_dword v5, v121, s[4:7], s47 offen
    v_cvt_pk_bf16_f32 v94, v40, v41
    v_cvt_pk_bf16_f32 v95, v42, v43
    v_exp_f32 v44, v44
    v_exp_f32 v45, v45
    v_exp_f32 v46, v46
    v_exp_f32 v47, v47
    v_mfma_f32_32x32x16_bf16 v[68:83], a[16:19], v[92:95], v[68:83]
    s_mul_i32 s86, s86, 4096
    v_exp_f32 v48, v48
    v_exp_f32 v49, v49
    v_exp_f32 v50, v50
    v_exp_f32 v51, v51
    v_cvt_pk_bf16_f32 v96, v44, v45
    v_cvt_pk_bf16_f32 v97, v46, v47
    v_cvt_pk_bf16_f32 v98, v48, v49
    v_cvt_pk_bf16_f32 v99, v50, v51
    v_mfma_f32_32x32x16_bf16 v[36:51], a[24:27], v[104:107], 0
    s_waitcnt lgkmcnt(0)
    s_barrier
    s_add_u32 s50, s50, 4096
    v_exp_f32 v20, v20
    v_exp_f32 v21, v21
    v_exp_f32 v22, v22
    v_exp_f32 v23, v23
    v_mfma_f32_32x32x8_bf16 v[36:51], a[196:197], v[110:111], v[36:51]
    s_add_u32 s86, s86, s84
    v_exp_f32 v24, v24
    v_exp_f32 v25, v25
    v_exp_f32 v26, v26
    v_exp_f32 v27, v27
    v_cvt_pk_bf16_f32 v84, v20, v21
    v_cvt_pk_bf16_f32 v85, v22, v23
    v_mfma_f32_32x32x16_bf16 v[68:83], a[20:23], v[96:99], v[68:83]
    buffer_load_dwordx4 v[252:255], v1, s[4:7], s50 offen offset:0
    v_cvt_pk_bf16_f32 v86, v24, v25
    v_cvt_pk_bf16_f32 v87, v26, v27
    v_exp_f32 v28, v28
    v_exp_f32 v29, v29
    v_exp_f32 v30, v30
    v_exp_f32 v31, v31
    v_mfma_f32_32x32x16_bf16 v[52:67], a[28:31], v[84:87], v[52:67]
    buffer_load_dword v5, v121, s[4:7], s51 offen
    v_exp_f32 v32, v32
    v_exp_f32 v33, v33
    v_exp_f32 v34, v34
    v_exp_f32 v35, v35
    v_cvt_pk_bf16_f32 v88, v28, v29
    v_cvt_pk_bf16_f32 v89, v30, v31
    v_cvt_pk_bf16_f32 v90, v32, v33
    v_cvt_pk_bf16_f32 v91, v34, v35
    v_mfma_f32_32x32x16_bf16 v[20:35], a[36:39], v[100:103], 0
    s_and_b32 s36, s26, 1
    v_exp_f32 v36, v36
    v_exp_f32 v37, v37
    v_exp_f32 v38, v38
    v_exp_f32 v39, v39
    v_mfma_f32_32x32x8_bf16 v[20:35], a[198:199], v[108:109], v[20:35]
    s_lshl_b32 s36, s36, 3
    v_exp_f32 v40, v40
    v_exp_f32 v41, v41
    v_exp_f32 v42, v42
    v_exp_f32 v43, v43
    v_cvt_pk_bf16_f32 v92, v36, v37
    v_cvt_pk_bf16_f32 v93, v38, v39
    v_mfma_f32_32x32x16_bf16 v[52:67], a[32:35], v[88:91], v[52:67]
    s_add_u32 s84, s84, s36
    v_cvt_pk_bf16_f32 v94, v40, v41
    v_cvt_pk_bf16_f32 v95, v42, v43
    v_exp_f32 v44, v44
    v_exp_f32 v45, v45
    v_exp_f32 v46, v46
    v_exp_f32 v47, v47
    v_mfma_f32_32x32x16_bf16 v[68:83], a[28:31], v[92:95], v[68:83]
    s_mul_i32 s82, s82, 4096
    v_exp_f32 v48, v48
    v_exp_f32 v49, v49
    v_exp_f32 v50, v50
    v_exp_f32 v51, v51
    v_cvt_pk_bf16_f32 v96, v44, v45
    v_cvt_pk_bf16_f32 v97, v46, v47
    v_cvt_pk_bf16_f32 v98, v48, v49
    v_cvt_pk_bf16_f32 v99, v50, v51
    v_mfma_f32_32x32x16_bf16 v[36:51], a[36:39], v[104:107], 0
    s_mul_i32 s61, s20, 6144
    v_exp_f32 v20, v20
    v_exp_f32 v21, v21
    v_exp_f32 v22, v22
    v_exp_f32 v23, v23
    v_mfma_f32_32x32x8_bf16 v[36:51], a[198:199], v[110:111], v[36:51]
    s_mul_i32 s36, s21, 1703936
    v_exp_f32 v24, v24
    v_exp_f32 v25, v25
    v_exp_f32 v26, v26
    v_exp_f32 v27, v27
    v_cvt_pk_bf16_f32 v84, v20, v21
    v_cvt_pk_bf16_f32 v85, v22, v23
    v_mfma_f32_32x32x16_bf16 v[68:83], a[32:35], v[96:99], v[68:83]
    s_add_u32 s61, s61, 122880
    v_cvt_pk_bf16_f32 v86, v24, v25
    v_cvt_pk_bf16_f32 v87, v26, v27
    v_exp_f32 v28, v28
    v_exp_f32 v29, v29
    v_exp_f32 v30, v30
    v_exp_f32 v31, v31
    v_mfma_f32_32x32x16_bf16 v[52:67], a[40:43], v[84:87], v[52:67]
    v_lshl_add_u32 v114, v0, 4, s61
    v_exp_f32 v32, v32
    v_exp_f32 v33, v33
    v_exp_f32 v34, v34
    v_exp_f32 v35, v35
    v_cvt_pk_bf16_f32 v88, v28, v29
    v_cvt_pk_bf16_f32 v89, v30, v31
    v_cvt_pk_bf16_f32 v90, v32, v33
    v_cvt_pk_bf16_f32 v91, v34, v35
    v_mfma_f32_32x32x16_bf16 v[20:35], a[48:51], v[100:103], 0
    s_add_u32 s82, s82, s36
    v_exp_f32 v36, v36
    v_exp_f32 v37, v37
    v_exp_f32 v38, v38
    v_exp_f32 v39, v39
    v_mfma_f32_32x32x8_bf16 v[20:35], a[200:201], v[108:109], v[20:35]
    s_add_u32 s82, s82, 8912896
    v_exp_f32 v40, v40
    v_exp_f32 v41, v41
    v_exp_f32 v42, v42
    v_exp_f32 v43, v43
    v_cvt_pk_bf16_f32 v92, v36, v37
    v_cvt_pk_bf16_f32 v93, v38, v39
    v_mfma_f32_32x32x16_bf16 v[52:67], a[44:47], v[88:91], v[52:67]
    s_and_b32 s83, s25, 1
    v_cvt_pk_bf16_f32 v94, v40, v41
    v_cvt_pk_bf16_f32 v95, v42, v43
    v_exp_f32 v44, v44
    v_exp_f32 v45, v45
    v_exp_f32 v46, v46
    v_exp_f32 v47, v47
    v_mfma_f32_32x32x16_bf16 v[68:83], a[40:43], v[92:95], v[68:83]
    s_mul_i32 s83, s83, 8
    v_exp_f32 v48, v48
    v_exp_f32 v49, v49
    v_exp_f32 v50, v50
    v_exp_f32 v51, v51
    v_cvt_pk_bf16_f32 v96, v44, v45
    v_cvt_pk_bf16_f32 v97, v46, v47
    v_cvt_pk_bf16_f32 v98, v48, v49
    v_cvt_pk_bf16_f32 v99, v50, v51
    v_mfma_f32_32x32x16_bf16 v[36:51], a[48:51], v[104:107], 0
    ds_read_b128 v[124:127], v114 offset:0
    v_exp_f32 v20, v20
    v_exp_f32 v21, v21
    v_exp_f32 v22, v22
    v_exp_f32 v23, v23
    v_mfma_f32_32x32x8_bf16 v[36:51], a[200:201], v[110:111], v[36:51]
    ds_read_b128 v[128:131], v114 offset:1024
    v_exp_f32 v24, v24
    v_exp_f32 v25, v25
    v_exp_f32 v26, v26
    v_exp_f32 v27, v27
    v_cvt_pk_bf16_f32 v84, v20, v21
    v_cvt_pk_bf16_f32 v85, v22, v23
    v_mfma_f32_32x32x16_bf16 v[68:83], a[44:47], v[96:99], v[68:83]
    ds_read_b128 v[132:135], v114 offset:2048
    v_cvt_pk_bf16_f32 v86, v24, v25
    v_cvt_pk_bf16_f32 v87, v26, v27
    v_exp_f32 v28, v28
    v_exp_f32 v29, v29
    v_exp_f32 v30, v30
    v_exp_f32 v31, v31
    v_mfma_f32_32x32x16_bf16 v[52:67], a[52:55], v[84:87], v[52:67]
    ds_read_b128 v[136:139], v114 offset:3072
    v_exp_f32 v32, v32
    v_exp_f32 v33, v33
    v_exp_f32 v34, v34
    v_exp_f32 v35, v35
    v_cvt_pk_bf16_f32 v88, v28, v29
    v_cvt_pk_bf16_f32 v89, v30, v31
    v_cvt_pk_bf16_f32 v90, v32, v33
    v_cvt_pk_bf16_f32 v91, v34, v35
    v_mfma_f32_32x32x16_bf16 v[20:35], a[60:63], v[100:103], 0
    ds_read_b128 v[140:143], v114 offset:4096
    v_exp_f32 v36, v36
    v_exp_f32 v37, v37
    v_exp_f32 v38, v38
    v_exp_f32 v39, v39
    v_mfma_f32_32x32x8_bf16 v[20:35], a[202:203], v[108:109], v[20:35]
    ds_read_b128 v[144:147], v114 offset:5120
    v_exp_f32 v40, v40
    v_exp_f32 v41, v41
    v_exp_f32 v42, v42
    v_exp_f32 v43, v43
    v_cvt_pk_bf16_f32 v92, v36, v37
    v_cvt_pk_bf16_f32 v93, v38, v39
    v_mfma_f32_32x32x16_bf16 v[52:67], a[56:59], v[88:91], v[52:67]
    s_mul_i32 s36, s20, 2
    v_cvt_pk_bf16_f32 v94, v40, v41
    v_cvt_pk_bf16_f32 v95, v42, v43
    v_exp_f32 v44, v44
    v_exp_f32 v45, v45
    v_exp_f32 v46, v46
    v_exp_f32 v47, v47
    v_mfma_f32_32x32x16_bf16 v[68:83], a[52:55], v[92:95], v[68:83]
    s_add_u32 s83, s83, s36
    v_exp_f32 v48, v48
    v_exp_f32 v49, v49
    v_exp_f32 v50, v50
    v_exp_f32 v51, v51
    v_cvt_pk_bf16_f32 v96, v44, v45
    v_cvt_pk_bf16_f32 v97, v46, v47
    v_cvt_pk_bf16_f32 v98, v48, v49
    v_cvt_pk_bf16_f32 v99, v50, v51
    v_mfma_f32_32x32x16_bf16 v[36:51], a[60:63], v[104:107], 0
    s_add_u32 s51, s51, 2048
    v_exp_f32 v20, v20
    v_exp_f32 v21, v21
    v_exp_f32 v22, v22
    v_exp_f32 v23, v23
    v_mfma_f32_32x32x8_bf16 v[36:51], a[202:203], v[110:111], v[36:51]
    s_add_u32 s83, s83, 1
    v_exp_f32 v24, v24
    v_exp_f32 v25, v25
    v_exp_f32 v26, v26
    v_exp_f32 v27, v27
    v_cvt_pk_bf16_f32 v84, v20, v21
    v_cvt_pk_bf16_f32 v85, v22, v23
    v_mfma_f32_32x32x16_bf16 v[68:83], a[56:59], v[96:99], v[68:83]
    s_add_u32 s52, s52, 4096
    v_cvt_pk_bf16_f32 v86, v24, v25
    v_cvt_pk_bf16_f32 v87, v26, v27
    v_exp_f32 v28, v28
    v_exp_f32 v29, v29
    v_exp_f32 v30, v30
    v_exp_f32 v31, v31
    v_mfma_f32_32x32x16_bf16 v[52:67], a[64:67], v[84:87], v[52:67]
    s_add_u32 s53, s53, 4096
    v_exp_f32 v32, v32
    v_exp_f32 v33, v33
    v_exp_f32 v34, v34
    v_exp_f32 v35, v35
    v_cvt_pk_bf16_f32 v88, v28, v29
    v_cvt_pk_bf16_f32 v89, v30, v31
    v_cvt_pk_bf16_f32 v90, v32, v33
    v_cvt_pk_bf16_f32 v91, v34, v35
    v_mfma_f32_32x32x16_bf16 v[20:35], a[72:75], v[100:103], 0
    s_mov_b32 m0, s53
    v_exp_f32 v36, v36
    v_exp_f32 v37, v37
    v_exp_f32 v38, v38
    v_exp_f32 v39, v39
    v_mfma_f32_32x32x8_bf16 v[20:35], a[204:205], v[108:109], v[20:35]
    s_mul_i32 s81, s83, 20480
    v_exp_f32 v40, v40
    v_exp_f32 v41, v41
    v_exp_f32 v42, v42
    v_exp_f32 v43, v43
    v_cvt_pk_bf16_f32 v92, v36, v37
    v_cvt_pk_bf16_f32 v93, v38, v39
    v_mfma_f32_32x32x16_bf16 v[52:67], a[68:71], v[88:91], v[52:67]
    buffer_load_dwordx4 v1, s[4:7], s52 offen offset:0 lds
    v_cvt_pk_bf16_f32 v94, v40, v41
    v_cvt_pk_bf16_f32 v95, v42, v43
    v_exp_f32 v44, v44
    v_exp_f32 v45, v45
    v_exp_f32 v46, v46
    v_exp_f32 v47, v47
    v_mfma_f32_32x32x16_bf16 v[68:83], a[64:67], v[92:95], v[68:83]
    buffer_load_dwordx4 a[224:227], v1, s[4:7], s50 offen offset:1024
    v_exp_f32 v48, v48
    v_exp_f32 v49, v49
    v_exp_f32 v50, v50
    v_exp_f32 v51, v51
    v_cvt_pk_bf16_f32 v96, v44, v45
    v_cvt_pk_bf16_f32 v97, v46, v47
    v_cvt_pk_bf16_f32 v98, v48, v49
    v_cvt_pk_bf16_f32 v99, v50, v51
    v_mfma_f32_32x32x16_bf16 v[36:51], a[72:75], v[104:107], 0
    buffer_load_dword v5, v121, s[4:7], s51 offen
    s_add_u32 s51, s51, 2048
    v_exp_f32 v20, v20
    v_exp_f32 v21, v21
    v_exp_f32 v22, v22
    v_exp_f32 v23, v23
    v_mfma_f32_32x32x8_bf16 v[36:51], a[204:205], v[110:111], v[36:51]
    s_mul_i32 s53, s20, 5120
    s_add_u32 s53, s53, 102400
    v_exp_f32 v24, v24
    v_exp_f32 v25, v25
    v_exp_f32 v26, v26
    v_exp_f32 v27, v27
    v_cvt_pk_bf16_f32 v84, v20, v21
    v_cvt_pk_bf16_f32 v85, v22, v23
    v_mfma_f32_32x32x16_bf16 v[68:83], a[68:71], v[96:99], v[68:83]
    s_mul_i32 s52, s26, 143360
    s_add_u32 s52, s52, s53
    v_cvt_pk_bf16_f32 v86, v24, v25
    v_cvt_pk_bf16_f32 v87, v26, v27
    v_exp_f32 v28, v28
    v_exp_f32 v29, v29
    v_exp_f32 v30, v30
    v_exp_f32 v31, v31
    v_mfma_f32_32x32x16_bf16 v[52:67], a[76:79], v[84:87], v[52:67]
    s_add_u32 s52, s52, 4071424
    s_mov_b32 m0, s53
    v_exp_f32 v32, v32
    v_exp_f32 v33, v33
    v_exp_f32 v34, v34
    v_exp_f32 v35, v35
    v_cvt_pk_bf16_f32 v88, v28, v29
    v_cvt_pk_bf16_f32 v89, v30, v31
    v_cvt_pk_bf16_f32 v90, v32, v33
    v_cvt_pk_bf16_f32 v91, v34, v35
    v_mfma_f32_32x32x16_bf16 v[20:35], a[84:87], v[100:103], 0
    s_waitcnt vmcnt(48)
    buffer_load_dwordx4 v1, s[4:7], s52 offen offset:0 lds
    v_exp_f32 v36, v36
    v_exp_f32 v37, v37
    v_exp_f32 v38, v38
    v_exp_f32 v39, v39
    v_mfma_f32_32x32x8_bf16 v[20:35], a[206:207], v[108:109], v[20:35]
    s_mul_i32 s36, s21, 1703936
    v_exp_f32 v40, v40
    v_exp_f32 v41, v41
    v_exp_f32 v42, v42
    v_exp_f32 v43, v43
    v_cvt_pk_bf16_f32 v92, v36, v37
    v_cvt_pk_bf16_f32 v93, v38, v39
    v_mfma_f32_32x32x16_bf16 v[52:67], a[80:83], v[88:91], v[52:67]
    global_load_dword v5, v115, s[42:43]
    v_cvt_pk_bf16_f32 v94, v40, v41
    v_cvt_pk_bf16_f32 v95, v42, v43
    v_exp_f32 v44, v44
    v_exp_f32 v45, v45
    v_exp_f32 v46, v46
    v_exp_f32 v47, v47
    v_mfma_f32_32x32x16_bf16 v[68:83], a[76:79], v[92:95], v[68:83]
    s_add_u32 s81, s81, s36
    v_exp_f32 v48, v48
    v_exp_f32 v49, v49
    v_exp_f32 v50, v50
    v_exp_f32 v51, v51
    v_cvt_pk_bf16_f32 v96, v44, v45
    v_cvt_pk_bf16_f32 v97, v46, v47
    v_cvt_pk_bf16_f32 v98, v48, v49
    v_cvt_pk_bf16_f32 v99, v50, v51
    v_mfma_f32_32x32x16_bf16 v[36:51], a[84:87], v[104:107], 0
    buffer_load_dwordx4 a[228:231], v1, s[4:7], s50 offen offset:2048
    v_exp_f32 v20, v20
    v_exp_f32 v21, v21
    v_exp_f32 v22, v22
    v_exp_f32 v23, v23
    v_mfma_f32_32x32x8_bf16 v[36:51], a[206:207], v[110:111], v[36:51]
    s_add_u32 s81, s81, 7602176
    v_exp_f32 v24, v24
    v_exp_f32 v25, v25
    v_exp_f32 v26, v26
    v_exp_f32 v27, v27
    v_cvt_pk_bf16_f32 v84, v20, v21
    v_cvt_pk_bf16_f32 v85, v22, v23
    v_mfma_f32_32x32x16_bf16 v[68:83], a[80:83], v[96:99], v[68:83]
    buffer_load_dword v5, v121, s[4:7], s51 offen
    v_cvt_pk_bf16_f32 v86, v24, v25
    v_cvt_pk_bf16_f32 v87, v26, v27
    v_exp_f32 v28, v28
    v_exp_f32 v29, v29
    v_exp_f32 v30, v30
    v_exp_f32 v31, v31
    v_mfma_f32_32x32x16_bf16 v[52:67], a[88:91], v[84:87], v[52:67]
    s_mul_i32 s85, s83, 57344
    v_exp_f32 v32, v32
    v_exp_f32 v33, v33
    v_exp_f32 v34, v34
    v_exp_f32 v35, v35
    v_cvt_pk_bf16_f32 v88, v28, v29
    v_cvt_pk_bf16_f32 v89, v30, v31
    v_cvt_pk_bf16_f32 v90, v32, v33
    v_cvt_pk_bf16_f32 v91, v34, v35
    v_mfma_f32_32x32x16_bf16 v[20:35], a[96:99], v[100:103], 0
    s_mul_i32 s36, s21, 1703936
    v_exp_f32 v36, v36
    v_exp_f32 v37, v37
    v_exp_f32 v38, v38
    v_exp_f32 v39, v39
    v_mfma_f32_32x32x8_bf16 v[20:35], a[208:209], v[108:109], v[20:35]
    s_add_u32 s85, s85, s36
    v_exp_f32 v40, v40
    v_exp_f32 v41, v41
    v_exp_f32 v42, v42
    v_exp_f32 v43, v43
    v_cvt_pk_bf16_f32 v92, v36, v37
    v_cvt_pk_bf16_f32 v93, v38, v39
    v_mfma_f32_32x32x16_bf16 v[52:67], a[92:95], v[88:91], v[52:67]
    s_lshr_b32 s36, s26, 1
    v_cvt_pk_bf16_f32 v94, v40, v41
    v_cvt_pk_bf16_f32 v95, v42, v43
    v_exp_f32 v44, v44
    v_exp_f32 v45, v45
    v_exp_f32 v46, v46
    v_exp_f32 v47, v47
    v_mfma_f32_32x32x16_bf16 v[68:83], a[88:91], v[92:95], v[68:83]
    s_mul_i32 s36, s36, 7168
    v_exp_f32 v48, v48
    v_exp_f32 v49, v49
    v_exp_f32 v50, v50
    v_exp_f32 v51, v51
    v_cvt_pk_bf16_f32 v96, v44, v45
    v_cvt_pk_bf16_f32 v97, v46, v47
    v_cvt_pk_bf16_f32 v98, v48, v49
    v_cvt_pk_bf16_f32 v99, v50, v51
    v_mfma_f32_32x32x16_bf16 v[36:51], a[96:99], v[104:107], 0
    s_add_u32 s51, s51, 2048
    v_exp_f32 v20, v20
    v_exp_f32 v21, v21
    v_exp_f32 v22, v22
    v_exp_f32 v23, v23
    v_mfma_f32_32x32x8_bf16 v[36:51], a[208:209], v[110:111], v[36:51]
    s_add_u32 s85, s85, s36
    v_exp_f32 v24, v24
    v_exp_f32 v25, v25
    v_exp_f32 v26, v26
    v_exp_f32 v27, v27
    v_cvt_pk_bf16_f32 v84, v20, v21
    v_cvt_pk_bf16_f32 v85, v22, v23
    v_mfma_f32_32x32x16_bf16 v[68:83], a[92:95], v[96:99], v[68:83]
    s_mov_b32 m0, s53
    v_cvt_pk_bf16_f32 v86, v24, v25
    v_cvt_pk_bf16_f32 v87, v26, v27
    v_exp_f32 v28, v28
    v_exp_f32 v29, v29
    v_exp_f32 v30, v30
    v_exp_f32 v31, v31
    v_mfma_f32_32x32x16_bf16 v[52:67], a[100:103], v[84:87], v[52:67]
    buffer_load_dwordx4 v1, s[4:7], s52 offen offset:1024 lds
    v_exp_f32 v32, v32
    v_exp_f32 v33, v33
    v_exp_f32 v34, v34
    v_exp_f32 v35, v35
    v_cvt_pk_bf16_f32 v88, v28, v29
    v_cvt_pk_bf16_f32 v89, v30, v31
    v_cvt_pk_bf16_f32 v90, v32, v33
    v_cvt_pk_bf16_f32 v91, v34, v35
    v_mfma_f32_32x32x16_bf16 v[20:35], a[108:111], v[100:103], 0
    s_add_u32 s47, s47, 262144
    buffer_load_dwordx4 a[232:235], v1, s[4:7], s50 offen offset:3072
    v_exp_f32 v36, v36
    v_exp_f32 v37, v37
    v_exp_f32 v38, v38
    v_exp_f32 v39, v39
    v_mfma_f32_32x32x8_bf16 v[20:35], a[210:211], v[108:109], v[20:35]
    s_add_u32 s85, s85, 7929856
    v_exp_f32 v40, v40
    v_exp_f32 v41, v41
    v_exp_f32 v42, v42
    v_exp_f32 v43, v43
    v_cvt_pk_bf16_f32 v92, v36, v37
    v_cvt_pk_bf16_f32 v93, v38, v39
    v_mfma_f32_32x32x16_bf16 v[52:67], a[104:107], v[88:91], v[52:67]
    buffer_load_dword v5, v121, s[4:7], s47 offen
    v_cvt_pk_bf16_f32 v94, v40, v41
    v_cvt_pk_bf16_f32 v95, v42, v43
    v_exp_f32 v44, v44
    v_exp_f32 v45, v45
    v_exp_f32 v46, v46
    v_exp_f32 v47, v47
    v_mfma_f32_32x32x16_bf16 v[68:83], a[100:103], v[92:95], v[68:83]
    s_and_b32 s87, s26, 1
    v_exp_f32 v48, v48
    v_exp_f32 v49, v49
    v_exp_f32 v50, v50
    v_exp_f32 v51, v51
    v_cvt_pk_bf16_f32 v96, v44, v45
    v_cvt_pk_bf16_f32 v97, v46, v47
    v_cvt_pk_bf16_f32 v98, v48, v49
    v_cvt_pk_bf16_f32 v99, v50, v51
    v_mfma_f32_32x32x16_bf16 v[36:51], a[108:111], v[104:107], 0
    buffer_load_dword v5, v121, s[4:7], s51 offen
    v_exp_f32 v20, v20
    v_exp_f32 v21, v21
    v_exp_f32 v22, v22
    v_exp_f32 v23, v23
    v_mfma_f32_32x32x8_bf16 v[36:51], a[210:211], v[110:111], v[36:51]
    s_mul_i32 s87, s87, 4096
    v_exp_f32 v24, v24
    v_exp_f32 v25, v25
    v_exp_f32 v26, v26
    v_exp_f32 v27, v27
    v_cvt_pk_bf16_f32 v84, v20, v21
    v_cvt_pk_bf16_f32 v85, v22, v23
    v_mfma_f32_32x32x16_bf16 v[68:83], a[104:107], v[96:99], v[68:83]
    s_add_u32 s51, s51, 2048
    v_cvt_pk_bf16_f32 v86, v24, v25
    v_cvt_pk_bf16_f32 v87, v26, v27
    v_exp_f32 v28, v28
    v_exp_f32 v29, v29
    v_exp_f32 v30, v30
    v_exp_f32 v31, v31
    v_mfma_f32_32x32x16_bf16 v[52:67], a[112:115], v[84:87], v[52:67]
    s_mov_b32 m0, s53
    v_exp_f32 v32, v32
    v_exp_f32 v33, v33
    v_exp_f32 v34, v34
    v_exp_f32 v35, v35
    v_cvt_pk_bf16_f32 v88, v28, v29
    v_cvt_pk_bf16_f32 v89, v30, v31
    v_cvt_pk_bf16_f32 v90, v32, v33
    v_cvt_pk_bf16_f32 v91, v34, v35
    v_mfma_f32_32x32x16_bf16 v[20:35], a[120:123], v[100:103], 0
    buffer_load_dwordx4 v1, s[4:7], s52 offen offset:2048 lds
    v_exp_f32 v36, v36
    v_exp_f32 v37, v37
    v_exp_f32 v38, v38
    v_exp_f32 v39, v39
    v_mfma_f32_32x32x8_bf16 v[20:35], a[212:213], v[108:109], v[20:35]
    s_add_u32 s87, s87, s85
    v_exp_f32 v40, v40
    v_exp_f32 v41, v41
    v_exp_f32 v42, v42
    v_exp_f32 v43, v43
    v_cvt_pk_bf16_f32 v92, v36, v37
    v_cvt_pk_bf16_f32 v93, v38, v39
    v_mfma_f32_32x32x16_bf16 v[52:67], a[116:119], v[88:91], v[52:67]
    s_and_b32 s36, s26, 1
    v_cvt_pk_bf16_f32 v94, v40, v41
    v_cvt_pk_bf16_f32 v95, v42, v43
    v_exp_f32 v44, v44
    v_exp_f32 v45, v45
    v_exp_f32 v46, v46
    v_exp_f32 v47, v47
    v_mfma_f32_32x32x16_bf16 v[68:83], a[112:115], v[92:95], v[68:83]
    s_lshl_b32 s36, s36, 3
    v_exp_f32 v48, v48
    v_exp_f32 v49, v49
    v_exp_f32 v50, v50
    v_exp_f32 v51, v51
    v_cvt_pk_bf16_f32 v96, v44, v45
    v_cvt_pk_bf16_f32 v97, v46, v47
    v_cvt_pk_bf16_f32 v98, v48, v49
    v_cvt_pk_bf16_f32 v99, v50, v51
    v_mfma_f32_32x32x16_bf16 v[36:51], a[120:123], v[104:107], 0
    s_add_u32 s50, s50, 4096
    v_exp_f32 v20, v20
    v_exp_f32 v21, v21
    v_exp_f32 v22, v22
    v_exp_f32 v23, v23
    v_mfma_f32_32x32x8_bf16 v[36:51], a[212:213], v[110:111], v[36:51]
    s_add_u32 s85, s85, s36
    v_exp_f32 v24, v24
    v_exp_f32 v25, v25
    v_exp_f32 v26, v26
    v_exp_f32 v27, v27
    v_cvt_pk_bf16_f32 v84, v20, v21
    v_cvt_pk_bf16_f32 v85, v22, v23
    v_mfma_f32_32x32x16_bf16 v[68:83], a[116:119], v[96:99], v[68:83]
    buffer_load_dwordx4 a[236:239], v1, s[4:7], s50 offen offset:0
    v_cvt_pk_bf16_f32 v86, v24, v25
    v_cvt_pk_bf16_f32 v87, v26, v27
    v_exp_f32 v28, v28
    v_exp_f32 v29, v29
    v_exp_f32 v30, v30
    v_exp_f32 v31, v31
    v_mfma_f32_32x32x16_bf16 v[52:67], a[124:127], v[84:87], v[52:67]
    buffer_load_dword v5, v121, s[4:7], s51 offen
    v_exp_f32 v32, v32
    v_exp_f32 v33, v33
    v_exp_f32 v34, v34
    v_exp_f32 v35, v35
    v_cvt_pk_bf16_f32 v88, v28, v29
    v_cvt_pk_bf16_f32 v89, v30, v31
    v_cvt_pk_bf16_f32 v90, v32, v33
    v_cvt_pk_bf16_f32 v91, v34, v35
    v_mfma_f32_32x32x16_bf16 v[20:35], a[132:135], v[100:103], 0
    s_mul_i32 s83, s83, 4096
    v_exp_f32 v36, v36
    v_exp_f32 v37, v37
    v_exp_f32 v38, v38
    v_exp_f32 v39, v39
    v_mfma_f32_32x32x8_bf16 v[20:35], a[214:215], v[108:109], v[20:35]
    s_mul_i32 s36, s21, 1703936
    v_exp_f32 v40, v40
    v_exp_f32 v41, v41
    v_exp_f32 v42, v42
    v_exp_f32 v43, v43
    v_cvt_pk_bf16_f32 v92, v36, v37
    v_cvt_pk_bf16_f32 v93, v38, v39
    v_mfma_f32_32x32x16_bf16 v[52:67], a[128:131], v[88:91], v[52:67]
    s_add_u32 s83, s83, s36
    v_cvt_pk_bf16_f32 v94, v40, v41
    v_cvt_pk_bf16_f32 v95, v42, v43
    v_exp_f32 v44, v44
    v_exp_f32 v45, v45
    v_exp_f32 v46, v46
    v_exp_f32 v47, v47
    v_mfma_f32_32x32x16_bf16 v[68:83], a[124:127], v[92:95], v[68:83]
    s_add_u32 s83, s83, 8912896
    v_exp_f32 v48, v48
    v_exp_f32 v49, v49
    v_exp_f32 v50, v50
    v_exp_f32 v51, v51
    v_cvt_pk_bf16_f32 v96, v44, v45
    v_cvt_pk_bf16_f32 v97, v46, v47
    v_cvt_pk_bf16_f32 v98, v48, v49
    v_cvt_pk_bf16_f32 v99, v50, v51
    v_mfma_f32_32x32x16_bf16 v[36:51], a[132:135], v[104:107], 0
    s_add_u32 s51, s51, 2048
    v_exp_f32 v20, v20
    v_exp_f32 v21, v21
    v_exp_f32 v22, v22
    v_exp_f32 v23, v23
    v_mfma_f32_32x32x8_bf16 v[36:51], a[214:215], v[110:111], v[36:51]
    s_mul_i32 s88, s25, 256
    v_exp_f32 v24, v24
    v_exp_f32 v25, v25
    v_exp_f32 v26, v26
    v_exp_f32 v27, v27
    v_cvt_pk_bf16_f32 v84, v20, v21
    v_cvt_pk_bf16_f32 v85, v22, v23
    v_mfma_f32_32x32x16_bf16 v[68:83], a[128:131], v[96:99], v[68:83]
    s_mov_b32 m0, s53
    v_cvt_pk_bf16_f32 v86, v24, v25
    v_cvt_pk_bf16_f32 v87, v26, v27
    v_exp_f32 v28, v28
    v_exp_f32 v29, v29
    v_exp_f32 v30, v30
    v_exp_f32 v31, v31
    v_mfma_f32_32x32x16_bf16 v[52:67], a[136:139], v[84:87], v[52:67]
    buffer_load_dwordx4 v1, s[4:7], s52 offen offset:3072 lds
    v_exp_f32 v32, v32
    v_exp_f32 v33, v33
    v_exp_f32 v34, v34
    v_exp_f32 v35, v35
    v_cvt_pk_bf16_f32 v88, v28, v29
    v_cvt_pk_bf16_f32 v89, v30, v31
    v_cvt_pk_bf16_f32 v90, v32, v33
    v_cvt_pk_bf16_f32 v91, v34, v35
    v_mfma_f32_32x32x16_bf16 v[20:35], a[144:147], v[100:103], 0
    s_waitcnt vmcnt(48)
    buffer_load_dwordx4 a[240:243], v1, s[4:7], s50 offen offset:1024
    v_exp_f32 v36, v36
    v_exp_f32 v37, v37
    v_exp_f32 v38, v38
    v_exp_f32 v39, v39
    v_mfma_f32_32x32x8_bf16 v[20:35], a[216:217], v[108:109], v[20:35]
    s_lshr_b32 s36, s20, 1
    v_exp_f32 v40, v40
    v_exp_f32 v41, v41
    v_exp_f32 v42, v42
    v_exp_f32 v43, v43
    v_cvt_pk_bf16_f32 v92, v36, v37
    v_cvt_pk_bf16_f32 v93, v38, v39
    v_mfma_f32_32x32x16_bf16 v[52:67], a[140:143], v[88:91], v[52:67]
    s_mul_i32 s36, s36, 128
    v_cvt_pk_bf16_f32 v94, v40, v41
    v_cvt_pk_bf16_f32 v95, v42, v43
    v_exp_f32 v44, v44
    v_exp_f32 v45, v45
    v_exp_f32 v46, v46
    v_exp_f32 v47, v47
    v_mfma_f32_32x32x16_bf16 v[68:83], a[136:139], v[92:95], v[68:83]
    s_add_u32 s88, s88, s36
    v_exp_f32 v48, v48
    v_exp_f32 v49, v49
    v_exp_f32 v50, v50
    v_exp_f32 v51, v51
    v_cvt_pk_bf16_f32 v96, v44, v45
    v_cvt_pk_bf16_f32 v97, v46, v47
    v_cvt_pk_bf16_f32 v98, v48, v49
    v_cvt_pk_bf16_f32 v99, v50, v51
    v_mfma_f32_32x32x16_bf16 v[36:51], a[144:147], v[104:107], 0
    s_add_u32 s52, s52, 4096
    v_exp_f32 v20, v20
    v_exp_f32 v21, v21
    v_exp_f32 v22, v22
    v_exp_f32 v23, v23
    v_mfma_f32_32x32x8_bf16 v[36:51], a[216:217], v[110:111], v[36:51]
    s_mul_i32 s36, s26, 8
    v_exp_f32 v24, v24
    v_exp_f32 v25, v25
    v_exp_f32 v26, v26
    v_exp_f32 v27, v27
    v_cvt_pk_bf16_f32 v84, v20, v21
    v_cvt_pk_bf16_f32 v85, v22, v23
    v_mfma_f32_32x32x16_bf16 v[68:83], a[140:143], v[96:99], v[68:83]
    s_add_u32 s53, s53, 4096
    v_cvt_pk_bf16_f32 v86, v24, v25
    v_cvt_pk_bf16_f32 v87, v26, v27
    v_exp_f32 v28, v28
    v_exp_f32 v29, v29
    v_exp_f32 v30, v30
    v_exp_f32 v31, v31
    v_mfma_f32_32x32x16_bf16 v[52:67], a[148:151], v[84:87], v[52:67]
    s_mov_b32 m0, s53
    v_exp_f32 v32, v32
    v_exp_f32 v33, v33
    v_exp_f32 v34, v34
    v_exp_f32 v35, v35
    v_cvt_pk_bf16_f32 v88, v28, v29
    v_cvt_pk_bf16_f32 v89, v30, v31
    v_cvt_pk_bf16_f32 v90, v32, v33
    v_cvt_pk_bf16_f32 v91, v34, v35
    v_mfma_f32_32x32x16_bf16 v[20:35], a[156:159], v[100:103], 0
    buffer_load_dwordx4 v1, s[4:7], s52 offen offset:0 lds
    v_exp_f32 v36, v36
    v_exp_f32 v37, v37
    v_exp_f32 v38, v38
    v_exp_f32 v39, v39
    v_mfma_f32_32x32x8_bf16 v[20:35], a[218:219], v[108:109], v[20:35]
    s_add_u32 s88, s88, s36
    v_exp_f32 v40, v40
    v_exp_f32 v41, v41
    v_exp_f32 v42, v42
    v_exp_f32 v43, v43
    v_cvt_pk_bf16_f32 v92, v36, v37
    v_cvt_pk_bf16_f32 v93, v38, v39
    v_mfma_f32_32x32x16_bf16 v[52:67], a[152:155], v[88:91], v[52:67]
    buffer_load_dwordx4 a[244:247], v1, s[4:7], s50 offen offset:2048
    v_cvt_pk_bf16_f32 v94, v40, v41
    v_cvt_pk_bf16_f32 v95, v42, v43
    v_exp_f32 v44, v44
    v_exp_f32 v45, v45
    v_exp_f32 v46, v46
    v_exp_f32 v47, v47
    v_mfma_f32_32x32x16_bf16 v[68:83], a[148:151], v[92:95], v[68:83]
    s_and_b32 s36, s20, 1
    v_exp_f32 v48, v48
    v_exp_f32 v49, v49
    v_exp_f32 v50, v50
    v_exp_f32 v51, v51
    v_cvt_pk_bf16_f32 v96, v44, v45
    v_cvt_pk_bf16_f32 v97, v46, v47
    v_cvt_pk_bf16_f32 v98, v48, v49
    v_cvt_pk_bf16_f32 v99, v50, v51
    v_mfma_f32_32x32x16_bf16 v[36:51], a[156:159], v[104:107], 0
    buffer_load_dwordx4 a[248:251], v1, s[4:7], s50 offen offset:3072
    v_exp_f32 v20, v20
    v_exp_f32 v21, v21
    v_exp_f32 v22, v22
    v_exp_f32 v23, v23
    v_mfma_f32_32x32x8_bf16 v[36:51], a[218:219], v[110:111], v[36:51]
    s_mul_i32 s36, s36, 4
    v_exp_f32 v24, v24
    v_exp_f32 v25, v25
    v_exp_f32 v26, v26
    v_exp_f32 v27, v27
    v_cvt_pk_bf16_f32 v84, v20, v21
    v_cvt_pk_bf16_f32 v85, v22, v23
    v_mfma_f32_32x32x16_bf16 v[68:83], a[152:155], v[96:99], v[68:83]
    s_add_u32 s50, s50, 4096
    v_cvt_pk_bf16_f32 v86, v24, v25
    v_cvt_pk_bf16_f32 v87, v26, v27
    v_exp_f32 v28, v28
    v_exp_f32 v29, v29
    v_exp_f32 v30, v30
    v_exp_f32 v31, v31
    v_mfma_f32_32x32x16_bf16 v[52:67], a[160:163], v[84:87], v[52:67]
    buffer_load_dwordx4 a[252:255], v1, s[4:7], s50 offen offset:0
    v_exp_f32 v32, v32
    v_exp_f32 v33, v33
    v_exp_f32 v34, v34
    v_exp_f32 v35, v35
    v_cvt_pk_bf16_f32 v88, v28, v29
    v_cvt_pk_bf16_f32 v89, v30, v31
    v_cvt_pk_bf16_f32 v90, v32, v33
    v_cvt_pk_bf16_f32 v91, v34, v35
    v_mfma_f32_32x32x16_bf16 v[20:35], a[168:171], v[100:103], 0
    s_add_u32 s88, s88, s36
    v_exp_f32 v36, v36
    v_exp_f32 v37, v37
    v_exp_f32 v38, v38
    v_exp_f32 v39, v39
    v_mfma_f32_32x32x8_bf16 v[20:35], a[220:221], v[108:109], v[20:35]
    s_add_u32 s88, s88, s28
    v_exp_f32 v40, v40
    v_exp_f32 v41, v41
    v_exp_f32 v42, v42
    v_exp_f32 v43, v43
    v_cvt_pk_bf16_f32 v92, v36, v37
    v_cvt_pk_bf16_f32 v93, v38, v39
    v_mfma_f32_32x32x16_bf16 v[52:67], a[164:167], v[88:91], v[52:67]
    s_add_u32 s88, s88, 7065600
    v_cvt_pk_bf16_f32 v94, v40, v41
    v_cvt_pk_bf16_f32 v95, v42, v43
    v_exp_f32 v44, v44
    v_exp_f32 v45, v45
    v_exp_f32 v46, v46
    v_exp_f32 v47, v47
    v_mfma_f32_32x32x16_bf16 v[68:83], a[160:163], v[92:95], v[68:83]
    s_mul_i32 s89, s25, 256
    v_exp_f32 v48, v48
    v_exp_f32 v49, v49
    v_exp_f32 v50, v50
    v_exp_f32 v51, v51
    v_cvt_pk_bf16_f32 v96, v44, v45
    v_cvt_pk_bf16_f32 v97, v46, v47
    v_cvt_pk_bf16_f32 v98, v48, v49
    v_cvt_pk_bf16_f32 v99, v50, v51
    v_mfma_f32_32x32x16_bf16 v[36:51], a[168:171], v[104:107], 0
    s_lshr_b32 s36, s20, 1
    v_exp_f32 v20, v20
    v_exp_f32 v21, v21
    v_exp_f32 v22, v22
    v_exp_f32 v23, v23
    v_mfma_f32_32x32x8_bf16 v[36:51], a[220:221], v[110:111], v[36:51]
    s_mul_i32 s36, s36, 128
    v_exp_f32 v24, v24
    v_exp_f32 v25, v25
    v_exp_f32 v26, v26
    v_exp_f32 v27, v27
    v_cvt_pk_bf16_f32 v84, v20, v21
    v_cvt_pk_bf16_f32 v85, v22, v23
    v_mfma_f32_32x32x16_bf16 v[68:83], a[164:167], v[96:99], v[68:83]
    s_add_u32 s89, s89, s36
    v_cvt_pk_bf16_f32 v86, v24, v25
    v_cvt_pk_bf16_f32 v87, v26, v27
    v_exp_f32 v28, v28
    v_exp_f32 v29, v29
    v_exp_f32 v30, v30
    v_exp_f32 v31, v31
    v_mfma_f32_32x32x16_bf16 v[52:67], a[172:175], v[84:87], v[52:67]
    s_and_b32 s36, s20, 1
    v_exp_f32 v32, v32
    v_exp_f32 v33, v33
    v_exp_f32 v34, v34
    v_exp_f32 v35, v35
    v_cvt_pk_bf16_f32 v88, v28, v29
    v_cvt_pk_bf16_f32 v89, v30, v31
    v_cvt_pk_bf16_f32 v90, v32, v33
    v_cvt_pk_bf16_f32 v91, v34, v35
    v_mfma_f32_32x32x16_bf16 v[20:35], a[180:183], v[100:103], 0
    s_mul_i32 s36, s36, 16
    v_exp_f32 v36, v36
    v_exp_f32 v37, v37
    v_exp_f32 v38, v38
    v_exp_f32 v39, v39
    v_mfma_f32_32x32x8_bf16 v[20:35], a[222:223], v[108:109], v[20:35]
    s_add_u32 s89, s89, s36
    v_exp_f32 v40, v40
    v_exp_f32 v41, v41
    v_exp_f32 v42, v42
    v_exp_f32 v43, v43
    v_cvt_pk_bf16_f32 v92, v36, v37
    v_cvt_pk_bf16_f32 v93, v38, v39
    v_mfma_f32_32x32x16_bf16 v[52:67], a[176:179], v[88:91], v[52:67]
    s_add_u32 s89, s89, s28
    v_cvt_pk_bf16_f32 v94, v40, v41
    v_cvt_pk_bf16_f32 v95, v42, v43
    v_exp_f32 v44, v44
    v_exp_f32 v45, v45
    v_exp_f32 v46, v46
    v_exp_f32 v47, v47
    v_mfma_f32_32x32x16_bf16 v[68:83], a[172:175], v[92:95], v[68:83]
    s_add_u32 s89, s89, 7061504
    v_exp_f32 v48, v48
    v_exp_f32 v49, v49
    v_exp_f32 v50, v50
    v_exp_f32 v51, v51
    v_cvt_pk_bf16_f32 v96, v44, v45
    v_cvt_pk_bf16_f32 v97, v46, v47
    v_cvt_pk_bf16_f32 v98, v48, v49
    v_cvt_pk_bf16_f32 v99, v50, v51
    v_mfma_f32_32x32x16_bf16 v[36:51], a[180:183], v[104:107], 0
    s_mov_b32 s90, 0x3fb8aa3b
    v_exp_f32 v20, v20
    v_exp_f32 v21, v21
    v_exp_f32 v22, v22
    v_exp_f32 v23, v23
    v_mfma_f32_32x32x8_bf16 v[36:51], a[222:223], v[110:111], v[36:51]
    s_mov_b32 s91, s90
    v_exp_f32 v24, v24
    v_exp_f32 v25, v25
    v_exp_f32 v26, v26
    v_exp_f32 v27, v27
    v_cvt_pk_bf16_f32 v84, v20, v21
    v_cvt_pk_bf16_f32 v85, v22, v23
    v_mfma_f32_32x32x16_bf16 v[68:83], a[176:179], v[96:99], v[68:83]
    s_mov_b32 s92, 0x3f3504f3
    v_cvt_pk_bf16_f32 v86, v24, v25
    v_cvt_pk_bf16_f32 v87, v26, v27
    v_exp_f32 v28, v28
    v_exp_f32 v29, v29
    v_exp_f32 v30, v30
    v_exp_f32 v31, v31
    v_mfma_f32_32x32x16_bf16 v[52:67], a[184:187], v[84:87], v[52:67]
    s_mov_b32 s93, s92
    v_exp_f32 v32, v32
    v_exp_f32 v33, v33
    v_exp_f32 v34, v34
    v_exp_f32 v35, v35
    v_cvt_pk_bf16_f32 v88, v28, v29
    v_cvt_pk_bf16_f32 v89, v30, v31
    v_cvt_pk_bf16_f32 v90, v32, v33
    v_cvt_pk_bf16_f32 v91, v34, v35
    v_mfma_f32_32x32x16_bf16 v[20:35], a[0:3], v[100:103], 0
    v_exp_f32 v36, v36
    v_exp_f32 v37, v37
    v_exp_f32 v38, v38
    v_exp_f32 v39, v39
    v_mfma_f32_32x32x8_bf16 v[20:35], a[192:193], v[108:109], v[20:35]
    v_exp_f32 v40, v40
    v_exp_f32 v41, v41
    v_exp_f32 v42, v42
    v_exp_f32 v43, v43
    v_cvt_pk_bf16_f32 v92, v36, v37
    v_cvt_pk_bf16_f32 v93, v38, v39
    v_mfma_f32_32x32x16_bf16 v[52:67], a[188:191], v[88:91], v[52:67]
    v_cvt_pk_bf16_f32 v94, v40, v41
    v_cvt_pk_bf16_f32 v95, v42, v43
    v_exp_f32 v44, v44
    v_exp_f32 v45, v45
    v_exp_f32 v46, v46
    v_exp_f32 v47, v47
    v_mfma_f32_32x32x16_bf16 v[68:83], a[184:187], v[92:95], v[68:83]
    v_exp_f32 v48, v48
    v_exp_f32 v49, v49
    v_exp_f32 v50, v50
    v_exp_f32 v51, v51
    v_cvt_pk_bf16_f32 v96, v44, v45
    v_cvt_pk_bf16_f32 v97, v46, v47
    v_cvt_pk_bf16_f32 v98, v48, v49
    v_cvt_pk_bf16_f32 v99, v50, v51
    s_nop 1
    v_mfma_f32_32x32x16_bf16 v[68:83], a[188:191], v[96:99], v[68:83]
L_chain:
    s_waitcnt vmcnt(0)
    v_mov_b32 v6, 161024
    ds_read_b64 v[108:109], v6
    s_mov_b64 s[64:65], 0
    s_waitcnt lgkmcnt(0)
    v_pk_add_f32 v[52:53], v[52:53], v[124:125]
    v_pk_add_f32 v[54:55], v[54:55], v[126:127]
    v_pk_add_f32 v[56:57], v[56:57], v[128:129]
    v_pk_add_f32 v[58:59], v[58:59], v[130:131]
    v_pk_add_f32 v[60:61], v[60:61], v[132:133]
    v_pk_add_f32 v[62:63], v[62:63], v[134:135]
    v_mov_b32 v116, v60
    v_mov_b32 v117, v60
    s_nop 1
    v_permlane32_swap_b32 v116, v117
    v_med3_f32 v118, v117, s62, v123
    v_rcp_f32 v116, v117
    v_cmp_neq_f32 vcc, v118, v117
    v_pk_mul_f32 v[52:53], v[116:117], v[52:53] op_sel_hi:[0,1]
    v_pk_mul_f32 v[54:55], v[116:117], v[54:55] op_sel_hi:[0,1]
    v_pk_mul_f32 v[56:57], v[116:117], v[56:57] op_sel_hi:[0,1]
    v_pk_mul_f32 v[58:59], v[116:117], v[58:59] op_sel_hi:[0,1]
    v_pk_mul_f32 v[60:61], v[116:117], v[60:61] op_sel_hi:[0,1]
    v_pk_mul_f32 v[62:63], v[116:117], v[62:63] op_sel_hi:[0,1]
    s_or_b64 s[64:65], s[64:65], vcc
    v_cvt_pk_bf16_f32 v84, v52, v53
    v_cvt_pk_bf16_f32 v85, v54, v55
    v_cvt_pk_bf16_f32 v86, v56, v57
    v_cvt_pk_bf16_f32 v87, v58, v59
    v_cvt_pk_bf16_f32 v88, v60, v61
    v_cvt_pk_bf16_f32 v89, v62, v63
    s_add_u32 s61, s57, 0
    buffer_store_dwordx4 v[84:87], v119, s[4:7], s61 offen
    s_mov_b64 exec, 0xffffffff
    buffer_store_dwordx2 v[88:89], v120, s[4:7], s61 offen
    s_mov_b64 exec, -1
    v_add_f32 v118, abs(v52), abs(v53)
    v_add_f32 v118, v118, abs(v54)
    v_add_f32 v118, v118, abs(v55)
    v_add_f32 v118, v118, abs(v56)
    v_add_f32 v118, v118, abs(v57)
    v_add_f32 v118, v118, abs(v58)
    v_add_f32 v118, v118, abs(v59)
    v_add_f32 v100, abs(v60), abs(v61)
    v_add_f32 v101, abs(v62), abs(v63)
    v_add_f32 v100, v100, v101
    v_cmp_class_f32 vcc, v118, v122
    s_nop 1
    s_or_b64 s[64:65], s[64:65], vcc
    v_cmp_class_f32 vcc, v100, v122
    s_nop 1
    s_or_b32 s64, s64, vcc_lo
    v_pk_add_f32 v[68:69], v[68:69], v[136:137]
    v_pk_add_f32 v[70:71], v[70:71], v[138:139]
    v_pk_add_f32 v[72:73], v[72:73], v[140:141]
    v_pk_add_f32 v[74:75], v[74:75], v[142:143]
    v_pk_add_f32 v[76:77], v[76:77], v[144:145]
    v_pk_add_f32 v[78:79], v[78:79], v[146:147]
    v_mov_b32 v116, v76
    v_mov_b32 v117, v76
    s_nop 1
    v_permlane32_swap_b32 v116, v117
    v_med3_f32 v118, v117, s62, v123
    v_rcp_f32 v116, v117
    v_cmp_neq_f32 vcc, v118, v117
    v_pk_mul_f32 v[68:69], v[116:117], v[68:69] op_sel_hi:[0,1]
    v_pk_mul_f32 v[70:71], v[116:117], v[70:71] op_sel_hi:[0,1]
    v_pk_mul_f32 v[72:73], v[116:117], v[72:73] op_sel_hi:[0,1]
    v_pk_mul_f32 v[74:75], v[116:117], v[74:75] op_sel_hi:[0,1]
    v_pk_mul_f32 v[76:77], v[116:117], v[76:77] op_sel_hi:[0,1]
    v_pk_mul_f32 v[78:79], v[116:117], v[78:79] op_sel_hi:[0,1]
    s_or_b64 s[64:65], s[64:65], vcc
    v_cvt_pk_bf16_f32 v92, v68, v69
    v_cvt_pk_bf16_f32 v93, v70, v71
    v_cvt_pk_bf16_f32 v94, v72, v73
    v_cvt_pk_bf16_f32 v95, v74, v75
    v_cvt_pk_bf16_f32 v96, v76, v77
    v_cvt_pk_bf16_f32 v97, v78, v79
    s_add_u32 s61, s57, 40960
    buffer_store_dwordx4 v[92:95], v119, s[4:7], s61 offen
    s_mov_b64 exec, 0xffffffff
    buffer_store_dwordx2 v[96:97], v120, s[4:7], s61 offen
    s_mov_b64 exec, -1
    v_add_f32 v118, abs(v68), abs(v69)
    v_add_f32 v118, v118, abs(v70)
    v_add_f32 v118, v118, abs(v71)
    v_add_f32 v118, v118, abs(v72)
    v_add_f32 v118, v118, abs(v73)
    v_add_f32 v118, v118, abs(v74)
    v_add_f32 v118, v118, abs(v75)
    v_add_f32 v100, abs(v76), abs(v77)
    v_add_f32 v101, abs(v78), abs(v79)
    v_add_f32 v100, v100, v101
    v_cmp_class_f32 vcc, v118, v122
    s_nop 1
    s_or_b64 s[64:65], s[64:65], vcc
    v_cmp_class_f32 vcc, v100, v122
    s_nop 1
    s_or_b32 s64, s64, vcc_lo
    v_readfirstlane_b32 s29, v109
    s_cmp_lg_u32 s76, 0
    s_cselect_b64 s[64:65], 0, s[64:65]
    s_cmp_lg_u64 s[64:65], 0
    s_cbranch_scc1 L_bad_28
    s_waitcnt vmcnt(0)
    s_cmp_lg_u32 s57, 0
    s_cbranch_scc1 L_nobad_27
    v_mov_b32 v5, s27
    s_mov_b64 exec, 1
    s_cmp_lg_u32 s29, 0
    s_cbranch_scc1 L_sg_29
    buffer_store_dword v5, off, s[4:7], s49
L_sj_30:
    s_mov_b64 exec, -1
    s_mov_b32 s57, 1073741824
    s_branch L_nobad_27
L_bad_28:
    ds_write_b32 v6, v6
L_nobad_27:
    s_waitcnt lgkmcnt(0)
    s_barrier
    ds_read_b32 v7, v6
    s_waitcnt lgkmcnt(0)
    v_readfirstlane_b32 s36, v7
    s_nop 1
    s_cmp_lg_u32 s36, 0
    s_cbranch_scc1 L_slow
    s_mov_b32 s76, 0
    s_mul_i32 s47, s20, 9216
    s_add_u32 s47, s47, 122880
    s_mul_i32 s46, s26, 143360
    s_add_u32 s46, s46, s47
    s_add_u32 s46, s46, 4071424
    s_mov_b32 m0, s47
    s_nop 0
    buffer_load_dwordx4 v1, s[4:7], s46 offen offset:0 lds
    s_mov_b32 m0, s47
    s_nop 0
    buffer_load_dwordx4 v1, s[4:7], s46 offen offset:1024 lds
    s_mov_b32 m0, s47
    s_nop 0
    buffer_load_dwordx4 v1, s[4:7], s46 offen offset:2048 lds
    s_mov_b32 m0, s47
    s_nop 0
    buffer_load_dwordx4 v1, s[4:7], s46 offen offset:3072 lds
    s_add_u32 s46, s46, 4096
    s_add_u32 s47, s47, 4096
    s_mov_b32 m0, s47
    s_nop 0
    buffer_load_dwordx4 v1, s[4:7], s46 offen offset:0 lds
    s_cmp_lg_u32 s2, 0
    s_cbranch_scc1 L_noep
    v_mov_b32 v5, s27
    s_mov_b32 s36, 0
    s_mov_b64 exec, 1
    buffer_store_dword v5, off, s[4:7], s36
    s_mov_b64 exec, -1
L_noep:
    s_cmp_lg_u32 s28, 0
    s_cbranch_scc1 L_cs1l_31
    s_mul_i32 s36, s26, 8960
    s_mul_i32 s37, s20, 2240
    s_add_u32 s36, s36, s37
    s_add_u32 s36, s36, 6467584
    s_mov_b64 exec, 0xfffffff
    buffer_load_dwordx4 v[24:27], v1, s[4:7], s36 offen offset:0 sc1
    buffer_load_dwordx4 v[28:31], v1, s[4:7], s36 offen offset:448 sc1
    buffer_load_dwordx4 v[32:35], v1, s[4:7], s36 offen offset:896 sc1
    buffer_load_dwordx4 v[36:39], v1, s[4:7], s36 offen offset:1344 sc1
    buffer_load_dwordx4 v[40:43], v1, s[4:7], s36 offen offset:1792 sc1
    s_mov_b64 exec, -1
L_cs1l_31:
    v_bfe_u32 v66, v0, 2, 2
    v_lshlrev_b32 v66, 5, v66
    v_and_b32 v67, 3, v0
    v_lshl_add_u32 v66, v67, 2, v66
    v_add_u32 v64, 0, v1
    v_add_u32 v65, 51200, v1
    v_and_b32 v6, 31, v0
    v_lshlrev_b32 v6, 2, v6
    buffer_load_dword v5, v6, s[4:7], s33 offen sc1
    s_mov_b32 s35, 0
    s_sleep 1
L_poll_32:
    buffer_load_dword v7, v6, s[4:7], s33 offen sc1
    s_waitcnt vmcnt(1)
    v_cmp_ne_u32 vcc, s27, v5
    s_nop 4
    s_cbranch_vccz L_pollx_33
    buffer_load_dword v5, v6, s[4:7], s33 offen sc1
    s_waitcnt vmcnt(1)
    v_cmp_ne_u32 vcc, s27, v7
    s_nop 4
    s_cbranch_vccz L_pollx_33
    s_add_u32 s35, s35, 1
    s_cmp_lt_u32 s35, 0x20000
    s_cbranch_scc1 L_poll_32
L_pollx_33:
    s_cmp_lg_u32 s29, 0
    s_cbranch_scc1 L_pg_34
L_pj_35:
    buffer_load_dwordx4 a[0:3], v1, s[4:7], s30 offen offset:0 sc1
    buffer_load_dwordx4 a[4:7], v1, s[4:7], s30 offen offset:1024 sc1
    buffer_load_dwordx4 a[8:11], v1, s[4:7], s30 offen offset:2048 sc1
    buffer_load_dwordx4 a[12:15], v1, s[4:7], s30 offen offset:3072 sc1
    s_add_u32 s30, s30, 4096
    buffer_load_dwordx4 a[16:19], v1, s[4:7], s30 offen offset:0 sc1
    buffer_load_dwordx4 a[20:23], v1, s[4:7], s30 offen offset:1024 sc1
    buffer_load_dwordx4 a[24:27], v1, s[4:7], s30 offen offset:2048 sc1
    ds_read_b128 v[68:71], v64 offset:0
    ds_read_b128 v[72:75], v64 offset:1024
    ds_read_b128 v[76:79], v64 offset:2048
    ds_read_b128 v[80:83], v64 offset:3072
    ds_read_b128 v[84:87], v64 offset:4096
    ds_read_b128 v[88:91], v64 offset:5120
    ds_read_b128 v[92:95], v64 offset:6144
    ds_read_b128 v[96:99], v64 offset:7168
    ds_read_b128 v[100:103], v64 offset:8192
    s_waitcnt vmcnt(6)
    s_waitcnt lgkmcnt(8)
    v_mfma_f32_16x16x32_bf16 v[108:111], v[68:71], a[0:3], 0
    ds_read_b128 v[104:107], v64 offset:9216
    s_waitcnt lgkmcnt(8)
    v_mfma_f32_16x16x32_bf16 v[112:115], v[72:75], a[0:3], 0
    ds_read_b128 v[68:71], v64 offset:10240
    buffer_load_dwordx4 a[28:31], v1, s[4:7], s30 offen offset:3072 sc1
    s_waitcnt lgkmcnt(8)
    v_mfma_f32_16x16x32_bf16 v[116:119], v[76:79], a[0:3], 0
    ds_read_b128 v[72:75], v64 offset:11264
    s_waitcnt lgkmcnt(8)
    v_mfma_f32_16x16x32_bf16 v[120:123], v[80:83], a[0:3], 0
    ds_read_b128 v[76:79], v64 offset:12288
    s_waitcnt lgkmcnt(8)
    v_mfma_f32_16x16x32_bf16 v[124:127], v[84:87], a[0:3], 0
    ds_read_b128 v[80:83], v64 offset:13312
    s_waitcnt vmcnt(6)
    s_waitcnt lgkmcnt(8)
    v_mfma_f32_16x16x32_bf16 v[108:111], v[88:91], a[4:7], v[108:111]
    ds_read_b128 v[84:87], v64 offset:14336
    s_add_u32 s30, s30, 4096
    buffer_load_dwordx4 a[32:35], v1, s[4:7], s30 offen offset:0 sc1
    s_waitcnt lgkmcnt(8)
    v_mfma_f32_16x16x32_bf16 v[112:115], v[92:95], a[4:7], v[112:115]
    ds_read_b128 v[88:91], v64 offset:15360
    s_waitcnt lgkmcnt(8)
    v_mfma_f32_16x16x32_bf16 v[116:119], v[96:99], a[4:7], v[116:119]
    ds_read_b128 v[92:95], v64 offset:16384
    s_waitcnt lgkmcnt(8)
    v_mfma_f32_16x16x32_bf16 v[120:123], v[100:103], a[4:7], v[120:123]
    ds_read_b128 v[96:99], v64 offset:17408
    s_waitcnt lgkmcnt(8)
    v_mfma_f32_16x16x32_bf16 v[124:127], v[104:107], a[4:7], v[124:127]
    ds_read_b128 v[100:103], v64 offset:18432
    buffer_load_dwordx4 a[36:39], v1, s[4:7], s30 offen offset:1024 sc1
    s_waitcnt vmcnt(7)
    s_waitcnt lgkmcnt(8)
    v_mfma_f32_16x16x32_bf16 v[108:111], v[68:71], a[8:11], v[108:111]
    ds_read_b128 v[104:107], v64 offset:19456
    s_waitcnt lgkmcnt(8)
    v_mfma_f32_16x16x32_bf16 v[112:115], v[72:75], a[8:11], v[112:115]
    ds_read_b128 v[68:71], v64 offset:20480
    s_waitcnt lgkmcnt(8)
    v_mfma_f32_16x16x32_bf16 v[116:119], v[76:79], a[8:11], v[116:119]
    ds_read_b128 v[72:75], v64 offset:21504
    s_waitcnt lgkmcnt(8)
    v_mfma_f32_16x16x32_bf16 v[120:123], v[80:83], a[8:11], v[120:123]
    ds_read_b128 v[76:79], v64 offset:22528
    buffer_load_dwordx4 a[40:43], v1, s[4:7], s30 offen offset:2048 sc1
    s_waitcnt lgkmcnt(8)
    v_mfma_f32_16x16x32_bf16 v[124:127], v[84:87], a[8:11], v[124:127]
    ds_read_b128 v[80:83], v64 offset:23552
    s_waitcnt vmcnt(7)
    s_waitcnt lgkmcnt(8)
    v_mfma_f32_16x16x32_bf16 v[108:111], v[88:91], a[12:15], v[108:111]
    ds_read_b128 v[84:87], v64 offset:24576
    s_waitcnt lgkmcnt(8)
    v_mfma_f32_16x16x32_bf16 v[112:115], v[92:95], a[12:15], v[112:115]
    ds_read_b128 v[88:91], v64 offset:25600
    s_waitcnt lgkmcnt(8)
    v_mfma_f32_16x16x32_bf16 v[116:119], v[96:99], a[12:15], v[116:119]
    ds_read_b128 v[92:95], v64 offset:26624
    buffer_load_dwordx4 a[44:47], v1, s[4:7], s30 offen offset:3072 sc1
    s_waitcnt lgkmcnt(8)
    v_mfma_f32_16x16x32_bf16 v[120:123], v[100:103], a[12:15], v[120:123]
    ds_read_b128 v[96:99], v64 offset:27648
    s_waitcnt lgkmcnt(8)
    v_mfma_f32_16x16x32_bf16 v[124:127], v[104:107], a[12:15], v[124:127]
    ds_read_b128 v[100:103], v64 offset:28672
    s_waitcnt vmcnt(7)
    s_waitcnt lgkmcnt(8)
    v_mfma_f32_16x16x32_bf16 v[108:111], v[68:71], a[16:19], v[108:111]
    ds_read_b128 v[104:107], v64 offset:29696
    s_waitcnt lgkmcnt(8)
    v_mfma_f32_16x16x32_bf16 v[112:115], v[72:75], a[16:19], v[112:115]
    ds_read_b128 v[68:71], v64 offset:30720
    s_add_u32 s30, s30, 4096
    buffer_load_dwordx4 a[48:51], v1, s[4:7], s30 offen offset:0 sc1
    s_waitcnt lgkmcnt(8)
    v_mfma_f32_16x16x32_bf16 v[116:119], v[76:79], a[16:19], v[116:119]
    ds_read_b128 v[72:75], v64 offset:31744
    s_waitcnt lgkmcnt(8)
    v_mfma_f32_16x16x32_bf16 v[120:123], v[80:83], a[16:19], v[120:123]
    ds_read_b128 v[76:79], v64 offset:32768
    s_waitcnt lgkmcnt(8)
    v_mfma_f32_16x16x32_bf16 v[124:127], v[84:87], a[16:19], v[124:127]
    ds_read_b128 v[80:83], v64 offset:33792
    s_waitcnt vmcnt(7)
    s_waitcnt lgkmcnt(8)
    v_mfma_f32_16x16x32_bf16 v[108:111], v[88:91], a[20:23], v[108:111]
    ds_read_b128 v[84:87], v64 offset:34816
    buffer_load_dwordx4 a[52:55], v1, s[4:7], s30 offen offset:1024 sc1
    s_waitcnt lgkmcnt(8)
    v_mfma_f32_16x16x32_bf16 v[112:115], v[92:95], a[20:23], v[112:115]
    ds_read_b128 v[88:91], v64 offset:35840
    s_waitcnt lgkmcnt(8)
    v_mfma_f32_16x16x32_bf16 v[116:119], v[96:99], a[20:23], v[116:119]
    ds_read_b128 v[92:95], v64 offset:36864
    s_waitcnt lgkmcnt(8)
    v_mfma_f32_16x16x32_bf16 v[120:123], v[100:103], a[20:23], v[120:123]
    ds_read_b128 v[96:99], v64 offset:37888
    s_waitcnt lgkmcnt(8)
    v_mfma_f32_16x16x32_bf16 v[124:127], v[104:107], a[20:23], v[124:127]
    ds_read_b128 v[100:103], v64 offset:38912
    buffer_load_dwordx4 a[56:59], v1, s[4:7], s30 offen offset:2048 sc1
    s_waitcnt vmcnt(8)
    s_waitcnt lgkmcnt(8)
    v_mfma_f32_16x16x32_bf16 v[108:111], v[68:71], a[24:27], v[108:111]
    ds_read_b128 v[104:107], v64 offset:39936
    s_waitcnt lgkmcnt(8)
    v_mfma_f32_16x16x32_bf16 v[112:115], v[72:75], a[24:27], v[112:115]
    ds_read_b128 v[68:71], v64 offset:40960
    s_waitcnt lgkmcnt(8)
    v_mfma_f32_16x16x32_bf16 v[116:119], v[76:79], a[24:27], v[116:119]
    ds_read_b128 v[72:75], v64 offset:41984
    s_waitcnt lgkmcnt(8)
    v_mfma_f32_16x16x32_bf16 v[120:123], v[80:83], a[24:27], v[120:123]
    ds_read_b128 v[76:79], v64 offset:43008
    buffer_load_dwordx4 a[60:63], v1, s[4:7], s30 offen offset:3072 sc1
    s_waitcnt lgkmcnt(8)
    v_mfma_f32_16x16x32_bf16 v[124:127], v[84:87], a[24:27], v[124:127]
    ds_read_b128 v[80:83], v64 offset:44032
    s_waitcnt vmcnt(8)
    s_waitcnt lgkmcnt(8)
    v_mfma_f32_16x16x32_bf16 v[108:111], v[88:91], a[28:31], v[108:111]
    ds_read_b128 v[84:87], v64 offset:45056
    s_waitcnt lgkmcnt(8)
    v_mfma_f32_16x16x32_bf16 v[112:115], v[92:95], a[28:31], v[112:115]
    ds_read_b128 v[88:91], v64 offset:46080
    s_waitcnt lgkmcnt(8)
    v_mfma_f32_16x16x32_bf16 v[116:119], v[96:99], a[28:31], v[116:119]
    ds_read_b128 v[92:95], v64 offset:47104
    s_add_u32 s30, s30, 4096
    buffer_load_dwordx4 a[64:67], v1, s[4:7], s30 offen offset:0 sc1
    s_waitcnt lgkmcnt(8)
    v_mfma_f32_16x16x32_bf16 v[120:123], v[100:103], a[28:31], v[120:123]
    ds_read_b128 v[96:99], v64 offset:48128
    s_waitcnt lgkmcnt(8)
    v_mfma_f32_16x16x32_bf16 v[124:127], v[104:107], a[28:31], v[124:127]
    ds_read_b128 v[100:103], v64 offset:49152
    s_waitcnt vmcnt(8)
    s_waitcnt lgkmcnt(8)
    v_mfma_f32_16x16x32_bf16 v[108:111], v[68:71], a[32:35], v[108:111]
    ds_read_b128 v[104:107], v64 offset:50176
    s_waitcnt lgkmcnt(8)
    v_mfma_f32_16x16x32_bf16 v[112:115], v[72:75], a[32:35], v[112:115]
    ds_read_b128 v[68:71], v65 offset:0
    buffer_load_dwordx4 a[68:71], v1, s[4:7], s30 offen offset:1024 sc1
    s_waitcnt lgkmcnt(8)
    v_mfma_f32_16x16x32_bf16 v[116:119], v[76:79], a[32:35], v[116:119]
    ds_read_b128 v[72:75], v65 offset:1024
    s_waitcnt lgkmcnt(8)
    v_mfma_f32_16x16x32_bf16 v[120:123], v[80:83], a[32:35], v[120:123]
    ds_read_b128 v[76:79], v65 offset:2048
    s_waitcnt lgkmcnt(8)
    v_mfma_f32_16x16x32_bf16 v[124:127], v[84:87], a[32:35], v[124:127]
    ds_read_b128 v[80:83], v65 offset:3072
    s_waitcnt vmcnt(8)
    s_waitcnt lgkmcnt(8)
    v_mfma_f32_16x16x32_bf16 v[108:111], v[88:91], a[36:39], v[108:111]
    ds_read_b128 v[84:87], v65 offset:4096
    buffer_load_dwordx4 a[72:75], v1, s[4:7], s30 offen offset:2048 sc1
    s_waitcnt lgkmcnt(8)
    v_mfma_f32_16x16x32_bf16 v[112:115], v[92:95], a[36:39], v[112:115]
    ds_read_b128 v[88:91], v65 offset:5120
    s_waitcnt lgkmcnt(8)
    v_mfma_f32_16x16x32_bf16 v[116:119], v[96:99], a[36:39], v[116:119]
    ds_read_b128 v[92:95], v65 offset:6144
    s_waitcnt lgkmcnt(8)
    v_mfma_f32_16x16x32_bf16 v[120:123], v[100:103], a[36:39], v[120:123]
    ds_read_b128 v[96:99], v65 offset:7168
    s_waitcnt lgkmcnt(8)
    v_mfma_f32_16x16x32_bf16 v[124:127], v[104:107], a[36:39], v[124:127]
    ds_read_b128 v[100:103], v65 offset:8192
    buffer_load_dwordx4 a[76:79], v1, s[4:7], s30 offen offset:3072 sc1
    s_waitcnt vmcnt(9)
    s_waitcnt lgkmcnt(8)
    v_mfma_f32_16x16x32_bf16 v[108:111], v[68:71], a[40:43], v[108:111]
    ds_read_b128 v[104:107], v65 offset:9216
    s_waitcnt lgkmcnt(8)
    v_mfma_f32_16x16x32_bf16 v[112:115], v[72:75], a[40:43], v[112:115]
    ds_read_b128 v[68:71], v65 offset:10240
    s_waitcnt lgkmcnt(8)
    v_mfma_f32_16x16x32_bf16 v[116:119], v[76:79], a[40:43], v[116:119]
    ds_read_b128 v[72:75], v65 offset:11264
    s_waitcnt lgkmcnt(8)
    v_mfma_f32_16x16x32_bf16 v[120:123], v[80:83], a[40:43], v[120:123]
    ds_read_b128 v[76:79], v65 offset:12288
    s_mov_b32 m0, s47
    s_nop 0
    buffer_load_dwordx4 v1, s[4:7], s46 offen offset:1024 lds
    s_waitcnt lgkmcnt(8)
    v_mfma_f32_16x16x32_bf16 v[124:127], v[84:87], a[40:43], v[124:127]
    ds_read_b128 v[80:83], v65 offset:13312
    s_waitcnt vmcnt(9)
    s_waitcnt lgkmcnt(8)
    v_mfma_f32_16x16x32_bf16 v[108:111], v[88:91], a[44:47], v[108:111]
    ds_read_b128 v[84:87], v65 offset:14336
    s_waitcnt lgkmcnt(8)
    v_mfma_f32_16x16x32_bf16 v[112:115], v[92:95], a[44:47], v[112:115]
    ds_read_b128 v[88:91], v65 offset:15360
    s_waitcnt lgkmcnt(8)
    v_mfma_f32_16x16x32_bf16 v[116:119], v[96:99], a[44:47], v[116:119]
    ds_read_b128 v[92:95], v65 offset:16384
    s_mov_b32 m0, s47
    s_nop 0
    buffer_load_dwordx4 v1, s[4:7], s46 offen offset:2048 lds
    s_waitcnt lgkmcnt(8)
    v_mfma_f32_16x16x32_bf16 v[120:123], v[100:103], a[44:47], v[120:123]
    ds_read_b128 v[96:99], v65 offset:17408
    s_waitcnt lgkmcnt(8)
    v_mfma_f32_16x16x32_bf16 v[124:127], v[104:107], a[44:47], v[124:127]
    ds_read_b128 v[100:103], v65 offset:18432
    s_waitcnt vmcnt(9)
    s_waitcnt lgkmcnt(8)
    v_mfma_f32_16x16x32_bf16 v[108:111], v[68:71], a[48:51], v[108:111]
    ds_read_b128 v[104:107], v65 offset:19456
    s_waitcnt lgkmcnt(8)
    v_mfma_f32_16x16x32_bf16 v[112:115], v[72:75], a[48:51], v[112:115]
    ds_read_b128 v[68:71], v65 offset:20480
    s_mov_b32 m0, s47
    s_nop 0
    buffer_load_dwordx4 v1, s[4:7], s46 offen offset:3072 lds
    s_waitcnt lgkmcnt(8)
    v_mfma_f32_16x16x32_bf16 v[116:119], v[76:79], a[48:51], v[116:119]
    ds_read_b128 v[72:75], v65 offset:21504
    s_waitcnt lgkmcnt(8)
    v_mfma_f32_16x16x32_bf16 v[120:123], v[80:83], a[48:51], v[120:123]
    ds_read_b128 v[76:79], v65 offset:22528
    s_waitcnt lgkmcnt(8)
    v_mfma_f32_16x16x32_bf16 v[124:127], v[84:87], a[48:51], v[124:127]
    ds_read_b128 v[80:83], v65 offset:23552
    s_waitcnt vmcnt(9)
    s_waitcnt lgkmcnt(8)
    v_mfma_f32_16x16x32_bf16 v[108:111], v[88:91], a[52:55], v[108:111]
    ds_read_b128 v[84:87], v65 offset:24576
    s_add_u32 s46, s46, 4096
    s_add_u32 s47, s47, 4096
    s_mov_b32 m0, s47
    s_nop 0
    buffer_load_dwordx4 v1, s[4:7], s46 offen offset:0 lds
    s_waitcnt lgkmcnt(8)
    v_mfma_f32_16x16x32_bf16 v[112:115], v[92:95], a[52:55], v[112:115]
    ds_read_b128 v[88:91], v65 offset:25600
    s_waitcnt lgkmcnt(8)
    v_mfma_f32_16x16x32_bf16 v[116:119], v[96:99], a[52:55], v[116:119]
    ds_read_b128 v[92:95], v65 offset:26624
    s_waitcnt lgkmcnt(8)
    v_mfma_f32_16x16x32_bf16 v[120:123], v[100:103], a[52:55], v[120:123]
    ds_read_b128 v[96:99], v65 offset:27648
    s_waitcnt lgkmcnt(8)
    v_mfma_f32_16x16x32_bf16 v[124:127], v[104:107], a[52:55], v[124:127]
    ds_read_b128 v[100:103], v65 offset:28672
    buffer_load_dwordx4 a[120:123], v1, s[4:7], s50 offen offset:1024
    s_waitcnt vmcnt(10)
    s_waitcnt lgkmcnt(8)
    v_mfma_f32_16x16x32_bf16 v[108:111], v[68:71], a[56:59], v[108:111]
    ds_read_b128 v[104:107], v65 offset:29696
    s_waitcnt lgkmcnt(8)
    v_mfma_f32_16x16x32_bf16 v[112:115], v[72:75], a[56:59], v[112:115]
    ds_read_b128 v[68:71], v65 offset:30720
    s_waitcnt lgkmcnt(8)
    v_mfma_f32_16x16x32_bf16 v[116:119], v[76:79], a[56:59], v[116:119]
    ds_read_b128 v[72:75], v65 offset:31744
    s_waitcnt lgkmcnt(8)
    v_mfma_f32_16x16x32_bf16 v[120:123], v[80:83], a[56:59], v[120:123]
    ds_read_b128 v[76:79], v65 offset:32768
    buffer_load_dwordx4 a[124:127], v1, s[4:7], s50 offen offset:2048
    s_waitcnt lgkmcnt(8)
    v_mfma_f32_16x16x32_bf16 v[124:127], v[84:87], a[56:59], v[124:127]
    ds_read_b128 v[80:83], v65 offset:33792
    s_waitcnt vmcnt(10)
    s_waitcnt lgkmcnt(8)
    v_mfma_f32_16x16x32_bf16 v[108:111], v[88:91], a[60:63], v[108:111]
    ds_read_b128 v[84:87], v65 offset:34816
    s_waitcnt lgkmcnt(8)
    v_mfma_f32_16x16x32_bf16 v[112:115], v[92:95], a[60:63], v[112:115]
    ds_read_b128 v[88:91], v65 offset:35840
    s_waitcnt lgkmcnt(8)
    v_mfma_f32_16x16x32_bf16 v[116:119], v[96:99], a[60:63], v[116:119]
    ds_read_b128 v[92:95], v65 offset:36864
    buffer_load_dwordx4 a[128:131], v1, s[4:7], s50 offen offset:3072
    s_waitcnt lgkmcnt(8)
    v_mfma_f32_16x16x32_bf16 v[120:123], v[100:103], a[60:63], v[120:123]
    ds_read_b128 v[96:99], v65 offset:37888
    s_waitcnt lgkmcnt(8)
    v_mfma_f32_16x16x32_bf16 v[124:127], v[104:107], a[60:63], v[124:127]
    ds_read_b128 v[100:103], v65 offset:38912
    s_waitcnt vmcnt(10)
    s_waitcnt lgkmcnt(8)
    v_mfma_f32_16x16x32_bf16 v[108:111], v[68:71], a[64:67], v[108:111]
    ds_read_b128 v[104:107], v65 offset:39936
    s_waitcnt lgkmcnt(8)
    v_mfma_f32_16x16x32_bf16 v[112:115], v[72:75], a[64:67], v[112:115]
    ds_read_b128 v[68:71], v65 offset:40960
    s_add_u32 s50, s50, 4096
    buffer_load_dwordx4 a[132:135], v1, s[4:7], s50 offen offset:0
    s_waitcnt lgkmcnt(8)
    v_mfma_f32_16x16x32_bf16 v[116:119], v[76:79], a[64:67], v[116:119]
    ds_read_b128 v[72:75], v65 offset:41984
    s_waitcnt lgkmcnt(8)
    v_mfma_f32_16x16x32_bf16 v[120:123], v[80:83], a[64:67], v[120:123]
    ds_read_b128 v[76:79], v65 offset:43008
    s_waitcnt lgkmcnt(8)
    v_mfma_f32_16x16x32_bf16 v[124:127], v[84:87], a[64:67], v[124:127]
    ds_read_b128 v[80:83], v65 offset:44032
    s_waitcnt vmcnt(10)
    s_waitcnt lgkmcnt(8)
    v_mfma_f32_16x16x32_bf16 v[108:111], v[88:91], a[68:71], v[108:111]
    ds_read_b128 v[84:87], v65 offset:45056
    buffer_load_dwordx4 a[136:139], v1, s[4:7], s50 offen offset:1024
    s_waitcnt lgkmcnt(8)
    v_mfma_f32_16x16x32_bf16 v[112:115], v[92:95], a[68:71], v[112:115]
    ds_read_b128 v[88:91], v65 offset:46080
    s_waitcnt lgkmcnt(8)
    v_mfma_f32_16x16x32_bf16 v[116:119], v[96:99], a[68:71], v[116:119]
    ds_read_b128 v[92:95], v65 offset:47104
    s_waitcnt lgkmcnt(8)
    v_mfma_f32_16x16x32_bf16 v[120:123], v[100:103], a[68:71], v[120:123]
    ds_read_b128 v[96:99], v65 offset:48128
    s_waitcnt lgkmcnt(8)
    v_mfma_f32_16x16x32_bf16 v[124:127], v[104:107], a[68:71], v[124:127]
    ds_read_b128 v[100:103], v65 offset:49152
    buffer_load_dwordx4 a[140:143], v1, s[4:7], s50 offen offset:2048
    s_waitcnt vmcnt(11)
    s_waitcnt lgkmcnt(8)
    v_mfma_f32_16x16x32_bf16 v[108:111], v[68:71], a[72:75], v[108:111]
    ds_read_b128 v[104:107], v65 offset:50176
    s_waitcnt lgkmcnt(8)
    v_mfma_f32_16x16x32_bf16 v[112:115], v[72:75], a[72:75], v[112:115]
    s_waitcnt lgkmcnt(7)
    v_mfma_f32_16x16x32_bf16 v[116:119], v[76:79], a[72:75], v[116:119]
    s_waitcnt lgkmcnt(6)
    v_mfma_f32_16x16x32_bf16 v[120:123], v[80:83], a[72:75], v[120:123]
    s_waitcnt lgkmcnt(5)
    v_mfma_f32_16x16x32_bf16 v[124:127], v[84:87], a[72:75], v[124:127]
    s_waitcnt vmcnt(10)
    s_waitcnt lgkmcnt(4)
    v_mfma_f32_16x16x32_bf16 v[108:111], v[88:91], a[76:79], v[108:111]
    s_waitcnt lgkmcnt(3)
    v_mfma_f32_16x16x32_bf16 v[112:115], v[92:95], a[76:79], v[112:115]
    s_waitcnt lgkmcnt(2)
    v_mfma_f32_16x16x32_bf16 v[116:119], v[96:99], a[76:79], v[116:119]
    s_waitcnt lgkmcnt(1)
    v_mfma_f32_16x16x32_bf16 v[120:123], v[100:103], a[76:79], v[120:123]
    s_waitcnt lgkmcnt(0)
    v_mfma_f32_16x16x32_bf16 v[124:127], v[104:107], a[76:79], v[124:127]
    v_dot2c_f32_bf16 v108, s66, v8
    v_dot2c_f32_bf16 v109, s67, v8
    v_dot2c_f32_bf16 v110, s66, v9
    v_dot2c_f32_bf16 v111, s67, v9
    v_dot2c_f32_bf16 v112, s66, v10
    v_dot2c_f32_bf16 v113, s67, v10
    v_dot2c_f32_bf16 v114, s66, v11
    v_dot2c_f32_bf16 v115, s67, v11
    v_dot2c_f32_bf16 v116, s66, v12
    v_dot2c_f32_bf16 v117, s67, v12
    v_dot2c_f32_bf16 v118, s66, v13
    v_dot2c_f32_bf16 v119, s67, v13
    v_dot2c_f32_bf16 v120, s66, v14
    v_dot2c_f32_bf16 v121, s67, v14
    v_dot2c_f32_bf16 v122, s66, v15
    v_dot2c_f32_bf16 v123, s67, v15
    v_dot2c_f32_bf16 v124, s66, v16
    v_dot2c_f32_bf16 v125, s67, v16
    v_dot2c_f32_bf16 v126, s66, v17
    v_dot2c_f32_bf16 v127, s67, v17
    v_mov_b32 v20, 0
    v_mov_b32 v21, 0
    v_cvt_pk_bf16_f32 v8, v108, v109
    v_cvt_pk_bf16_f32 v9, v110, v111
    v_cvt_pk_bf16_f32 v10, v112, v113
    v_cvt_pk_bf16_f32 v11, v114, v115
    buffer_store_dwordx4 v[8:11], v1, s[4:7], s39 offen
    v_cvt_pk_bf16_f32 v12, v116, v117
    v_cvt_pk_bf16_f32 v13, v118, v119
    v_cvt_pk_bf16_f32 v14, v120, v121
    v_cvt_pk_bf16_f32 v15, v122, v123
    buffer_store_dwordx4 v[12:15], v1, s[4:7], s39 offen offset:1024
    v_cvt_pk_bf16_f32 v16, v124, v125
    v_cvt_pk_bf16_f32 v17, v126, v127
    buffer_store_dwordx2 v[16:17], v1, s[4:7], s38 offen offset:2048
    v_dot2c_f32_bf16 v20, s68, v8
    v_dot2c_f32_bf16 v21, v8, v8
    v_dot2c_f32_bf16 v20, s68, v9
    v_dot2c_f32_bf16 v21, v9, v9
    v_dot2c_f32_bf16 v20, s68, v10
    v_dot2c_f32_bf16 v21, v10, v10
    v_dot2c_f32_bf16 v20, s68, v11
    v_dot2c_f32_bf16 v21, v11, v11
    v_dot2c_f32_bf16 v20, s68, v12
    v_dot2c_f32_bf16 v21, v12, v12
    v_dot2c_f32_bf16 v20, s68, v13
    v_dot2c_f32_bf16 v21, v13, v13
    v_dot2c_f32_bf16 v20, s68, v14
    v_dot2c_f32_bf16 v21, v14, v14
    v_dot2c_f32_bf16 v20, s68, v15
    v_dot2c_f32_bf16 v21, v15, v15
    v_dot2c_f32_bf16 v20, s68, v16
    v_dot2c_f32_bf16 v21, v16, v16
    v_dot2c_f32_bf16 v20, s68, v17
    v_dot2c_f32_bf16 v21, v17, v17
    s_nop 2
    buffer_store_dwordx2 v[20:21], v18, s[4:7], s41 offen
    s_barrier
    s_mul_i32 s53, s20, 11264
    s_mul_i32 s52, s26, 143360
    s_add_u32 s52, s52, s53
    s_add_u32 s52, s52, 4231168
    s_mov_b32 m0, s53
    s_nop 0
    buffer_load_dwordx4 v1, s[4:7], s52 offen offset:0 lds
    s_mov_b32 m0, s53
    s_nop 0
    buffer_load_dwordx4 v1, s[4:7], s52 offen offset:1024 lds
    s_mov_b32 m0, s53
    s_nop 0
    buffer_load_dwordx4 v1, s[4:7], s52 offen offset:2048 lds
    s_mov_b32 m0, s53
    s_nop 0
    buffer_load_dwordx4 v1, s[4:7], s52 offen offset:3072 lds
    s_add_u32 s52, s52, 4096
    s_add_u32 s53, s53, 4096
    s_mov_b32 m0, s53
    s_nop 0
    buffer_load_dwordx4 v1, s[4:7], s52 offen offset:0 lds
    s_mov_b32 m0, s53
    s_nop 0
    buffer_load_dwordx4 v1, s[4:7], s52 offen offset:1024 lds
    s_waitcnt vmcnt(6)
    v_mov_b32 v5, s27
    s_mov_b64 exec, 1
    s_cmp_lg_u32 s29, 0
    s_cbranch_scc1 L_sg_36
    buffer_store_dword v5, off, s[4:7], s40
L_sj_37:
    s_mov_b64 exec, -1
    s_mov_b32 m0, s53
    s_nop 0
    buffer_load_dwordx4 v1, s[4:7], s52 offen offset:2048 lds
    s_mov_b32 m0, s53
    s_nop 0
    buffer_load_dwordx4 v1, s[4:7], s52 offen offset:3072 lds
    s_add_u32 s52, s52, 4096
    s_add_u32 s53, s53, 4096
    s_mov_b32 m0, s53
    s_nop 0
    buffer_load_dwordx4 v1, s[4:7], s52 offen offset:0 lds
    s_mov_b32 m0, s53
    s_nop 0
    buffer_load_dwordx4 v1, s[4:7], s52 offen offset:1024 lds
    s_mov_b32 m0, s53
    s_nop 0
    buffer_load_dwordx4 v1, s[4:7], s52 offen offset:2048 lds
    s_cmp_lg_u32 s28, 0
    s_cbranch_scc1 L_cs1a_38
    v_add_f32 v24, v24, v28
    v_add_f32 v25, v25, v29
    v_add_f32 v26, v26, v30
    v_add_f32 v27, v27, v31
    v_add_f32 v32, v32, v36
    v_add_f32 v33, v33, v37
    v_add_f32 v34, v34, v38
    v_add_f32 v35, v35, v39
    v_add_f32 v24, v24, v32
    v_add_f32 v25, v25, v33
    v_add_f32 v26, v26, v34
    v_add_f32 v27, v27, v35
    v_add_f32 v24, v24, v40
    v_add_f32 v25, v25, v41
    v_add_f32 v26, v26, v42
    v_add_f32 v27, v27, v43
    s_mul_i32 s36, s20, 448
    s_add_u32 s36, s36, 161088
    v_add_u32 v7, s36, v1
    s_mov_b64 exec, 0xfffffff
    ds_write_b128 v7, v[24:27]
    s_mov_b64 exec, -1
    s_waitcnt lgkmcnt(0)
L_cs1a_38:
    buffer_load_dword v5, v66, s[4:7], s89 offen sc1
    s_mov_b32 s35, 0
    s_sleep 1
L_poll_39:
    buffer_load_dword v6, v66, s[4:7], s89 offen sc1
    s_waitcnt vmcnt(1)
    v_cmp_ne_u32 vcc, s27, v5
    s_nop 4
    s_cbranch_vccz L_pollx_40
    buffer_load_dword v5, v66, s[4:7], s89 offen sc1
    s_waitcnt vmcnt(1)
    v_cmp_ne_u32 vcc, s27, v6
    s_nop 4
    s_cbranch_vccz L_pollx_40
    s_add_u32 s35, s35, 1
    s_cmp_lt_u32 s35, 0x20000
    s_cbranch_scc1 L_poll_39
L_pollx_40:
    s_cmp_lg_u32 s29, 0
    s_cbranch_scc1 L_pg_41
L_pj_42:
    v_add_u32 v116, 102400, v1
    v_add_u32 v117, 0, v1
    v_add_u32 v118, 57344, v1
    v_lshlrev_b32 v119, 4, v4
    v_add_u32 v119, 159744, v119
    buffer_load_dwordx4 a[0:3], v1, s[4:7], s80 offen offset:0 sc1
    buffer_load_dwordx4 a[4:7], v1, s[4:7], s81 offen offset:0 sc1
    buffer_load_dwordx4 a[8:11], v1, s[4:7], s80 offen offset:1024 sc1
    buffer_load_dwordx4 a[12:15], v1, s[4:7], s81 offen offset:1024 sc1
    buffer_load_dwordx4 a[16:19], v1, s[4:7], s80 offen offset:2048 sc1
    buffer_load_dwordx4 a[20:23], v1, s[4:7], s81 offen offset:2048 sc1
    buffer_load_dwordx4 a[24:27], v1, s[4:7], s80 offen offset:3072 sc1
    buffer_load_dwordx4 a[28:31], v1, s[4:7], s81 offen offset:3072 sc1
    s_barrier
    ds_read_b128 a[64:67], v116 offset:0
    ds_read_b128 a[68:71], v116 offset:1024
    ds_read_b128 a[72:75], v116 offset:2048
    ds_read_b128 a[76:79], v116 offset:3072
    ds_read_b128 a[80:83], v116 offset:4096
    ds_read_b128 a[84:87], v116 offset:5120
    ds_read_b128 a[88:91], v116 offset:6144
    s_waitcnt vmcnt(6)
    s_waitcnt lgkmcnt(0)
    v_mfma_f32_16x16x32_bf16 v[20:23], a[64:67], a[0:3], 0
    ds_read_b128 a[92:95], v116 offset:7168
    v_mfma_f32_16x16x32_bf16 v[48:51], a[64:67], a[4:7], 0
    ds_read_b128 a[96:99], v116 offset:8192
    v_mfma_f32_16x16x32_bf16 v[24:27], a[68:71], a[0:3], 0
    ds_read_b128 a[100:103], v116 offset:9216
    v_mfma_f32_16x16x32_bf16 v[52:55], a[68:71], a[4:7], 0
    ds_read_b128 a[104:107], v116 offset:10240
    v_mfma_f32_16x16x32_bf16 v[28:31], a[72:75], a[0:3], 0
    ds_read_b128 a[108:111], v116 offset:11264
    v_mfma_f32_16x16x32_bf16 v[56:59], a[72:75], a[4:7], 0
    ds_read_b128 a[112:115], v116 offset:12288
    v_mfma_f32_16x16x32_bf16 v[32:35], a[76:79], a[0:3], 0
    ds_read_b128 a[116:119], v116 offset:13312
    v_mfma_f32_16x16x32_bf16 v[60:63], a[76:79], a[4:7], 0
    s_add_u32 s80, s80, 4096
    buffer_load_dwordx4 a[32:35], v1, s[4:7], s80 offen offset:0 sc1
    s_add_u32 s81, s81, 4096
    buffer_load_dwordx4 a[36:39], v1, s[4:7], s81 offen offset:0 sc1
    v_mfma_f32_16x16x32_bf16 v[36:39], a[80:83], a[0:3], 0
    s_mul_i32 s53, s20, 10240
    s_add_u32 s53, s53, 45056
    s_mul_i32 s52, s26, 143360
    s_add_u32 s52, s52, s53
    s_add_u32 s52, s52, 4231168
    s_mov_b32 m0, s53
    s_nop 0
    buffer_load_dwordx4 v1, s[4:7], s52 offen offset:0 lds
    v_mfma_f32_16x16x32_bf16 v[64:67], a[80:83], a[4:7], 0
    buffer_load_dwordx4 a[40:43], v1, s[4:7], s80 offen offset:1024 sc1
    buffer_load_dwordx4 a[44:47], v1, s[4:7], s81 offen offset:1024 sc1
    v_mfma_f32_16x16x32_bf16 v[40:43], a[84:87], a[0:3], 0
    v_mfma_f32_16x16x32_bf16 v[68:71], a[84:87], a[4:7], 0
    s_mov_b32 m0, s53
    s_nop 0
    buffer_load_dwordx4 v1, s[4:7], s52 offen offset:1024 lds
    v_mfma_f32_16x16x32_bf16 v[44:47], a[88:91], a[0:3], 0
    v_mfma_f32_16x16x32_bf16 v[72:75], a[88:91], a[4:7], 0
    s_waitcnt vmcnt(10)
    s_waitcnt lgkmcnt(0)
    v_mfma_f32_16x16x32_bf16 v[20:23], a[92:95], a[8:11], v[20:23]
    ds_read_b128 a[64:67], v116 offset:14336
    v_mfma_f32_16x16x32_bf16 v[48:51], a[92:95], a[12:15], v[48:51]
    ds_read_b128 a[68:71], v116 offset:15360
    v_mfma_f32_16x16x32_bf16 v[24:27], a[96:99], a[8:11], v[24:27]
    ds_read_b128 a[72:75], v116 offset:16384
    v_mfma_f32_16x16x32_bf16 v[52:55], a[96:99], a[12:15], v[52:55]
    ds_read_b128 a[76:79], v116 offset:17408
    v_mfma_f32_16x16x32_bf16 v[28:31], a[100:103], a[8:11], v[28:31]
    ds_read_b128 a[80:83], v116 offset:18432
    v_mfma_f32_16x16x32_bf16 v[56:59], a[100:103], a[12:15], v[56:59]
    ds_read_b128 a[84:87], v116 offset:19456
    v_mfma_f32_16x16x32_bf16 v[32:35], a[104:107], a[8:11], v[32:35]
    ds_read_b128 a[88:91], v116 offset:20480
    v_mfma_f32_16x16x32_bf16 v[60:63], a[104:107], a[12:15], v[60:63]
    v_mfma_f32_16x16x32_bf16 v[36:39], a[108:111], a[8:11], v[36:39]
    v_mfma_f32_16x16x32_bf16 v[64:67], a[108:111], a[12:15], v[64:67]
    buffer_load_dwordx4 a[48:51], v1, s[4:7], s80 offen offset:2048 sc1
    buffer_load_dwordx4 a[52:55], v1, s[4:7], s81 offen offset:2048 sc1
    v_mfma_f32_16x16x32_bf16 v[40:43], a[112:115], a[8:11], v[40:43]
    v_mfma_f32_16x16x32_bf16 v[68:71], a[112:115], a[12:15], v[68:71]
    s_mov_b32 m0, s53
    s_nop 0
    buffer_load_dwordx4 v1, s[4:7], s52 offen offset:2048 lds
    v_mfma_f32_16x16x32_bf16 v[44:47], a[116:119], a[8:11], v[44:47]
    v_mfma_f32_16x16x32_bf16 v[72:75], a[116:119], a[12:15], v[72:75]
    s_waitcnt vmcnt(11)
    s_waitcnt lgkmcnt(0)
    v_mfma_f32_16x16x32_bf16 v[20:23], a[64:67], a[16:19], v[20:23]
    ds_read_b128 a[92:95], v116 offset:21504
    v_mfma_f32_16x16x32_bf16 v[48:51], a[64:67], a[20:23], v[48:51]
    ds_read_b128 a[96:99], v116 offset:22528
    v_mfma_f32_16x16x32_bf16 v[24:27], a[68:71], a[16:19], v[24:27]
    ds_read_b128 a[100:103], v116 offset:23552
    v_mfma_f32_16x16x32_bf16 v[52:55], a[68:71], a[20:23], v[52:55]
    ds_read_b128 a[104:107], v116 offset:24576
    v_mfma_f32_16x16x32_bf16 v[28:31], a[72:75], a[16:19], v[28:31]
    ds_read_b128 a[108:111], v116 offset:25600
    v_mfma_f32_16x16x32_bf16 v[56:59], a[72:75], a[20:23], v[56:59]
    ds_read_b128 a[112:115], v116 offset:26624
    v_mfma_f32_16x16x32_bf16 v[32:35], a[76:79], a[16:19], v[32:35]
    ds_read_b128 a[116:119], v116 offset:27648
    v_mfma_f32_16x16x32_bf16 v[60:63], a[76:79], a[20:23], v[60:63]
    v_mfma_f32_16x16x32_bf16 v[36:39], a[80:83], a[16:19], v[36:39]
    s_mov_b32 m0, s53
    s_nop 0
    buffer_load_dwordx4 v1, s[4:7], s52 offen offset:3072 lds
    v_mfma_f32_16x16x32_bf16 v[64:67], a[80:83], a[20:23], v[64:67]
    buffer_load_dwordx4 a[56:59], v1, s[4:7], s80 offen offset:3072 sc1
    buffer_load_dwordx4 a[60:63], v1, s[4:7], s81 offen offset:3072 sc1
    v_mfma_f32_16x16x32_bf16 v[40:43], a[84:87], a[16:19], v[40:43]
    v_mfma_f32_16x16x32_bf16 v[68:71], a[84:87], a[20:23], v[68:71]
    s_add_u32 s52, s52, 4096
    s_add_u32 s53, s53, 4096
    s_mov_b32 m0, s53
    s_nop 0
    buffer_load_dwordx4 v1, s[4:7], s52 offen offset:0 lds
    v_mfma_f32_16x16x32_bf16 v[44:47], a[88:91], a[16:19], v[44:47]
    v_mfma_f32_16x16x32_bf16 v[72:75], a[88:91], a[20:23], v[72:75]
    s_waitcnt vmcnt(13)
    s_waitcnt lgkmcnt(0)
    v_mfma_f32_16x16x32_bf16 v[20:23], a[92:95], a[24:27], v[20:23]
    ds_read_b128 a[64:67], v116 offset:28672
    v_mfma_f32_16x16x32_bf16 v[48:51], a[92:95], a[28:31], v[48:51]
    ds_read_b128 a[68:71], v116 offset:29696
    v_mfma_f32_16x16x32_bf16 v[24:27], a[96:99], a[24:27], v[24:27]
    ds_read_b128 a[72:75], v116 offset:30720
    v_mfma_f32_16x16x32_bf16 v[52:55], a[96:99], a[28:31], v[52:55]
    ds_read_b128 a[76:79], v116 offset:31744
    v_mfma_f32_16x16x32_bf16 v[28:31], a[100:103], a[24:27], v[28:31]
    ds_read_b128 a[80:83], v116 offset:32768
    v_mfma_f32_16x16x32_bf16 v[56:59], a[100:103], a[28:31], v[56:59]
    ds_read_b128 a[84:87], v116 offset:33792
    v_mfma_f32_16x16x32_bf16 v[32:35], a[104:107], a[24:27], v[32:35]
    ds_read_b128 a[88:91], v116 offset:34816
    v_mfma_f32_16x16x32_bf16 v[60:63], a[104:107], a[28:31], v[60:63]
    v_mfma_f32_16x16x32_bf16 v[36:39], a[108:111], a[24:27], v[36:39]
    v_mfma_f32_16x16x32_bf16 v[64:67], a[108:111], a[28:31], v[64:67]
    s_add_u32 s80, s80, 4096
    buffer_load_dwordx4 a[0:3], v1, s[4:7], s80 offen offset:0 sc1
    s_add_u32 s81, s81, 4096
    buffer_load_dwordx4 a[4:7], v1, s[4:7], s81 offen offset:0 sc1
    v_mfma_f32_16x16x32_bf16 v[40:43], a[112:115], a[24:27], v[40:43]
    v_mfma_f32_16x16x32_bf16 v[68:71], a[112:115], a[28:31], v[68:71]
    s_mov_b32 m0, s53
    s_nop 0
    buffer_load_dwordx4 v1, s[4:7], s52 offen offset:1024 lds
    v_mfma_f32_16x16x32_bf16 v[44:47], a[116:119], a[24:27], v[44:47]
    v_mfma_f32_16x16x32_bf16 v[72:75], a[116:119], a[28:31], v[72:75]
    s_cmp_lg_u32 s28, 0
    s_cbranch_scc1 L_cs1b_43
    v_add_u32 v7, 161088, v1
    s_mov_b64 exec, 0xfffffff
    ds_read_b128 v[92:95], v7 offset:0
    ds_read_b128 v[96:99], v7 offset:448
    ds_read_b128 v[100:103], v7 offset:896
    ds_read_b128 v[104:107], v7 offset:1344
    s_waitcnt lgkmcnt(0)
    v_add_f32 v92, v92, v96
    v_add_f32 v93, v93, v97
    v_add_f32 v94, v94, v98
    v_add_f32 v95, v95, v99
    v_add_f32 v100, v100, v104
    v_add_f32 v101, v101, v105
    v_add_f32 v102, v102, v106
    v_add_f32 v103, v103, v107
    v_add_f32 v92, v92, v100
    v_add_f32 v93, v93, v101
    v_add_f32 v94, v94, v102
    v_add_f32 v95, v95, v103
    v_add_u32 v7, 159744, v1
    ds_write_b128 v7, v[92:95]
    s_mov_b64 exec, -1
    s_waitcnt lgkmcnt(0)
L_cs1b_43:
    s_waitcnt vmcnt(14)
    s_waitcnt lgkmcnt(0)
    v_mfma_f32_16x16x32_bf16 v[20:23], a[64:67], a[32:35], v[20:23]
    ds_read_b128 a[92:95], v116 offset:35840
    s_add_u32 s37, s20, 1
    v_mfma_f32_16x16x32_bf16 v[48:51], a[64:67], a[36:39], v[48:51]
    ds_read_b128 a[96:99], v116 offset:36864
    s_and_b32 s37, s37, 3
    v_mfma_f32_16x16x32_bf16 v[24:27], a[68:71], a[32:35], v[24:27]
    ds_read_b128 a[100:103], v116 offset:37888
    s_mul_i32 s44, s37, 5120
    v_mfma_f32_16x16x32_bf16 v[52:55], a[68:71], a[36:39], v[52:55]
    ds_read_b128 a[104:107], v116 offset:38912
    s_add_u32 s44, s44, 122880
    v_mfma_f32_16x16x32_bf16 v[28:31], a[72:75], a[32:35], v[28:31]
    ds_read_b128 a[108:111], v116 offset:39936
    s_mul_i32 s30, s37, 57344
    v_mfma_f32_16x16x32_bf16 v[56:59], a[72:75], a[36:39], v[56:59]
    ds_read_b128 a[112:115], v116 offset:40960
    s_mul_i32 s36, s21, 1703936
    v_mfma_f32_16x16x32_bf16 v[32:35], a[76:79], a[32:35], v[32:35]
    ds_read_b128 a[116:119], v116 offset:41984
    s_add_u32 s30, s30, s36
    v_mfma_f32_16x16x32_bf16 v[60:63], a[76:79], a[36:39], v[60:63]
    s_and_b32 s36, s23, 3
    v_mfma_f32_16x16x32_bf16 v[36:39], a[80:83], a[32:35], v[36:39]
    s_mov_b32 m0, s53
    s_nop 0
    buffer_load_dwordx4 v1, s[4:7], s52 offen offset:2048 lds
    s_mul_i32 s36, s36, 229376
    v_mfma_f32_16x16x32_bf16 v[64:67], a[80:83], a[36:39], v[64:67]
    buffer_load_dwordx4 a[8:11], v1, s[4:7], s80 offen offset:1024 sc1
    buffer_load_dwordx4 a[12:15], v1, s[4:7], s81 offen offset:1024 sc1
    s_add_u32 s30, s30, s36
    v_mfma_f32_16x16x32_bf16 v[40:43], a[84:87], a[32:35], v[40:43]
    s_mul_i32 s36, s20, 14336
    v_mfma_f32_16x16x32_bf16 v[68:71], a[84:87], a[36:39], v[68:71]
    s_mov_b32 m0, s53
    s_nop 0
    buffer_load_dwordx4 v1, s[4:7], s52 offen offset:3072 lds
    s_add_u32 s30, s30, s36
    v_mfma_f32_16x16x32_bf16 v[44:47], a[88:91], a[32:35], v[44:47]
    s_add_u32 s30, s30, 7929856
    v_mfma_f32_16x16x32_bf16 v[72:75], a[88:91], a[36:39], v[72:75]
    s_add_u32 s37, s20, 2
    s_waitcnt vmcnt(15)
    s_waitcnt lgkmcnt(0)
    v_mfma_f32_16x16x32_bf16 v[20:23], a[92:95], a[40:43], v[20:23]
    ds_read_b128 a[64:67], v116 offset:43008
    s_and_b32 s37, s37, 3
    v_mfma_f32_16x16x32_bf16 v[48:51], a[92:95], a[44:47], v[48:51]
    ds_read_b128 a[68:71], v116 offset:44032
    s_mul_i32 s45, s37, 5120
    v_mfma_f32_16x16x32_bf16 v[24:27], a[96:99], a[40:43], v[24:27]
    ds_read_b128 a[72:75], v116 offset:45056
    s_add_u32 s45, s45, 122880
    v_mfma_f32_16x16x32_bf16 v[52:55], a[96:99], a[44:47], v[52:55]
    ds_read_b128 a[76:79], v116 offset:46080
    s_mul_i32 s31, s37, 57344
    v_mfma_f32_16x16x32_bf16 v[28:31], a[100:103], a[40:43], v[28:31]
    ds_read_b128 a[80:83], v116 offset:47104
    s_mul_i32 s36, s21, 1703936
    v_mfma_f32_16x16x32_bf16 v[56:59], a[100:103], a[44:47], v[56:59]
    ds_read_b128 a[84:87], v116 offset:48128
    s_add_u32 s31, s31, s36
    v_mfma_f32_16x16x32_bf16 v[32:35], a[104:107], a[40:43], v[32:35]
    ds_read_b128 a[88:91], v116 offset:49152
    s_and_b32 s36, s23, 3
    v_mfma_f32_16x16x32_bf16 v[60:63], a[104:107], a[44:47], v[60:63]
    s_mul_i32 s36, s36, 229376
    v_mfma_f32_16x16x32_bf16 v[36:39], a[108:111], a[40:43], v[36:39]
    s_add_u32 s31, s31, s36
    v_mfma_f32_16x16x32_bf16 v[64:67], a[108:111], a[44:47], v[64:67]
    buffer_load_dwordx4 a[16:19], v1, s[4:7], s80 offen offset:2048 sc1
    buffer_load_dwordx4 a[20:23], v1, s[4:7], s81 offen offset:2048 sc1
    s_mul_i32 s36, s20, 14336
    v_mfma_f32_16x16x32_bf16 v[40:43], a[112:115], a[40:43], v[40:43]
    s_add_u32 s31, s31, s36
    v_mfma_f32_16x16x32_bf16 v[68:71], a[112:115], a[44:47], v[68:71]
    s_add_u32 s52, s52, 4096
    s_add_u32 s53, s53, 4096
    s_mov_b32 m0, s53
    s_nop 0
    buffer_load_dwordx4 v1, s[4:7], s52 offen offset:0 lds
    s_add_u32 s31, s31, 7929856
    v_mfma_f32_16x16x32_bf16 v[44:47], a[116:119], a[40:43], v[44:47]
    s_add_u32 s37, s20, 3
    v_mfma_f32_16x16x32_bf16 v[72:75], a[116:119], a[44:47], v[72:75]
    s_and_b32 s37, s37, 3
    s_waitcnt vmcnt(15)
    s_waitcnt lgkmcnt(0)
    v_mfma_f32_16x16x32_bf16 v[20:23], a[64:67], a[48:51], v[20:23]
    ds_read_b128 a[92:95], v116 offset:50176
    s_mul_i32 s46, s37, 5120
    v_mfma_f32_16x16x32_bf16 v[48:51], a[64:67], a[52:55], v[48:51]
    ds_read_b128 a[96:99], v116 offset:51200
    s_add_u32 s46, s46, 122880
    v_mfma_f32_16x16x32_bf16 v[24:27], a[68:71], a[48:51], v[24:27]
    ds_read_b128 a[100:103], v116 offset:52224
    s_mul_i32 s32, s37, 57344
    v_mfma_f32_16x16x32_bf16 v[52:55], a[68:71], a[52:55], v[52:55]
    ds_read_b128 a[104:107], v116 offset:53248
    s_mul_i32 s36, s21, 1703936
    v_mfma_f32_16x16x32_bf16 v[28:31], a[72:75], a[48:51], v[28:31]
    ds_read_b128 a[108:111], v116 offset:54272
    s_add_u32 s32, s32, s36
    v_mfma_f32_16x16x32_bf16 v[56:59], a[72:75], a[52:55], v[56:59]
    ds_read_b128 a[112:115], v116 offset:55296
    s_and_b32 s36, s23, 3
    v_mfma_f32_16x16x32_bf16 v[32:35], a[76:79], a[48:51], v[32:35]
    ds_read_b128 a[116:119], v116 offset:56320
    s_mul_i32 s36, s36, 229376
    v_mfma_f32_16x16x32_bf16 v[60:63], a[76:79], a[52:55], v[60:63]
    s_add_u32 s32, s32, s36
    v_mfma_f32_16x16x32_bf16 v[36:39], a[80:83], a[48:51], v[36:39]
    s_mov_b32 m0, s53
    s_nop 0
    buffer_load_dwordx4 v1, s[4:7], s52 offen offset:1024 lds
    s_mul_i32 s36, s20, 14336
    v_mfma_f32_16x16x32_bf16 v[64:67], a[80:83], a[52:55], v[64:67]
    buffer_load_dwordx4 a[24:27], v1, s[4:7], s80 offen offset:3072 sc1
    buffer_load_dwordx4 a[28:31], v1, s[4:7], s81 offen offset:3072 sc1
    s_add_u32 s32, s32, s36
    v_mfma_f32_16x16x32_bf16 v[40:43], a[84:87], a[48:51], v[40:43]
    s_add_u32 s32, s32, 7929856
    v_mfma_f32_16x16x32_bf16 v[68:71], a[84:87], a[52:55], v[68:71]
    buffer_load_dwordx4 v[76:79], v1, s[4:7], s82 offen offset:0 sc1
    s_add_u32 s37, s20, 4
    v_mfma_f32_16x16x32_bf16 v[44:47], a[88:91], a[48:51], v[44:47]
    s_and_b32 s37, s37, 3
    v_mfma_f32_16x16x32_bf16 v[72:75], a[88:91], a[52:55], v[72:75]
    s_mul_i32 s47, s37, 5120
    s_waitcnt vmcnt(15)
    s_waitcnt lgkmcnt(0)
    v_mfma_f32_16x16x32_bf16 v[20:23], a[92:95], a[56:59], v[20:23]
    ds_read_b128 a[64:67], v117 offset:0
    s_add_u32 s47, s47, 122880
    v_mfma_f32_16x16x32_bf16 v[48:51], a[92:95], a[60:63], v[48:51]
    ds_read_b128 a[68:71], v117 offset:1024
    s_mul_i32 s33, s37, 57344
    v_mfma_f32_16x16x32_bf16 v[24:27], a[96:99], a[56:59], v[24:27]
    ds_read_b128 a[72:75], v117 offset:2048
    s_mul_i32 s36, s21, 1703936
    v_mfma_f32_16x16x32_bf16 v[52:55], a[96:99], a[60:63], v[52:55]
    ds_read_b128 a[76:79], v117 offset:3072
    s_add_u32 s33, s33, s36
    v_mfma_f32_16x16x32_bf16 v[28:31], a[100:103], a[56:59], v[28:31]
    ds_read_b128 a[80:83], v117 offset:4096
    s_and_b32 s36, s23, 3
    v_mfma_f32_16x16x32_bf16 v[56:59], a[100:103], a[60:63], v[56:59]
    ds_read_b128 a[84:87], v117 offset:5120
    s_mul_i32 s36, s36, 229376
    v_mfma_f32_16x16x32_bf16 v[32:35], a[104:107], a[56:59], v[32:35]
    ds_read_b128 a[88:91], v117 offset:6144
    s_add_u32 s33, s33, s36
    v_mfma_f32_16x16x32_bf16 v[60:63], a[104:107], a[60:63], v[60:63]
    s_mul_i32 s36, s20, 14336
    v_mfma_f32_16x16x32_bf16 v[36:39], a[108:111], a[56:59], v[36:39]
    s_add_u32 s33, s33, s36
    v_mfma_f32_16x16x32_bf16 v[64:67], a[108:111], a[60:63], v[64:67]
    s_add_u32 s80, s80, 4096
    buffer_load_dwordx4 a[32:35], v1, s[4:7], s80 offen offset:0 sc1
    s_add_u32 s81, s81, 4096
    buffer_load_dwordx4 a[36:39], v1, s[4:7], s81 offen offset:0 sc1
    s_add_u32 s33, s33, 7929856
    v_mfma_f32_16x16x32_bf16 v[40:43], a[112:115], a[56:59], v[40:43]
    s_mul_i32 s38, s21, 1703936
    v_mfma_f32_16x16x32_bf16 v[68:71], a[112:115], a[60:63], v[68:71]
    buffer_load_dwordx4 v[80:83], v1, s[4:7], s82 offen offset:1024 sc1
    s_and_b32 s36, s23, 3
    v_mfma_f32_16x16x32_bf16 v[44:47], a[116:119], a[56:59], v[44:47]
    s_mul_i32 s36, s36, 81920
    v_mfma_f32_16x16x32_bf16 v[72:75], a[116:119], a[60:63], v[72:75]
    s_add_u32 s38, s38, s36
    s_waitcnt vmcnt(15)
    s_waitcnt lgkmcnt(0)
    v_mfma_f32_16x16x32_bf16 v[20:23], a[64:67], a[0:3], v[20:23]
    ds_read_b128 a[92:95], v117 offset:7168
    s_mul_i32 s36, s20, 20480
    v_mfma_f32_16x16x32_bf16 v[48:51], a[64:67], a[4:7], v[48:51]
    ds_read_b128 a[96:99], v117 offset:8192
    s_add_u32 s38, s38, s36
    v_mfma_f32_16x16x32_bf16 v[24:27], a[68:71], a[0:3], v[24:27]
    ds_read_b128 a[100:103], v117 offset:9216
    s_lshr_b32 s36, s24, 1
    v_mfma_f32_16x16x32_bf16 v[52:55], a[68:71], a[4:7], v[52:55]
    ds_read_b128 a[104:107], v117 offset:10240
    s_mul_i32 s36, s36, 5120
    v_mfma_f32_16x16x32_bf16 v[28:31], a[72:75], a[0:3], v[28:31]
    ds_read_b128 a[108:111], v117 offset:11264
    s_add_u32 s38, s38, s36
    v_mfma_f32_16x16x32_bf16 v[56:59], a[72:75], a[4:7], v[56:59]
    ds_read_b128 a[112:115], v117 offset:12288
    s_add_u32 s38, s38, 7274496
    v_mfma_f32_16x16x32_bf16 v[32:35], a[76:79], a[0:3], v[32:35]
    ds_read_b128 a[116:119], v117 offset:13312
    s_and_b32 s39, s24, 1
    v_mfma_f32_16x16x32_bf16 v[60:63], a[76:79], a[4:7], v[60:63]
    s_mul_i32 s39, s39, 3072
    v_mfma_f32_16x16x32_bf16 v[36:39], a[80:83], a[0:3], v[36:39]
    buffer_load_dwordx4 v[84:87], v1, s[4:7], s82 offen offset:2048 sc1
    s_add_u32 s39, s39, s38
    v_mfma_f32_16x16x32_bf16 v[64:67], a[80:83], a[4:7], v[64:67]
    buffer_load_dwordx4 a[40:43], v1, s[4:7], s80 offen offset:1024 sc1
    buffer_load_dwordx4 a[44:47], v1, s[4:7], s81 offen offset:1024 sc1
    s_and_b32 s36, s24, 1
    v_mfma_f32_16x16x32_bf16 v[40:43], a[84:87], a[0:3], v[40:43]
    s_lshl_b32 s36, s36, 3
    v_mfma_f32_16x16x32_bf16 v[68:71], a[84:87], a[4:7], v[68:71]
    buffer_load_dwordx4 v[88:91], v1, s[4:7], s82 offen offset:3072 sc1
    s_add_u32 s38, s38, s36
    v_mfma_f32_16x16x32_bf16 v[44:47], a[88:91], a[0:3], v[44:47]
    s_mul_i32 s41, s21, 1703936
    v_mfma_f32_16x16x32_bf16 v[72:75], a[88:91], a[4:7], v[72:75]
    s_and_b32 s36, s23, 3
    s_waitcnt vmcnt(15)
    s_waitcnt lgkmcnt(0)
    v_mfma_f32_16x16x32_bf16 v[20:23], a[92:95], a[8:11], v[20:23]
    ds_read_b128 a[64:67], v117 offset:14336
    s_mul_i32 s36, s36, 16384
    v_mfma_f32_16x16x32_bf16 v[48:51], a[92:95], a[12:15], v[48:51]
    ds_read_b128 a[68:71], v117 offset:15360
    s_add_u32 s41, s41, s36
    v_mfma_f32_16x16x32_bf16 v[24:27], a[96:99], a[8:11], v[24:27]
    ds_read_b128 a[72:75], v117 offset:16384
    s_mul_i32 s36, s20, 4096
    v_mfma_f32_16x16x32_bf16 v[52:55], a[96:99], a[12:15], v[52:55]
    ds_read_b128 a[76:79], v117 offset:17408
    s_add_u32 s41, s41, s36
    v_mfma_f32_16x16x32_bf16 v[28:31], a[100:103], a[8:11], v[28:31]
    ds_read_b128 a[80:83], v117 offset:18432
    s_and_b32 s36, s24, 1
    v_mfma_f32_16x16x32_bf16 v[56:59], a[100:103], a[12:15], v[56:59]
    ds_read_b128 a[84:87], v117 offset:19456
    s_mul_i32 s36, s36, 2048
    v_mfma_f32_16x16x32_bf16 v[32:35], a[104:107], a[8:11], v[32:35]
    ds_read_b128 a[88:91], v117 offset:20480
    s_add_u32 s41, s41, s36
    v_mfma_f32_16x16x32_bf16 v[60:63], a[104:107], a[12:15], v[60:63]
    s_lshr_b32 s36, s24, 1
    v_mfma_f32_16x16x32_bf16 v[36:39], a[108:111], a[8:11], v[36:39]
    s_mul_i32 s36, s36, 256
    v_mfma_f32_16x16x32_bf16 v[64:67], a[108:111], a[12:15], v[64:67]
    buffer_load_dwordx4 a[48:51], v1, s[4:7], s80 offen offset:2048 sc1
    buffer_load_dwordx4 a[52:55], v1, s[4:7], s81 offen offset:2048 sc1
    s_add_u32 s41, s41, s36
    v_mfma_f32_16x16x32_bf16 v[40:43], a[112:115], a[8:11], v[40:43]
    s_add_u32 s41, s41, 8847360
    v_mfma_f32_16x16x32_bf16 v[68:71], a[112:115], a[12:15], v[68:71]
    buffer_load_dwordx4 v[92:95], v1, s[4:7], s83 offen offset:0 sc1
    s_mul_i32 s40, s23, 128
    v_mfma_f32_16x16x32_bf16 v[44:47], a[116:119], a[8:11], v[44:47]
    s_lshr_b32 s36, s24, 1
    v_mfma_f32_16x16x32_bf16 v[72:75], a[116:119], a[12:15], v[72:75]
    s_mul_i32 s36, s36, 32
    s_waitcnt vmcnt(15)
    s_waitcnt lgkmcnt(0)
    v_mfma_f32_16x16x32_bf16 v[20:23], a[64:67], a[16:19], v[20:23]
    ds_read_b128 a[92:95], v117 offset:21504
    s_add_u32 s40, s40, s36
    v_mfma_f32_16x16x32_bf16 v[48:51], a[64:67], a[20:23], v[48:51]
    ds_read_b128 a[96:99], v117 offset:22528
    s_mul_i32 s36, s20, 8
    v_mfma_f32_16x16x32_bf16 v[24:27], a[68:71], a[16:19], v[24:27]
    ds_read_b128 a[100:103], v117 offset:23552
    s_add_u32 s40, s40, s36
    v_mfma_f32_16x16x32_bf16 v[52:55], a[68:71], a[20:23], v[52:55]
    ds_read_b128 a[104:107], v117 offset:24576
    s_and_b32 s36, s24, 1
    v_mfma_f32_16x16x32_bf16 v[28:31], a[72:75], a[16:19], v[28:31]
    ds_read_b128 a[108:111], v117 offset:25600
    s_mul_i32 s36, s36, 4
    v_mfma_f32_16x16x32_bf16 v[56:59], a[72:75], a[20:23], v[56:59]
    ds_read_b128 a[112:115], v117 offset:26624
    s_add_u32 s40, s40, s36
    v_mfma_f32_16x16x32_bf16 v[32:35], a[76:79], a[16:19], v[32:35]
    ds_read_b128 a[116:119], v117 offset:27648
    s_add_u32 s40, s40, s28
    v_mfma_f32_16x16x32_bf16 v[60:63], a[76:79], a[20:23], v[60:63]
    s_add_u32 s40, s40, 7270400
    v_mfma_f32_16x16x32_bf16 v[36:39], a[80:83], a[16:19], v[36:39]
    buffer_load_dwordx4 v[96:99], v1, s[4:7], s83 offen offset:1024 sc1
    s_mov_b32 s66, 0x00003f80
    v_mfma_f32_16x16x32_bf16 v[64:67], a[80:83], a[20:23], v[64:67]
    buffer_load_dwordx4 a[56:59], v1, s[4:7], s80 offen offset:3072 sc1
    buffer_load_dwordx4 a[60:63], v1, s[4:7], s81 offen offset:3072 sc1
    s_mov_b32 s67, 0x3f800000
    v_mfma_f32_16x16x32_bf16 v[40:43], a[84:87], a[16:19], v[40:43]
    s_mov_b32 s68, 0x3f803f80
    v_mfma_f32_16x16x32_bf16 v[68:71], a[84:87], a[20:23], v[68:71]
    buffer_load_dwordx4 v[100:103], v1, s[4:7], s83 offen offset:2048 sc1
    v_lshrrev_b32 v18, 1, v4
    v_mfma_f32_16x16x32_bf16 v[44:47], a[88:91], a[16:19], v[44:47]
    v_lshlrev_b32 v18, 10, v18
    v_mfma_f32_16x16x32_bf16 v[72:75], a[88:91], a[20:23], v[72:75]
    v_lshl_add_u32 v18, v3, 4, v18
    s_waitcnt vmcnt(15)
    s_waitcnt lgkmcnt(0)
    v_mfma_f32_16x16x32_bf16 v[20:23], a[92:95], a[24:27], v[20:23]
    ds_read_b128 a[64:67], v117 offset:28672
    v_and_b32 v6, 1, v4
    v_mfma_f32_16x16x32_bf16 v[48:51], a[92:95], a[28:31], v[48:51]
    ds_read_b128 a[68:71], v117 offset:29696
    v_lshl_add_u32 v18, v6, 3, v18
    v_mfma_f32_16x16x32_bf16 v[24:27], a[96:99], a[24:27], v[24:27]
    ds_read_b128 a[72:75], v117 offset:30720
    s_mul_i32 s48, s23, 128
    v_mfma_f32_16x16x32_bf16 v[52:55], a[96:99], a[28:31], v[52:55]
    ds_read_b128 a[76:79], v117 offset:31744
    s_mul_i32 s36, s20, 32
    v_mfma_f32_16x16x32_bf16 v[28:31], a[100:103], a[24:27], v[28:31]
    ds_read_b128 a[80:83], v117 offset:32768
    s_add_u32 s48, s48, s36
    v_mfma_f32_16x16x32_bf16 v[56:59], a[100:103], a[28:31], v[56:59]
    ds_read_b128 a[84:87], v117 offset:33792
    s_add_u32 s48, s48, s28
    v_mfma_f32_16x16x32_bf16 v[32:35], a[104:107], a[24:27], v[32:35]
    ds_read_b128 a[88:91], v117 offset:34816
    s_add_u32 s48, s48, 7065600
    v_mfma_f32_16x16x32_bf16 v[60:63], a[104:107], a[28:31], v[60:63]
    v_mfma_f32_16x16x32_bf16 v[36:39], a[108:111], a[24:27], v[36:39]
    v_mfma_f32_16x16x32_bf16 v[64:67], a[108:111], a[28:31], v[64:67]
    s_add_u32 s80, s80, 4096
    buffer_load_dwordx4 a[0:3], v1, s[4:7], s80 offen offset:0 sc1
    s_add_u32 s81, s81, 4096
    buffer_load_dwordx4 a[4:7], v1, s[4:7], s81 offen offset:0 sc1
    v_mfma_f32_16x16x32_bf16 v[40:43], a[112:115], a[24:27], v[40:43]
    v_mfma_f32_16x16x32_bf16 v[68:71], a[112:115], a[28:31], v[68:71]
    buffer_load_dwordx4 v[104:107], v1, s[4:7], s83 offen offset:3072 sc1
    v_mfma_f32_16x16x32_bf16 v[44:47], a[116:119], a[24:27], v[44:47]
    v_mfma_f32_16x16x32_bf16 v[72:75], a[116:119], a[28:31], v[72:75]
    s_waitcnt vmcnt(15)
    s_waitcnt lgkmcnt(0)
    v_mfma_f32_16x16x32_bf16 v[20:23], a[64:67], a[32:35], v[20:23]
    ds_read_b128 a[92:95], v117 offset:35840
    v_mfma_f32_16x16x32_bf16 v[48:51], a[64:67], a[36:39], v[48:51]
    ds_read_b128 a[96:99], v117 offset:36864
    v_mfma_f32_16x16x32_bf16 v[24:27], a[68:71], a[32:35], v[24:27]
    ds_read_b128 a[100:103], v117 offset:37888
    v_mfma_f32_16x16x32_bf16 v[52:55], a[68:71], a[36:39], v[52:55]
    ds_read_b128 a[104:107], v117 offset:38912
    v_mfma_f32_16x16x32_bf16 v[28:31], a[72:75], a[32:35], v[28:31]
    ds_read_b128 a[108:111], v117 offset:39936
    v_mfma_f32_16x16x32_bf16 v[56:59], a[72:75], a[36:39], v[56:59]
    ds_read_b128 a[112:115], v117 offset:40960
    v_mfma_f32_16x16x32_bf16 v[32:35], a[76:79], a[32:35], v[32:35]
    ds_read_b128 a[116:119], v117 offset:41984
    v_mfma_f32_16x16x32_bf16 v[60:63], a[76:79], a[36:39], v[60:63]
    v_mfma_f32_16x16x32_bf16 v[36:39], a[80:83], a[32:35], v[36:39]
    buffer_load_dwordx4 a[144:147], v1, s[4:7], s50 offen offset:3072
    v_mfma_f32_16x16x32_bf16 v[64:67], a[80:83], a[36:39], v[64:67]
    buffer_load_dwordx4 a[8:11], v1, s[4:7], s80 offen offset:1024 sc1
    buffer_load_dwordx4 a[12:15], v1, s[4:7], s81 offen offset:1024 sc1
    v_mfma_f32_16x16x32_bf16 v[40:43], a[84:87], a[32:35], v[40:43]
    v_mfma_f32_16x16x32_bf16 v[68:71], a[84:87], a[36:39], v[68:71]
    s_add_u32 s50, s50, 4096
    buffer_load_dwordx4 a[148:151], v1, s[4:7], s50 offen offset:0
    v_mfma_f32_16x16x32_bf16 v[44:47], a[88:91], a[32:35], v[44:47]
    v_mfma_f32_16x16x32_bf16 v[72:75], a[88:91], a[36:39], v[72:75]
    s_waitcnt vmcnt(15)
    s_barrier
    s_waitcnt lgkmcnt(0)
    v_mfma_f32_16x16x32_bf16 v[20:23], a[92:95], a[40:43], v[20:23]
    ds_read_b128 a[64:67], v117 offset:43008
    v_mfma_f32_16x16x32_bf16 v[48:51], a[92:95], a[44:47], v[48:51]
    ds_read_b128 a[68:71], v117 offset:44032
    v_mfma_f32_16x16x32_bf16 v[24:27], a[96:99], a[40:43], v[24:27]
    ds_read_b128 a[72:75], v117 offset:45056
    v_mfma_f32_16x16x32_bf16 v[52:55], a[96:99], a[44:47], v[52:55]
    ds_read_b128 a[76:79], v117 offset:46080
    v_mfma_f32_16x16x32_bf16 v[28:31], a[100:103], a[40:43], v[28:31]
    ds_read_b128 a[80:83], v117 offset:47104
    v_mfma_f32_16x16x32_bf16 v[56:59], a[100:103], a[44:47], v[56:59]
    ds_read_b128 a[84:87], v117 offset:48128
    v_mfma_f32_16x16x32_bf16 v[32:35], a[104:107], a[40:43], v[32:35]
    ds_read_b128 a[88:91], v117 offset:49152
    v_mfma_f32_16x16x32_bf16 v[60:63], a[104:107], a[44:47], v[60:63]
    v_mfma_f32_16x16x32_bf16 v[36:39], a[108:111], a[40:43], v[36:39]
    v_mfma_f32_16x16x32_bf16 v[64:67], a[108:111], a[44:47], v[64:67]
    buffer_load_dwordx4 a[16:19], v1, s[4:7], s80 offen offset:2048 sc1
    buffer_load_dwordx4 a[20:23], v1, s[4:7], s81 offen offset:2048 sc1
    v_mfma_f32_16x16x32_bf16 v[40:43], a[112:115], a[40:43], v[40:43]
    v_mfma_f32_16x16x32_bf16 v[68:71], a[112:115], a[44:47], v[68:71]
    buffer_load_dwordx4 a[152:155], v1, s[4:7], s50 offen offset:1024
    v_mfma_f32_16x16x32_bf16 v[44:47], a[116:119], a[40:43], v[44:47]
    v_mfma_f32_16x16x32_bf16 v[72:75], a[116:119], a[44:47], v[72:75]
    s_waitcnt vmcnt(15)
    s_waitcnt lgkmcnt(0)
    v_mfma_f32_16x16x32_bf16 v[20:23], a[64:67], a[48:51], v[20:23]
    ds_read_b128 a[92:95], v117 offset:50176
    v_mfma_f32_16x16x32_bf16 v[48:51], a[64:67], a[52:55], v[48:51]
    ds_read_b128 a[96:99], v117 offset:51200
    v_mfma_f32_16x16x32_bf16 v[24:27], a[68:71], a[48:51], v[24:27]
    ds_read_b128 a[100:103], v117 offset:52224
    v_mfma_f32_16x16x32_bf16 v[52:55], a[68:71], a[52:55], v[52:55]
    ds_read_b128 a[104:107], v117 offset:53248
    v_mfma_f32_16x16x32_bf16 v[28:31], a[72:75], a[48:51], v[28:31]
    ds_read_b128 a[108:111], v117 offset:54272
    v_mfma_f32_16x16x32_bf16 v[56:59], a[72:75], a[52:55], v[56:59]
    ds_read_b128 a[112:115], v117 offset:55296
    v_mfma_f32_16x16x32_bf16 v[32:35], a[76:79], a[48:51], v[32:35]
    ds_read_b128 a[116:119], v117 offset:56320
    v_mfma_f32_16x16x32_bf16 v[60:63], a[76:79], a[52:55], v[60:63]
    v_mfma_f32_16x16x32_bf16 v[36:39], a[80:83], a[48:51], v[36:39]
    buffer_load_dwordx4 a[156:159], v1, s[4:7], s50 offen offset:2048
    v_mfma_f32_16x16x32_bf16 v[64:67], a[80:83], a[52:55], v[64:67]
    buffer_load_dwordx4 a[24:27], v1, s[4:7], s80 offen offset:3072 sc1
    buffer_load_dwordx4 a[28:31], v1, s[4:7], s81 offen offset:3072 sc1
    v_mfma_f32_16x16x32_bf16 v[40:43], a[84:87], a[48:51], v[40:43]
    v_mfma_f32_16x16x32_bf16 v[68:71], a[84:87], a[52:55], v[68:71]
    buffer_load_dwordx4 a[160:163], v1, s[4:7], s50 offen offset:3072
    v_mfma_f32_16x16x32_bf16 v[44:47], a[88:91], a[48:51], v[44:47]
    v_mfma_f32_16x16x32_bf16 v[72:75], a[88:91], a[52:55], v[72:75]
    s_waitcnt vmcnt(15)
    s_waitcnt lgkmcnt(0)
    v_mfma_f32_16x16x32_bf16 v[20:23], a[92:95], a[56:59], v[20:23]
    ds_read_b128 a[64:67], v118 offset:0
    v_mfma_f32_16x16x32_bf16 v[48:51], a[92:95], a[60:63], v[48:51]
    ds_read_b128 a[68:71], v118 offset:1024
    v_mfma_f32_16x16x32_bf16 v[24:27], a[96:99], a[56:59], v[24:27]
    ds_read_b128 a[72:75], v118 offset:2048
    v_mfma_f32_16x16x32_bf16 v[52:55], a[96:99], a[60:63], v[52:55]
    ds_read_b128 a[76:79], v118 offset:3072
    v_mfma_f32_16x16x32_bf16 v[28:31], a[100:103], a[56:59], v[28:31]
    ds_read_b128 a[80:83], v118 offset:4096
    v_mfma_f32_16x16x32_bf16 v[56:59], a[100:103], a[60:63], v[56:59]
    ds_read_b128 a[84:87], v118 offset:5120
    s_add_u32 s50, s50, 4096
    buffer_load_dwordx4 a[164:167], v1, s[4:7], s50 offen offset:0
    v_mfma_f32_16x16x32_bf16 v[32:35], a[104:107], a[56:59], v[32:35]
    ds_read_b128 a[88:91], v118 offset:6144
    v_mfma_f32_16x16x32_bf16 v[60:63], a[104:107], a[60:63], v[60:63]
    v_mfma_f32_16x16x32_bf16 v[36:39], a[108:111], a[56:59], v[36:39]
    buffer_load_dwordx4 a[168:171], v1, s[4:7], s50 offen offset:1024
    v_mfma_f32_16x16x32_bf16 v[64:67], a[108:111], a[60:63], v[64:67]
    v_mfma_f32_16x16x32_bf16 v[40:43], a[112:115], a[56:59], v[40:43]
    v_mfma_f32_16x16x32_bf16 v[68:71], a[112:115], a[60:63], v[68:71]
    buffer_load_dwordx4 a[172:175], v1, s[4:7], s50 offen offset:2048
    v_mfma_f32_16x16x32_bf16 v[44:47], a[116:119], a[56:59], v[44:47]
    v_mfma_f32_16x16x32_bf16 v[72:75], a[116:119], a[60:63], v[72:75]
    s_waitcnt vmcnt(15)
    s_waitcnt vmcnt(14)
    s_waitcnt lgkmcnt(0)
    v_mfma_f32_16x16x32_bf16 v[20:23], a[64:67], a[0:3], v[20:23]
    ds_read_b128 a[92:95], v118 offset:7168
    v_add_f32 v76, v76, v84
    v_add_f32 v77, v77, v85
    v_mfma_f32_16x16x32_bf16 v[48:51], a[64:67], a[4:7], v[48:51]
    ds_read_b128 a[96:99], v118 offset:8192
    v_add_f32 v78, v78, v86
    v_add_f32 v79, v79, v87
    v_mfma_f32_16x16x32_bf16 v[24:27], a[68:71], a[0:3], v[24:27]
    ds_read_b128 a[100:103], v118 offset:9216
    v_add_f32 v80, v80, v88
    v_add_f32 v81, v81, v89
    v_mfma_f32_16x16x32_bf16 v[52:55], a[68:71], a[4:7], v[52:55]
    ds_read_b128 a[104:107], v118 offset:10240
    v_add_f32 v82, v82, v90
    v_add_f32 v83, v83, v91
    v_mfma_f32_16x16x32_bf16 v[28:31], a[72:75], a[0:3], v[28:31]
    ds_read_b128 a[108:111], v118 offset:11264
    v_add_f32 v76, v76, v80
    v_add_f32 v77, v77, v81
    v_mfma_f32_16x16x32_bf16 v[56:59], a[72:75], a[4:7], v[56:59]
    ds_read_b128 a[112:115], v118 offset:12288
    buffer_load_dwordx4 a[176:179], v1, s[4:7], s50 offen offset:3072
    v_add_f32 v78, v78, v82
    v_add_f32 v79, v79, v83
    v_mfma_f32_16x16x32_bf16 v[32:35], a[76:79], a[0:3], v[32:35]
    ds_read_b128 a[116:119], v118 offset:13312
    v_add_f32 v76, v76, v78
    v_add_f32 v77, v77, v79
    v_mfma_f32_16x16x32_bf16 v[60:63], a[76:79], a[4:7], v[60:63]
    v_mov_b32 v78, v76
    v_mov_b32 v79, v77
    v_mfma_f32_16x16x32_bf16 v[36:39], a[80:83], a[0:3], v[36:39]
    s_add_u32 s50, s50, 4096
    buffer_load_dwordx4 a[180:183], v1, s[4:7], s50 offen offset:0
    v_permlane16_swap_b32 v76, v78
    v_permlane16_swap_b32 v77, v79
    v_mfma_f32_16x16x32_bf16 v[64:67], a[80:83], a[4:7], v[64:67]
    v_add_f32 v76, v76, v78
    v_add_f32 v77, v77, v79
    v_mfma_f32_16x16x32_bf16 v[40:43], a[84:87], a[0:3], v[40:43]
    v_mov_b32 v78, v76
    v_mov_b32 v79, v77
    v_mfma_f32_16x16x32_bf16 v[68:71], a[84:87], a[4:7], v[68:71]
    buffer_load_dwordx4 a[184:187], v1, s[4:7], s50 offen offset:1024
    v_permlane32_swap_b32 v76, v78
    v_permlane32_swap_b32 v77, v79
    v_mfma_f32_16x16x32_bf16 v[44:47], a[88:91], a[0:3], v[44:47]
    v_add_f32 v76, v76, v78
    v_add_f32 v77, v77, v79
    v_mfma_f32_16x16x32_bf16 v[72:75], a[88:91], a[4:7], v[72:75]
    v_mul_f32 v108, 0xbacccccd, v76
    v_mul_f32 v78, v108, v108
    s_waitcnt vmcnt(14)
    s_waitcnt lgkmcnt(0)
    v_mfma_f32_16x16x32_bf16 v[20:23], a[92:95], a[8:11], v[20:23]
    ds_read_b128 a[64:67], v118 offset:14336
    v_mov_b32 v79, 0x3acccccd
    v_fma_f32 v77, v77, v79, -v78
    v_mfma_f32_16x16x32_bf16 v[48:51], a[92:95], a[12:15], v[48:51]
    ds_read_b128 a[68:71], v118 offset:15360
    v_max_f32 v77, 0, v77
    v_add_f32 v77, 0x3727c5ac, v77
    v_mfma_f32_16x16x32_bf16 v[24:27], a[96:99], a[8:11], v[24:27]
    ds_read_b128 a[72:75], v118 offset:16384
    v_rsq_f32 v109, v77
    s_nop 0
    v_mov_b32 v110, v109
    v_mfma_f32_16x16x32_bf16 v[52:55], a[96:99], a[12:15], v[52:55]
    ds_read_b128 a[76:79], v118 offset:17408
    v_add_f32 v92, v92, v100
    v_add_f32 v93, v93, v101
    v_mfma_f32_16x16x32_bf16 v[28:31], a[100:103], a[8:11], v[28:31]
    ds_read_b128 a[80:83], v118 offset:18432
    v_add_f32 v94, v94, v102
    v_add_f32 v95, v95, v103
    v_mfma_f32_16x16x32_bf16 v[56:59], a[100:103], a[12:15], v[56:59]
    ds_read_b128 a[84:87], v118 offset:19456
    buffer_load_dwordx4 a[188:191], v1, s[4:7], s50 offen offset:2048
    v_add_f32 v96, v96, v104
    v_add_f32 v97, v97, v105
    v_mfma_f32_16x16x32_bf16 v[32:35], a[104:107], a[8:11], v[32:35]
    ds_read_b128 a[88:91], v118 offset:20480
    v_add_f32 v98, v98, v106
    v_add_f32 v99, v99, v107
    v_mfma_f32_16x16x32_bf16 v[60:63], a[104:107], a[12:15], v[60:63]
    v_add_f32 v92, v92, v96
    v_add_f32 v93, v93, v97
    v_mfma_f32_16x16x32_bf16 v[36:39], a[108:111], a[8:11], v[36:39]
    buffer_load_dwordx4 a[192:195], v1, s[4:7], s50 offen offset:3072
    v_add_f32 v94, v94, v98
    v_add_f32 v95, v95, v99
    v_mfma_f32_16x16x32_bf16 v[64:67], a[108:111], a[12:15], v[64:67]
    v_add_f32 v92, v92, v94
    v_add_f32 v93, v93, v95
    v_mfma_f32_16x16x32_bf16 v[40:43], a[112:115], a[8:11], v[40:43]
    v_mov_b32 v94, v92
    v_mov_b32 v95, v93
    v_mfma_f32_16x16x32_bf16 v[68:71], a[112:115], a[12:15], v[68:71]
    s_add_u32 s50, s50, 4096
    buffer_load_dwordx4 a[196:199], v1, s[4:7], s50 offen offset:0
    v_permlane16_swap_b32 v92, v94
    v_permlane16_swap_b32 v93, v95
    v_mfma_f32_16x16x32_bf16 v[44:47], a[116:119], a[8:11], v[44:47]
    v_add_f32 v92, v92, v94
    v_add_f32 v93, v93, v95
    v_mfma_f32_16x16x32_bf16 v[72:75], a[116:119], a[12:15], v[72:75]
    v_mov_b32 v94, v92
    v_mov_b32 v95, v93
    s_waitcnt vmcnt(14)
    s_waitcnt lgkmcnt(0)
    v_mfma_f32_16x16x32_bf16 v[20:23], a[64:67], a[16:19], v[20:23]
    ds_read_b128 a[92:95], v118 offset:21504
    v_permlane32_swap_b32 v92, v94
    v_permlane32_swap_b32 v93, v95
    v_mfma_f32_16x16x32_bf16 v[48:51], a[64:67], a[20:23], v[48:51]
    ds_read_b128 a[96:99], v118 offset:22528
    v_add_f32 v92, v92, v94
    v_add_f32 v93, v93, v95
    v_mfma_f32_16x16x32_bf16 v[24:27], a[68:71], a[16:19], v[24:27]
    ds_read_b128 a[100:103], v118 offset:23552
    v_mul_f32 v112, 0xbacccccd, v92
    v_mul_f32 v94, v112, v112
    v_mfma_f32_16x16x32_bf16 v[52:55], a[68:71], a[20:23], v[52:55]
    ds_read_b128 a[104:107], v118 offset:24576
    v_mov_b32 v95, 0x3acccccd
    v_fma_f32 v93, v93, v95, -v94
    v_mfma_f32_16x16x32_bf16 v[28:31], a[72:75], a[16:19], v[28:31]
    ds_read_b128 a[108:111], v118 offset:25600
    v_max_f32 v93, 0, v93
    v_add_f32 v93, 0x3727c5ac, v93
    v_mfma_f32_16x16x32_bf16 v[56:59], a[72:75], a[20:23], v[56:59]
    ds_read_b128 a[112:115], v118 offset:26624
    buffer_load_dwordx4 a[200:203], v1, s[4:7], s50 offen offset:1024
    v_rsq_f32 v113, v93
    s_nop 0
    v_mov_b32 v114, v113
    v_mfma_f32_16x16x32_bf16 v[32:35], a[76:79], a[16:19], v[32:35]
    ds_read_b128 a[116:119], v118 offset:27648
    v_mfma_f32_16x16x32_bf16 v[60:63], a[76:79], a[20:23], v[60:63]
    v_mfma_f32_16x16x32_bf16 v[36:39], a[80:83], a[16:19], v[36:39]
    buffer_load_dwordx4 a[204:207], v1, s[4:7], s50 offen offset:2048
    v_mfma_f32_16x16x32_bf16 v[64:67], a[80:83], a[20:23], v[64:67]
    v_mfma_f32_16x16x32_bf16 v[40:43], a[84:87], a[16:19], v[40:43]
    v_mfma_f32_16x16x32_bf16 v[68:71], a[84:87], a[20:23], v[68:71]
    buffer_load_dwordx4 a[208:211], v1, s[4:7], s50 offen offset:3072
    v_mfma_f32_16x16x32_bf16 v[44:47], a[88:91], a[16:19], v[44:47]
    v_mfma_f32_16x16x32_bf16 v[72:75], a[88:91], a[20:23], v[72:75]
    s_waitcnt vmcnt(13)
    s_waitcnt lgkmcnt(0)
    v_mfma_f32_16x16x32_bf16 v[20:23], a[92:95], a[24:27], v[20:23]
    v_mfma_f32_16x16x32_bf16 v[48:51], a[92:95], a[28:31], v[48:51]
    v_mfma_f32_16x16x32_bf16 v[24:27], a[96:99], a[24:27], v[24:27]
    v_mfma_f32_16x16x32_bf16 v[52:55], a[96:99], a[28:31], v[52:55]
    v_mfma_f32_16x16x32_bf16 v[28:31], a[100:103], a[24:27], v[28:31]
    v_mfma_f32_16x16x32_bf16 v[56:59], a[100:103], a[28:31], v[56:59]
    s_add_u32 s50, s50, 4096
    buffer_load_dwordx4 a[212:215], v1, s[4:7], s50 offen offset:0
    v_mfma_f32_16x16x32_bf16 v[32:35], a[104:107], a[24:27], v[32:35]
    v_mfma_f32_16x16x32_bf16 v[60:63], a[104:107], a[28:31], v[60:63]
    v_mfma_f32_16x16x32_bf16 v[36:39], a[108:111], a[24:27], v[36:39]
    buffer_load_dwordx4 a[216:219], v1, s[4:7], s50 offen offset:1024
    v_mfma_f32_16x16x32_bf16 v[64:67], a[108:111], a[28:31], v[64:67]
    v_mfma_f32_16x16x32_bf16 v[40:43], a[112:115], a[24:27], v[40:43]
    v_mfma_f32_16x16x32_bf16 v[68:71], a[112:115], a[28:31], v[68:71]
    buffer_load_dwordx4 a[220:223], v1, s[4:7], s50 offen offset:2048
    v_mfma_f32_16x16x32_bf16 v[44:47], a[116:119], a[24:27], v[44:47]
    v_mfma_f32_16x16x32_bf16 v[72:75], a[116:119], a[28:31], v[72:75]
    s_barrier
    v_mov_b32 v7, v119
    ds_read_b128 v[76:79], v7 offset:0
    ds_read_b128 v[80:83], v7 offset:448
    s_waitcnt lgkmcnt(0)
    ds_read_b128 v[84:87], v7 offset:64
    ds_read_b128 v[88:91], v7 offset:512
    v_pk_fma_f32 v[20:21], v[108:109], v[76:77], v[20:21] op_sel_hi:[0,1,1]
    v_pk_fma_f32 v[22:23], v[108:109], v[78:79], v[22:23] op_sel_hi:[0,1,1]
    v_pk_fma_f32 v[48:49], v[112:113], v[76:77], v[48:49] op_sel_hi:[0,1,1]
    v_pk_fma_f32 v[50:51], v[112:113], v[78:79], v[50:51] op_sel_hi:[0,1,1]
    v_pk_fma_f32 v[20:21], v[20:21], v[110:111], v[80:81] op_sel_hi:[1,0,1]
    v_pk_fma_f32 v[22:23], v[22:23], v[110:111], v[82:83] op_sel_hi:[1,0,1]
    v_pk_fma_f32 v[48:49], v[48:49], v[114:115], v[80:81] op_sel_hi:[1,0,1]
    v_pk_fma_f32 v[50:51], v[50:51], v[114:115], v[82:83] op_sel_hi:[1,0,1]
    v_pk_fma_f32 v[120:121], v[20:21], s[90:91], -0.5 op_sel_hi:[1,1,0]
    v_pk_fma_f32 v[122:123], v[22:23], s[90:91], -0.5 op_sel_hi:[1,1,0]
    v_pk_fma_f32 v[124:125], v[48:49], s[90:91], -0.5 op_sel_hi:[1,1,0]
    v_pk_fma_f32 v[126:127], v[50:51], s[90:91], -0.5 op_sel_hi:[1,1,0]
    v_exp_f32 v120, v120
    v_exp_f32 v121, v121
    v_exp_f32 v122, v122
    v_exp_f32 v123, v123
    v_exp_f32 v124, v124
    v_exp_f32 v125, v125
    v_exp_f32 v126, v126
    v_exp_f32 v127, v127
    v_pk_add_f32 v[120:121], v[120:121], s[92:93]
    v_pk_add_f32 v[122:123], v[122:123], s[92:93]
    v_pk_add_f32 v[124:125], v[124:125], s[92:93]
    v_pk_add_f32 v[126:127], v[126:127], s[92:93]
    v_pk_fma_f32 v[120:121], v[120:121], v[120:121], 0.5 op_sel_hi:[1,1,0]
    v_pk_fma_f32 v[122:123], v[122:123], v[122:123], 0.5 op_sel_hi:[1,1,0]
    v_pk_fma_f32 v[124:125], v[124:125], v[124:125], 0.5 op_sel_hi:[1,1,0]
    v_pk_fma_f32 v[126:127], v[126:127], v[126:127], 0.5 op_sel_hi:[1,1,0]
    v_rcp_f32 v120, v120
    v_rcp_f32 v121, v121
    v_rcp_f32 v122, v122
    v_rcp_f32 v123, v123
    v_rcp_f32 v124, v124
    v_rcp_f32 v125, v125
    v_rcp_f32 v126, v126
    v_rcp_f32 v127, v127
    v_pk_fma_f32 v[20:21], v[20:21], v[120:121], v[20:21] neg_lo:[1,0,0] neg_hi:[1,0,0]
    v_pk_fma_f32 v[22:23], v[22:23], v[122:123], v[22:23] neg_lo:[1,0,0] neg_hi:[1,0,0]
    v_pk_fma_f32 v[48:49], v[48:49], v[124:125], v[48:49] neg_lo:[1,0,0] neg_hi:[1,0,0]
    v_pk_fma_f32 v[50:51], v[50:51], v[126:127], v[50:51] neg_lo:[1,0,0] neg_hi:[1,0,0]
    v_cvt_pk_bf16_f32 v128, v20, v21
    v_cvt_pk_bf16_f32 v129, v22, v23
    v_cvt_pk_bf16_f32 v92, v48, v49
    v_cvt_pk_bf16_f32 v93, v50, v51
    buffer_load_dwordx4 v[132:135], v1, s[4:7], s50 offen offset:3072
    s_add_u32 s50, s50, 4096
    buffer_load_dwordx4 v[136:139], v1, s[4:7], s50 offen offset:0
    s_waitcnt lgkmcnt(0)
    ds_read_b128 v[76:79], v7 offset:128
    ds_read_b128 v[80:83], v7 offset:576
    v_pk_fma_f32 v[24:25], v[108:109], v[84:85], v[24:25] op_sel_hi:[0,1,1]
    v_pk_fma_f32 v[26:27], v[108:109], v[86:87], v[26:27] op_sel_hi:[0,1,1]
    v_pk_fma_f32 v[52:53], v[112:113], v[84:85], v[52:53] op_sel_hi:[0,1,1]
    v_pk_fma_f32 v[54:55], v[112:113], v[86:87], v[54:55] op_sel_hi:[0,1,1]
    v_pk_fma_f32 v[24:25], v[24:25], v[110:111], v[88:89] op_sel_hi:[1,0,1]
    v_pk_fma_f32 v[26:27], v[26:27], v[110:111], v[90:91] op_sel_hi:[1,0,1]
    v_pk_fma_f32 v[52:53], v[52:53], v[114:115], v[88:89] op_sel_hi:[1,0,1]
    v_pk_fma_f32 v[54:55], v[54:55], v[114:115], v[90:91] op_sel_hi:[1,0,1]
    v_pk_fma_f32 v[120:121], v[24:25], s[90:91], -0.5 op_sel_hi:[1,1,0]
    v_pk_fma_f32 v[122:123], v[26:27], s[90:91], -0.5 op_sel_hi:[1,1,0]
    v_pk_fma_f32 v[124:125], v[52:53], s[90:91], -0.5 op_sel_hi:[1,1,0]
    v_pk_fma_f32 v[126:127], v[54:55], s[90:91], -0.5 op_sel_hi:[1,1,0]
    v_exp_f32 v120, v120
    v_exp_f32 v121, v121
    v_exp_f32 v122, v122
    v_exp_f32 v123, v123
    v_exp_f32 v124, v124
    v_exp_f32 v125, v125
    v_exp_f32 v126, v126
    v_exp_f32 v127, v127
    v_pk_add_f32 v[120:121], v[120:121], s[92:93]
    v_pk_add_f32 v[122:123], v[122:123], s[92:93]
    v_pk_add_f32 v[124:125], v[124:125], s[92:93]
    v_pk_add_f32 v[126:127], v[126:127], s[92:93]
    v_pk_fma_f32 v[120:121], v[120:121], v[120:121], 0.5 op_sel_hi:[1,1,0]
    v_pk_fma_f32 v[122:123], v[122:123], v[122:123], 0.5 op_sel_hi:[1,1,0]
    v_pk_fma_f32 v[124:125], v[124:125], v[124:125], 0.5 op_sel_hi:[1,1,0]
    v_pk_fma_f32 v[126:127], v[126:127], v[126:127], 0.5 op_sel_hi:[1,1,0]
    v_rcp_f32 v120, v120
    v_rcp_f32 v121, v121
    v_rcp_f32 v122, v122
    v_rcp_f32 v123, v123
    v_rcp_f32 v124, v124
    v_rcp_f32 v125, v125
    v_rcp_f32 v126, v126
    v_rcp_f32 v127, v127
    v_pk_fma_f32 v[24:25], v[24:25], v[120:121], v[24:25] neg_lo:[1,0,0] neg_hi:[1,0,0]
    v_pk_fma_f32 v[26:27], v[26:27], v[122:123], v[26:27] neg_lo:[1,0,0] neg_hi:[1,0,0]
    v_pk_fma_f32 v[52:53], v[52:53], v[124:125], v[52:53] neg_lo:[1,0,0] neg_hi:[1,0,0]
    v_pk_fma_f32 v[54:55], v[54:55], v[126:127], v[54:55] neg_lo:[1,0,0] neg_hi:[1,0,0]
    v_cvt_pk_bf16_f32 v130, v24, v25
    v_cvt_pk_bf16_f32 v131, v26, v27
    v_cvt_pk_bf16_f32 v94, v52, v53
    v_cvt_pk_bf16_f32 v95, v54, v55
    buffer_store_dwordx4 v[128:131], v1, s[4:7], s86 offen offset:0
    buffer_store_dwordx4 v[92:95], v1, s[4:7], s87 offen offset:0
    s_waitcnt lgkmcnt(0)
    ds_read_b128 v[84:87], v7 offset:192
    ds_read_b128 v[88:91], v7 offset:640
    v_pk_fma_f32 v[28:29], v[108:109], v[76:77], v[28:29] op_sel_hi:[0,1,1]
    v_pk_fma_f32 v[30:31], v[108:109], v[78:79], v[30:31] op_sel_hi:[0,1,1]
    v_pk_fma_f32 v[56:57], v[112:113], v[76:77], v[56:57] op_sel_hi:[0,1,1]
    v_pk_fma_f32 v[58:59], v[112:113], v[78:79], v[58:59] op_sel_hi:[0,1,1]
    v_pk_fma_f32 v[28:29], v[28:29], v[110:111], v[80:81] op_sel_hi:[1,0,1]
    v_pk_fma_f32 v[30:31], v[30:31], v[110:111], v[82:83] op_sel_hi:[1,0,1]
    v_pk_fma_f32 v[56:57], v[56:57], v[114:115], v[80:81] op_sel_hi:[1,0,1]
    v_pk_fma_f32 v[58:59], v[58:59], v[114:115], v[82:83] op_sel_hi:[1,0,1]
    v_pk_fma_f32 v[120:121], v[28:29], s[90:91], -0.5 op_sel_hi:[1,1,0]
    v_pk_fma_f32 v[122:123], v[30:31], s[90:91], -0.5 op_sel_hi:[1,1,0]
    v_pk_fma_f32 v[124:125], v[56:57], s[90:91], -0.5 op_sel_hi:[1,1,0]
    v_pk_fma_f32 v[126:127], v[58:59], s[90:91], -0.5 op_sel_hi:[1,1,0]
    v_exp_f32 v120, v120
    v_exp_f32 v121, v121
    v_exp_f32 v122, v122
    v_exp_f32 v123, v123
    v_exp_f32 v124, v124
    v_exp_f32 v125, v125
    v_exp_f32 v126, v126
    v_exp_f32 v127, v127
    v_pk_add_f32 v[120:121], v[120:121], s[92:93]
    v_pk_add_f32 v[122:123], v[122:123], s[92:93]
    v_pk_add_f32 v[124:125], v[124:125], s[92:93]
    v_pk_add_f32 v[126:127], v[126:127], s[92:93]
    v_pk_fma_f32 v[120:121], v[120:121], v[120:121], 0.5 op_sel_hi:[1,1,0]
    v_pk_fma_f32 v[122:123], v[122:123], v[122:123], 0.5 op_sel_hi:[1,1,0]
    v_pk_fma_f32 v[124:125], v[124:125], v[124:125], 0.5 op_sel_hi:[1,1,0]
    v_pk_fma_f32 v[126:127], v[126:127], v[126:127], 0.5 op_sel_hi:[1,1,0]
    v_rcp_f32 v120, v120
    v_rcp_f32 v121, v121
    v_rcp_f32 v122, v122
    v_rcp_f32 v123, v123
    v_rcp_f32 v124, v124
    v_rcp_f32 v125, v125
    v_rcp_f32 v126, v126
    v_rcp_f32 v127, v127
    v_pk_fma_f32 v[28:29], v[28:29], v[120:121], v[28:29] neg_lo:[1,0,0] neg_hi:[1,0,0]
    v_pk_fma_f32 v[30:31], v[30:31], v[122:123], v[30:31] neg_lo:[1,0,0] neg_hi:[1,0,0]
    v_pk_fma_f32 v[56:57], v[56:57], v[124:125], v[56:57] neg_lo:[1,0,0] neg_hi:[1,0,0]
    v_pk_fma_f32 v[58:59], v[58:59], v[126:127], v[58:59] neg_lo:[1,0,0] neg_hi:[1,0,0]
    v_cvt_pk_bf16_f32 v116, v28, v29
    v_cvt_pk_bf16_f32 v117, v30, v31
    v_cvt_pk_bf16_f32 v96, v56, v57
    v_cvt_pk_bf16_f32 v97, v58, v59
    buffer_load_dwordx4 v[140:143], v1, s[4:7], s50 offen offset:1024
    buffer_load_dwordx4 v[144:147], v1, s[4:7], s50 offen offset:2048
    s_waitcnt lgkmcnt(0)
    ds_read_b128 v[76:79], v7 offset:256
    ds_read_b128 v[80:83], v7 offset:704
    v_pk_fma_f32 v[32:33], v[108:109], v[84:85], v[32:33] op_sel_hi:[0,1,1]
    v_pk_fma_f32 v[34:35], v[108:109], v[86:87], v[34:35] op_sel_hi:[0,1,1]
    v_pk_fma_f32 v[60:61], v[112:113], v[84:85], v[60:61] op_sel_hi:[0,1,1]
    v_pk_fma_f32 v[62:63], v[112:113], v[86:87], v[62:63] op_sel_hi:[0,1,1]
    v_pk_fma_f32 v[32:33], v[32:33], v[110:111], v[88:89] op_sel_hi:[1,0,1]
    v_pk_fma_f32 v[34:35], v[34:35], v[110:111], v[90:91] op_sel_hi:[1,0,1]
    v_pk_fma_f32 v[60:61], v[60:61], v[114:115], v[88:89] op_sel_hi:[1,0,1]
    v_pk_fma_f32 v[62:63], v[62:63], v[114:115], v[90:91] op_sel_hi:[1,0,1]
    v_pk_fma_f32 v[120:121], v[32:33], s[90:91], -0.5 op_sel_hi:[1,1,0]
    v_pk_fma_f32 v[122:123], v[34:35], s[90:91], -0.5 op_sel_hi:[1,1,0]
    v_pk_fma_f32 v[124:125], v[60:61], s[90:91], -0.5 op_sel_hi:[1,1,0]
    v_pk_fma_f32 v[126:127], v[62:63], s[90:91], -0.5 op_sel_hi:[1,1,0]
    v_exp_f32 v120, v120
    v_exp_f32 v121, v121
    v_exp_f32 v122, v122
    v_exp_f32 v123, v123
    v_exp_f32 v124, v124
    v_exp_f32 v125, v125
    v_exp_f32 v126, v126
    v_exp_f32 v127, v127
    v_pk_add_f32 v[120:121], v[120:121], s[92:93]
    v_pk_add_f32 v[122:123], v[122:123], s[92:93]
    v_pk_add_f32 v[124:125], v[124:125], s[92:93]
    v_pk_add_f32 v[126:127], v[126:127], s[92:93]
    v_pk_fma_f32 v[120:121], v[120:121], v[120:121], 0.5 op_sel_hi:[1,1,0]
    v_pk_fma_f32 v[122:123], v[122:123], v[122:123], 0.5 op_sel_hi:[1,1,0]
    v_pk_fma_f32 v[124:125], v[124:125], v[124:125], 0.5 op_sel_hi:[1,1,0]
    v_pk_fma_f32 v[126:127], v[126:127], v[126:127], 0.5 op_sel_hi:[1,1,0]
    v_rcp_f32 v120, v120
    v_rcp_f32 v121, v121
    v_rcp_f32 v122, v122
    v_rcp_f32 v123, v123
    v_rcp_f32 v124, v124
    v_rcp_f32 v125, v125
    v_rcp_f32 v126, v126
    v_rcp_f32 v127, v127
    v_pk_fma_f32 v[32:33], v[32:33], v[120:121], v[32:33] neg_lo:[1,0,0] neg_hi:[1,0,0]
    v_pk_fma_f32 v[34:35], v[34:35], v[122:123], v[34:35] neg_lo:[1,0,0] neg_hi:[1,0,0]
    v_pk_fma_f32 v[60:61], v[60:61], v[124:125], v[60:61] neg_lo:[1,0,0] neg_hi:[1,0,0]
    v_pk_fma_f32 v[62:63], v[62:63], v[126:127], v[62:63] neg_lo:[1,0,0] neg_hi:[1,0,0]
    v_cvt_pk_bf16_f32 v118, v32, v33
    v_cvt_pk_bf16_f32 v119, v34, v35
    v_cvt_pk_bf16_f32 v98, v60, v61
    v_cvt_pk_bf16_f32 v99, v62, v63
    buffer_store_dwordx4 v[116:119], v1, s[4:7], s86 offen offset:1024
    buffer_store_dwordx4 v[96:99], v1, s[4:7], s87 offen offset:1024
    s_waitcnt lgkmcnt(0)
    ds_read_b128 v[84:87], v7 offset:320
    ds_read_b128 v[88:91], v7 offset:768
    v_pk_fma_f32 v[36:37], v[108:109], v[76:77], v[36:37] op_sel_hi:[0,1,1]
    v_pk_fma_f32 v[38:39], v[108:109], v[78:79], v[38:39] op_sel_hi:[0,1,1]
    v_pk_fma_f32 v[64:65], v[112:113], v[76:77], v[64:65] op_sel_hi:[0,1,1]
    v_pk_fma_f32 v[66:67], v[112:113], v[78:79], v[66:67] op_sel_hi:[0,1,1]
    v_pk_fma_f32 v[36:37], v[36:37], v[110:111], v[80:81] op_sel_hi:[1,0,1]
    v_pk_fma_f32 v[38:39], v[38:39], v[110:111], v[82:83] op_sel_hi:[1,0,1]
    v_pk_fma_f32 v[64:65], v[64:65], v[114:115], v[80:81] op_sel_hi:[1,0,1]
    v_pk_fma_f32 v[66:67], v[66:67], v[114:115], v[82:83] op_sel_hi:[1,0,1]
    v_pk_fma_f32 v[120:121], v[36:37], s[90:91], -0.5 op_sel_hi:[1,1,0]
    v_pk_fma_f32 v[122:123], v[38:39], s[90:91], -0.5 op_sel_hi:[1,1,0]
    v_pk_fma_f32 v[124:125], v[64:65], s[90:91], -0.5 op_sel_hi:[1,1,0]
    v_pk_fma_f32 v[126:127], v[66:67], s[90:91], -0.5 op_sel_hi:[1,1,0]
    v_exp_f32 v120, v120
    v_exp_f32 v121, v121
    v_exp_f32 v122, v122
    v_exp_f32 v123, v123
    v_exp_f32 v124, v124
    v_exp_f32 v125, v125
    v_exp_f32 v126, v126
    v_exp_f32 v127, v127
    v_pk_add_f32 v[120:121], v[120:121], s[92:93]
    v_pk_add_f32 v[122:123], v[122:123], s[92:93]
    v_pk_add_f32 v[124:125], v[124:125], s[92:93]
    v_pk_add_f32 v[126:127], v[126:127], s[92:93]
    v_pk_fma_f32 v[120:121], v[120:121], v[120:121], 0.5 op_sel_hi:[1,1,0]
    v_pk_fma_f32 v[122:123], v[122:123], v[122:123], 0.5 op_sel_hi:[1,1,0]
    v_pk_fma_f32 v[124:125], v[124:125], v[124:125], 0.5 op_sel_hi:[1,1,0]
    v_pk_fma_f32 v[126:127], v[126:127], v[126:127], 0.5 op_sel_hi:[1,1,0]
    v_rcp_f32 v120, v120
    v_rcp_f32 v121, v121
    v_rcp_f32 v122, v122
    v_rcp_f32 v123, v123
    v_rcp_f32 v124, v124
    v_rcp_f32 v125, v125
    v_rcp_f32 v126, v126
    v_rcp_f32 v127, v127
    v_pk_fma_f32 v[36:37], v[36:37], v[120:121], v[36:37] neg_lo:[1,0,0] neg_hi:[1,0,0]
    v_pk_fma_f32 v[38:39], v[38:39], v[122:123], v[38:39] neg_lo:[1,0,0] neg_hi:[1,0,0]
    v_pk_fma_f32 v[64:65], v[64:65], v[124:125], v[64:65] neg_lo:[1,0,0] neg_hi:[1,0,0]
    v_pk_fma_f32 v[66:67], v[66:67], v[126:127], v[66:67] neg_lo:[1,0,0] neg_hi:[1,0,0]
    v_cvt_pk_bf16_f32 v128, v36, v37
    v_cvt_pk_bf16_f32 v129, v38, v39
    v_cvt_pk_bf16_f32 v92, v64, v65
    v_cvt_pk_bf16_f32 v93, v66, v67
    buffer_load_dwordx4 v[148:151], v1, s[4:7], s50 offen offset:3072
    s_add_u32 s50, s50, 4096
    buffer_load_dwordx4 v[152:155], v1, s[4:7], s50 offen offset:0
    s_waitcnt lgkmcnt(0)
    ds_read_b128 v[76:79], v7 offset:384
    ds_read_b128 v[80:83], v7 offset:832
    v_pk_fma_f32 v[40:41], v[108:109], v[84:85], v[40:41] op_sel_hi:[0,1,1]
    v_pk_fma_f32 v[42:43], v[108:109], v[86:87], v[42:43] op_sel_hi:[0,1,1]
    v_pk_fma_f32 v[68:69], v[112:113], v[84:85], v[68:69] op_sel_hi:[0,1,1]
    v_pk_fma_f32 v[70:71], v[112:113], v[86:87], v[70:71] op_sel_hi:[0,1,1]
    v_pk_fma_f32 v[40:41], v[40:41], v[110:111], v[88:89] op_sel_hi:[1,0,1]
    v_pk_fma_f32 v[42:43], v[42:43], v[110:111], v[90:91] op_sel_hi:[1,0,1]
    v_pk_fma_f32 v[68:69], v[68:69], v[114:115], v[88:89] op_sel_hi:[1,0,1]
    v_pk_fma_f32 v[70:71], v[70:71], v[114:115], v[90:91] op_sel_hi:[1,0,1]
    v_pk_fma_f32 v[120:121], v[40:41], s[90:91], -0.5 op_sel_hi:[1,1,0]
    v_pk_fma_f32 v[122:123], v[42:43], s[90:91], -0.5 op_sel_hi:[1,1,0]
    v_pk_fma_f32 v[124:125], v[68:69], s[90:91], -0.5 op_sel_hi:[1,1,0]
    v_pk_fma_f32 v[126:127], v[70:71], s[90:91], -0.5 op_sel_hi:[1,1,0]
    v_exp_f32 v120, v120
    v_exp_f32 v121, v121
    v_exp_f32 v122, v122
    v_exp_f32 v123, v123
    v_exp_f32 v124, v124
    v_exp_f32 v125, v125
    v_exp_f32 v126, v126
    v_exp_f32 v127, v127
    v_pk_add_f32 v[120:121], v[120:121], s[92:93]
    v_pk_add_f32 v[122:123], v[122:123], s[92:93]
    v_pk_add_f32 v[124:125], v[124:125], s[92:93]
    v_pk_add_f32 v[126:127], v[126:127], s[92:93]
    v_pk_fma_f32 v[120:121], v[120:121], v[120:121], 0.5 op_sel_hi:[1,1,0]
    v_pk_fma_f32 v[122:123], v[122:123], v[122:123], 0.5 op_sel_hi:[1,1,0]
    v_pk_fma_f32 v[124:125], v[124:125], v[124:125], 0.5 op_sel_hi:[1,1,0]
    v_pk_fma_f32 v[126:127], v[126:127], v[126:127], 0.5 op_sel_hi:[1,1,0]
    v_rcp_f32 v120, v120
    v_rcp_f32 v121, v121
    v_rcp_f32 v122, v122
    v_rcp_f32 v123, v123
    v_rcp_f32 v124, v124
    v_rcp_f32 v125, v125
    v_rcp_f32 v126, v126
    v_rcp_f32 v127, v127
    v_pk_fma_f32 v[40:41], v[40:41], v[120:121], v[40:41] neg_lo:[1,0,0] neg_hi:[1,0,0]
    v_pk_fma_f32 v[42:43], v[42:43], v[122:123], v[42:43] neg_lo:[1,0,0] neg_hi:[1,0,0]
    v_pk_fma_f32 v[68:69], v[68:69], v[124:125], v[68:69] neg_lo:[1,0,0] neg_hi:[1,0,0]
    v_pk_fma_f32 v[70:71], v[70:71], v[126:127], v[70:71] neg_lo:[1,0,0] neg_hi:[1,0,0]
    v_cvt_pk_bf16_f32 v130, v40, v41
    v_cvt_pk_bf16_f32 v131, v42, v43
    v_cvt_pk_bf16_f32 v94, v68, v69
    v_cvt_pk_bf16_f32 v95, v70, v71
    buffer_store_dwordx4 v[128:131], v1, s[4:7], s86 offen offset:2048
    buffer_store_dwordx4 v[92:95], v1, s[4:7], s87 offen offset:2048
    s_waitcnt lgkmcnt(0)
    v_pk_fma_f32 v[44:45], v[108:109], v[76:77], v[44:45] op_sel_hi:[0,1,1]
    v_pk_fma_f32 v[46:47], v[108:109], v[78:79], v[46:47] op_sel_hi:[0,1,1]
    v_pk_fma_f32 v[72:73], v[112:113], v[76:77], v[72:73] op_sel_hi:[0,1,1]
    v_pk_fma_f32 v[74:75], v[112:113], v[78:79], v[74:75] op_sel_hi:[0,1,1]
    v_pk_fma_f32 v[44:45], v[44:45], v[110:111], v[80:81] op_sel_hi:[1,0,1]
    v_pk_fma_f32 v[46:47], v[46:47], v[110:111], v[82:83] op_sel_hi:[1,0,1]
    v_pk_fma_f32 v[72:73], v[72:73], v[114:115], v[80:81] op_sel_hi:[1,0,1]
    v_pk_fma_f32 v[74:75], v[74:75], v[114:115], v[82:83] op_sel_hi:[1,0,1]
    v_pk_fma_f32 v[120:121], v[44:45], s[90:91], -0.5 op_sel_hi:[1,1,0]
    v_pk_fma_f32 v[122:123], v[46:47], s[90:91], -0.5 op_sel_hi:[1,1,0]
    v_pk_fma_f32 v[124:125], v[72:73], s[90:91], -0.5 op_sel_hi:[1,1,0]
    v_pk_fma_f32 v[126:127], v[74:75], s[90:91], -0.5 op_sel_hi:[1,1,0]
    v_exp_f32 v120, v120
    v_exp_f32 v121, v121
    v_exp_f32 v122, v122
    v_exp_f32 v123, v123
    v_exp_f32 v124, v124
    v_exp_f32 v125, v125
    v_exp_f32 v126, v126
    v_exp_f32 v127, v127
    v_pk_add_f32 v[120:121], v[120:121], s[92:93]
    v_pk_add_f32 v[122:123], v[122:123], s[92:93]
    v_pk_add_f32 v[124:125], v[124:125], s[92:93]
    v_pk_add_f32 v[126:127], v[126:127], s[92:93]
    v_pk_fma_f32 v[120:121], v[120:121], v[120:121], 0.5 op_sel_hi:[1,1,0]
    v_pk_fma_f32 v[122:123], v[122:123], v[122:123], 0.5 op_sel_hi:[1,1,0]
    v_pk_fma_f32 v[124:125], v[124:125], v[124:125], 0.5 op_sel_hi:[1,1,0]
    v_pk_fma_f32 v[126:127], v[126:127], v[126:127], 0.5 op_sel_hi:[1,1,0]
    v_rcp_f32 v120, v120
    v_rcp_f32 v121, v121
    v_rcp_f32 v122, v122
    v_rcp_f32 v123, v123
    v_rcp_f32 v124, v124
    v_rcp_f32 v125, v125
    v_rcp_f32 v126, v126
    v_rcp_f32 v127, v127
    v_pk_fma_f32 v[44:45], v[44:45], v[120:121], v[44:45] neg_lo:[1,0,0] neg_hi:[1,0,0]
    v_pk_fma_f32 v[46:47], v[46:47], v[122:123], v[46:47] neg_lo:[1,0,0] neg_hi:[1,0,0]
    v_pk_fma_f32 v[72:73], v[72:73], v[124:125], v[72:73] neg_lo:[1,0,0] neg_hi:[1,0,0]
    v_pk_fma_f32 v[74:75], v[74:75], v[126:127], v[74:75] neg_lo:[1,0,0] neg_hi:[1,0,0]
    v_cvt_pk_bf16_f32 v116, v44, v45
    v_cvt_pk_bf16_f32 v117, v46, v47
    v_cvt_pk_bf16_f32 v96, v72, v73
    v_cvt_pk_bf16_f32 v97, v74, v75
    buffer_store_dwordx2 v[116:117], v1, s[4:7], s84 offen offset:3072
    buffer_store_dwordx2 v[96:97], v1, s[4:7], s85 offen offset:3072
    buffer_load_dwordx4 a[0:3], v1, s[4:7], s50 offen offset:1024
    buffer_load_dwordx4 a[4:7], v1, s[4:7], s50 offen offset:2048
    buffer_load_dwordx4 a[8:11], v1, s[4:7], s50 offen offset:3072
    s_add_u32 s50, s50, 4096
    buffer_load_dwordx4 a[12:15], v1, s[4:7], s50 offen offset:0
    buffer_load_dwordx4 a[16:19], v1, s[4:7], s50 offen offset:1024
    s_waitcnt vmcnt(5)
    v_mov_b32 v5, s27
    s_mov_b64 exec, 1
    s_cmp_lg_u32 s29, 0
    s_cbranch_scc1 L_sg_44
    buffer_store_dword v5, off, s[4:7], s88
L_sj_45:
    s_mov_b64 exec, -1
    v_and_b32 v120, 7, v0
    v_lshlrev_b32 v120, 2, v120
    buffer_load_dword v5, v120, s[4:7], s48 offen sc1
    s_mov_b32 s35, 0
    s_sleep 1
L_poll_46:
    buffer_load_dword v121, v120, s[4:7], s48 offen sc1
    s_waitcnt vmcnt(1)
    v_cmp_ne_u32 vcc, s27, v5
    s_nop 4
    s_cbranch_vccz L_pollx_47
    buffer_load_dword v5, v120, s[4:7], s48 offen sc1
    s_waitcnt vmcnt(1)
    v_cmp_ne_u32 vcc, s27, v121
    s_nop 4
    s_cbranch_vccz L_pollx_47
    s_add_u32 s35, s35, 1
    s_cmp_lt_u32 s35, 0x20000
    s_cbranch_scc1 L_poll_46
L_pollx_47:
    s_cmp_lg_u32 s29, 0
    s_cbranch_scc1 L_pg_48
L_pj_49:
    s_add_u32 s34, s30, 0
    buffer_load_dwordx4 a[20:23], v1, s[4:7], s34 offen offset:0 sc1
    buffer_load_dwordx4 a[24:27], v1, s[4:7], s34 offen offset:1024 sc1
    buffer_load_dwordx4 a[28:31], v1, s[4:7], s34 offen offset:2048 sc1
    buffer_load_dwordx4 a[32:35], v1, s[4:7], s34 offen offset:3072 sc1
    s_add_u32 s34, s30, 4096
    buffer_load_dwordx4 a[36:39], v1, s[4:7], s34 offen offset:0 sc1
    buffer_load_dwordx4 a[40:43], v1, s[4:7], s34 offen offset:1024 sc1
    s_waitcnt vmcnt(5)
    v_mfma_f32_16x16x32_bf16 v[20:23], v[156:159], a[20:23], 0
    v_mfma_f32_16x16x32_bf16 v[24:27], v[160:163], a[20:23], 0
    buffer_load_dwordx4 a[44:47], v1, s[4:7], s34 offen offset:2048 sc1
    v_mfma_f32_16x16x32_bf16 v[28:31], v[164:167], a[20:23], 0
    v_mfma_f32_16x16x32_bf16 v[32:35], v[168:171], a[20:23], 0
    v_mfma_f32_16x16x32_bf16 v[36:39], v[172:175], a[20:23], 0
    buffer_load_dwordx4 a[48:51], v1, s[4:7], s34 offen offset:3072 sc1
    s_waitcnt vmcnt(6)
    v_mfma_f32_16x16x32_bf16 v[20:23], v[176:179], a[24:27], v[20:23]
    v_mfma_f32_16x16x32_bf16 v[24:27], v[180:183], a[24:27], v[24:27]
    v_mfma_f32_16x16x32_bf16 v[28:31], v[184:187], a[24:27], v[28:31]
    v_mfma_f32_16x16x32_bf16 v[32:35], v[188:191], a[24:27], v[32:35]
    v_mfma_f32_16x16x32_bf16 v[36:39], v[192:195], a[24:27], v[36:39]
    s_add_u32 s34, s30, 8192
    buffer_load_dwordx4 a[52:55], v1, s[4:7], s34 offen offset:0 sc1
    s_waitcnt vmcnt(6)
    v_mfma_f32_16x16x32_bf16 v[20:23], v[196:199], a[28:31], v[20:23]
    v_mfma_f32_16x16x32_bf16 v[24:27], v[200:203], a[28:31], v[24:27]
    buffer_load_dwordx4 a[56:59], v1, s[4:7], s34 offen offset:1024 sc1
    v_mfma_f32_16x16x32_bf16 v[28:31], v[204:207], a[28:31], v[28:31]
    v_mfma_f32_16x16x32_bf16 v[32:35], v[208:211], a[28:31], v[32:35]
    v_mfma_f32_16x16x32_bf16 v[36:39], v[212:215], a[28:31], v[36:39]
    buffer_load_dwordx4 a[60:63], v1, s[4:7], s34 offen offset:2048 sc1
    s_waitcnt vmcnt(7)
    v_mfma_f32_16x16x32_bf16 v[20:23], v[216:219], a[32:35], v[20:23]
    v_mfma_f32_16x16x32_bf16 v[24:27], v[220:223], a[32:35], v[24:27]
    v_mfma_f32_16x16x32_bf16 v[28:31], v[224:227], a[32:35], v[28:31]
    v_mfma_f32_16x16x32_bf16 v[32:35], v[228:231], a[32:35], v[32:35]
    v_mfma_f32_16x16x32_bf16 v[36:39], v[232:235], a[32:35], v[36:39]
    buffer_load_dwordx4 a[64:67], v1, s[4:7], s34 offen offset:3072 sc1
    s_waitcnt vmcnt(7)
    v_mfma_f32_16x16x32_bf16 v[20:23], v[236:239], a[36:39], v[20:23]
    v_mfma_f32_16x16x32_bf16 v[24:27], v[240:243], a[36:39], v[24:27]
    s_add_u32 s34, s30, 12288
    buffer_load_dwordx4 a[68:71], v1, s[4:7], s34 offen offset:0 sc1
    v_mfma_f32_16x16x32_bf16 v[28:31], v[244:247], a[36:39], v[28:31]
    v_mfma_f32_16x16x32_bf16 v[32:35], v[248:251], a[36:39], v[32:35]
    s_mul_i32 s94, s23, 5632
    v_mfma_f32_16x16x32_bf16 v[36:39], v[252:255], a[36:39], v[36:39]
    buffer_load_dwordx4 a[72:75], v1, s[4:7], s34 offen offset:1024 sc1
    s_waitcnt vmcnt(8)
    v_mfma_f32_16x16x32_bf16 v[20:23], a[224:227], a[40:43], v[20:23]
    v_mfma_f32_16x16x32_bf16 v[24:27], a[228:231], a[40:43], v[24:27]
    v_mfma_f32_16x16x32_bf16 v[28:31], a[232:235], a[40:43], v[28:31]
    v_mfma_f32_16x16x32_bf16 v[32:35], a[236:239], a[40:43], v[32:35]
    s_lshr_b32 s36, s20, 1
    v_mfma_f32_16x16x32_bf16 v[36:39], a[240:243], a[40:43], v[36:39]
    s_add_u32 s34, s31, 0
    buffer_load_dwordx4 a[76:79], v1, s[4:7], s34 offen offset:0 sc1
    s_waitcnt vmcnt(8)
    v_mfma_f32_16x16x32_bf16 v[20:23], a[244:247], a[44:47], v[20:23]
    v_mfma_f32_16x16x32_bf16 v[24:27], a[248:251], a[44:47], v[24:27]
    buffer_load_dwordx4 a[80:83], v1, s[4:7], s34 offen offset:1024 sc1
    v_mfma_f32_16x16x32_bf16 v[28:31], a[252:255], a[44:47], v[28:31]
    v_mfma_f32_16x16x32_bf16 v[32:35], a[120:123], a[44:47], v[32:35]
    s_mul_i32 s36, s36, 2816
    v_mfma_f32_16x16x32_bf16 v[36:39], a[124:127], a[44:47], v[36:39]
    buffer_load_dwordx4 a[84:87], v1, s[4:7], s34 offen offset:2048 sc1
    s_waitcnt vmcnt(9)
    v_mfma_f32_16x16x32_bf16 v[20:23], a[128:131], a[48:51], v[20:23]
    v_mfma_f32_16x16x32_bf16 v[24:27], a[132:135], a[48:51], v[24:27]
    v_mfma_f32_16x16x32_bf16 v[28:31], a[136:139], a[48:51], v[28:31]
    v_mfma_f32_16x16x32_bf16 v[32:35], a[140:143], a[48:51], v[32:35]
    s_add_u32 s94, s94, s36
    v_mfma_f32_16x16x32_bf16 v[36:39], a[144:147], a[48:51], v[36:39]
    buffer_load_dwordx4 a[88:91], v1, s[4:7], s34 offen offset:3072 sc1
    s_waitcnt vmcnt(9)
    v_mfma_f32_16x16x32_bf16 v[20:23], a[148:151], a[52:55], v[20:23]
    v_mfma_f32_16x16x32_bf16 v[24:27], a[152:155], a[52:55], v[24:27]
    v_mfma_f32_16x16x32_bf16 v[28:31], a[156:159], a[52:55], v[28:31]
    v_mfma_f32_16x16x32_bf16 v[32:35], a[160:163], a[52:55], v[32:35]
    s_add_u32 s94, s94, 7073792
    v_mfma_f32_16x16x32_bf16 v[36:39], a[164:167], a[52:55], v[36:39]
    s_add_u32 s34, s31, 4096
    buffer_load_dwordx4 a[92:95], v1, s[4:7], s34 offen offset:0 sc1
    s_waitcnt vmcnt(9)
    v_mfma_f32_16x16x32_bf16 v[20:23], a[168:171], a[56:59], v[20:23]
    v_mfma_f32_16x16x32_bf16 v[24:27], a[172:175], a[56:59], v[24:27]
    v_mfma_f32_16x16x32_bf16 v[28:31], a[176:179], a[56:59], v[28:31]
    v_mfma_f32_16x16x32_bf16 v[32:35], a[180:183], a[56:59], v[32:35]
    s_mul_i32 s95, s23, 32
    v_mfma_f32_16x16x32_bf16 v[36:39], a[184:187], a[56:59], v[36:39]
    buffer_load_dwordx4 a[96:99], v1, s[4:7], s34 offen offset:1024 sc1
    s_waitcnt vmcnt(9)
    v_mfma_f32_16x16x32_bf16 v[20:23], a[188:191], a[60:63], v[20:23]
    v_mfma_f32_16x16x32_bf16 v[24:27], a[192:195], a[60:63], v[24:27]
    v_mfma_f32_16x16x32_bf16 v[28:31], a[196:199], a[60:63], v[28:31]
    v_mfma_f32_16x16x32_bf16 v[32:35], a[200:203], a[60:63], v[32:35]
    s_mul_i32 s36, s24, 4
    v_mfma_f32_16x16x32_bf16 v[36:39], a[204:207], a[60:63], v[36:39]
    buffer_load_dwordx4 a[100:103], v1, s[4:7], s34 offen offset:2048 sc1
    s_waitcnt vmcnt(9)
    v_mfma_f32_16x16x32_bf16 v[20:23], a[208:211], a[64:67], v[20:23]
    v_mfma_f32_16x16x32_bf16 v[24:27], a[212:215], a[64:67], v[24:27]
    v_mfma_f32_16x16x32_bf16 v[28:31], a[216:219], a[64:67], v[28:31]
    v_mfma_f32_16x16x32_bf16 v[32:35], a[220:223], a[64:67], v[32:35]
    s_add_u32 s95, s95, s36
    v_mfma_f32_16x16x32_bf16 v[36:39], v[132:135], a[64:67], v[36:39]
    buffer_load_dwordx4 a[104:107], v1, s[4:7], s34 offen offset:3072 sc1
    s_waitcnt vmcnt(9)
    v_mfma_f32_16x16x32_bf16 v[20:23], v[136:139], a[68:71], v[20:23]
    v_mfma_f32_16x16x32_bf16 v[24:27], v[140:143], a[68:71], v[24:27]
    v_mfma_f32_16x16x32_bf16 v[28:31], v[144:147], a[68:71], v[28:31]
    v_mfma_f32_16x16x32_bf16 v[32:35], v[148:151], a[68:71], v[32:35]
    s_add_u32 s95, s95, 7254016
    v_mfma_f32_16x16x32_bf16 v[36:39], v[152:155], a[68:71], v[36:39]
    s_add_u32 s34, s31, 8192
    buffer_load_dwordx4 a[108:111], v1, s[4:7], s34 offen offset:0 sc1
    s_waitcnt vmcnt(9)
    v_mfma_f32_16x16x32_bf16 v[20:23], a[0:3], a[72:75], v[20:23]
    v_mfma_f32_16x16x32_bf16 v[24:27], a[4:7], a[72:75], v[24:27]
    v_mfma_f32_16x16x32_bf16 v[28:31], a[8:11], a[72:75], v[28:31]
    v_mfma_f32_16x16x32_bf16 v[32:35], a[12:15], a[72:75], v[32:35]
    s_mul_i32 s96, s21, 1703936
    v_mfma_f32_16x16x32_bf16 v[36:39], a[16:19], a[72:75], v[36:39]
    buffer_load_dwordx4 a[112:115], v1, s[4:7], s34 offen offset:1024 sc1
    s_waitcnt vmcnt(9)
    v_mfma_f32_16x16x32_bf16 v[40:43], v[156:159], a[76:79], 0
    v_add_u32 v7, s44, v1
    v_mfma_f32_16x16x32_bf16 v[44:47], v[160:163], a[76:79], 0
    v_mfma_f32_16x16x32_bf16 v[48:51], v[164:167], a[76:79], 0
    v_mfma_f32_16x16x32_bf16 v[52:55], v[168:171], a[76:79], 0
    s_and_b32 s36, s23, 3
    v_mfma_f32_16x16x32_bf16 v[56:59], v[172:175], a[76:79], 0
    buffer_load_dwordx4 a[116:119], v1, s[4:7], s34 offen offset:2048 sc1
    s_waitcnt vmcnt(9)
    v_mfma_f32_16x16x32_bf16 v[40:43], v[176:179], a[80:83], v[40:43]
    v_mfma_f32_16x16x32_bf16 v[44:47], v[180:183], a[80:83], v[44:47]
    ds_write_b128 v7, v[20:23] offset:0
    v_mfma_f32_16x16x32_bf16 v[48:51], v[184:187], a[80:83], v[48:51]
    v_mfma_f32_16x16x32_bf16 v[52:55], v[188:191], a[80:83], v[52:55]
    s_mul_i32 s36, s36, 81920
    v_mfma_f32_16x16x32_bf16 v[56:59], v[192:195], a[80:83], v[56:59]
    buffer_load_dwordx4 a[20:23], v1, s[4:7], s34 offen offset:3072 sc1
    s_waitcnt vmcnt(9)
    v_mfma_f32_16x16x32_bf16 v[40:43], v[196:199], a[84:87], v[40:43]
    v_mfma_f32_16x16x32_bf16 v[44:47], v[200:203], a[84:87], v[44:47]
    ds_write_b128 v7, v[24:27] offset:1024
    v_mfma_f32_16x16x32_bf16 v[48:51], v[204:207], a[84:87], v[48:51]
    v_mfma_f32_16x16x32_bf16 v[52:55], v[208:211], a[84:87], v[52:55]
    s_add_u32 s96, s96, s36
    v_mfma_f32_16x16x32_bf16 v[56:59], v[212:215], a[84:87], v[56:59]
    s_add_u32 s34, s31, 12288
    buffer_load_dwordx4 a[24:27], v1, s[4:7], s34 offen offset:0 sc1
    s_waitcnt vmcnt(9)
    v_mfma_f32_16x16x32_bf16 v[40:43], v[216:219], a[88:91], v[40:43]
    v_mfma_f32_16x16x32_bf16 v[44:47], v[220:223], a[88:91], v[44:47]
    ds_write_b128 v7, v[28:31] offset:2048
    v_mfma_f32_16x16x32_bf16 v[48:51], v[224:227], a[88:91], v[48:51]
    v_mfma_f32_16x16x32_bf16 v[52:55], v[228:231], a[88:91], v[52:55]
    s_mul_i32 s36, s20, 20480
    v_mfma_f32_16x16x32_bf16 v[56:59], v[232:235], a[88:91], v[56:59]
    buffer_load_dwordx4 a[28:31], v1, s[4:7], s34 offen offset:1024 sc1
    s_waitcnt vmcnt(9)
    v_mfma_f32_16x16x32_bf16 v[40:43], v[236:239], a[92:95], v[40:43]
    v_mfma_f32_16x16x32_bf16 v[44:47], v[240:243], a[92:95], v[44:47]
    ds_write_b128 v7, v[32:35] offset:3072
    v_mfma_f32_16x16x32_bf16 v[48:51], v[244:247], a[92:95], v[48:51]
    v_mfma_f32_16x16x32_bf16 v[52:55], v[248:251], a[92:95], v[52:55]
    s_add_u32 s96, s96, s36
    v_mfma_f32_16x16x32_bf16 v[56:59], v[252:255], a[92:95], v[56:59]
    s_add_u32 s34, s32, 0
    buffer_load_dwordx4 a[32:35], v1, s[4:7], s34 offen offset:0 sc1
    s_waitcnt vmcnt(9)
    v_mfma_f32_16x16x32_bf16 v[40:43], a[224:227], a[96:99], v[40:43]
    v_mfma_f32_16x16x32_bf16 v[44:47], a[228:231], a[96:99], v[44:47]
    ds_write_b128 v7, v[36:39] offset:4096
    v_mfma_f32_16x16x32_bf16 v[48:51], a[232:235], a[96:99], v[48:51]
    v_mfma_f32_16x16x32_bf16 v[52:55], a[236:239], a[96:99], v[52:55]
    s_add_u32 s96, s96, 7274496
    v_mfma_f32_16x16x32_bf16 v[56:59], a[240:243], a[96:99], v[56:59]
    buffer_load_dwordx4 a[36:39], v1, s[4:7], s34 offen offset:1024 sc1
    s_waitcnt vmcnt(9)
    v_mfma_f32_16x16x32_bf16 v[40:43], a[244:247], a[100:103], v[40:43]
    v_mfma_f32_16x16x32_bf16 v[44:47], a[248:251], a[100:103], v[44:47]
    v_mfma_f32_16x16x32_bf16 v[48:51], a[252:255], a[100:103], v[48:51]
    v_mfma_f32_16x16x32_bf16 v[52:55], a[120:123], a[100:103], v[52:55]
    s_mul_i32 s97, s21, 1703936
    v_mfma_f32_16x16x32_bf16 v[56:59], a[124:127], a[100:103], v[56:59]
    buffer_load_dwordx4 a[40:43], v1, s[4:7], s34 offen offset:2048 sc1
    s_waitcnt vmcnt(9)
    v_mfma_f32_16x16x32_bf16 v[40:43], a[128:131], a[104:107], v[40:43]
    v_mfma_f32_16x16x32_bf16 v[44:47], a[132:135], a[104:107], v[44:47]
    v_mfma_f32_16x16x32_bf16 v[48:51], a[136:139], a[104:107], v[48:51]
    v_mfma_f32_16x16x32_bf16 v[52:55], a[140:143], a[104:107], v[52:55]
    s_waitcnt lgkmcnt(0)
    s_barrier
    v_add_u32 v6, s45, v1
    s_and_b32 s36, s23, 3
    v_mfma_f32_16x16x32_bf16 v[56:59], a[144:147], a[104:107], v[56:59]
    buffer_load_dwordx4 a[44:47], v1, s[4:7], s34 offen offset:3072 sc1
    s_waitcnt vmcnt(9)
    v_mfma_f32_16x16x32_bf16 v[40:43], a[148:151], a[108:111], v[40:43]
    ds_read_b128 v[80:83], v6 offset:0
    v_mfma_f32_16x16x32_bf16 v[44:47], a[152:155], a[108:111], v[44:47]
    v_mfma_f32_16x16x32_bf16 v[48:51], a[156:159], a[108:111], v[48:51]
    ds_read_b128 v[84:87], v6 offset:1024
    v_mfma_f32_16x16x32_bf16 v[52:55], a[160:163], a[108:111], v[52:55]
    s_mul_i32 s36, s36, 16384
    v_mfma_f32_16x16x32_bf16 v[56:59], a[164:167], a[108:111], v[56:59]
    ds_read_b128 v[88:91], v6 offset:2048
    s_add_u32 s34, s32, 4096
    buffer_load_dwordx4 a[48:51], v1, s[4:7], s34 offen offset:0 sc1
    s_waitcnt vmcnt(9)
    v_mfma_f32_16x16x32_bf16 v[40:43], a[168:171], a[112:115], v[40:43]
    v_mfma_f32_16x16x32_bf16 v[44:47], a[172:175], a[112:115], v[44:47]
    ds_read_b128 v[92:95], v6 offset:3072
    v_mfma_f32_16x16x32_bf16 v[48:51], a[176:179], a[112:115], v[48:51]
    v_mfma_f32_16x16x32_bf16 v[52:55], a[180:183], a[112:115], v[52:55]
    ds_read_b128 v[96:99], v6 offset:4096
    s_add_u32 s97, s97, s36
    v_mfma_f32_16x16x32_bf16 v[56:59], a[184:187], a[112:115], v[56:59]
    buffer_load_dwordx4 a[52:55], v1, s[4:7], s34 offen offset:1024 sc1
    s_waitcnt vmcnt(9)
    v_mfma_f32_16x16x32_bf16 v[40:43], a[188:191], a[116:119], v[40:43]
    v_mfma_f32_16x16x32_bf16 v[44:47], a[192:195], a[116:119], v[44:47]
    v_mfma_f32_16x16x32_bf16 v[48:51], a[196:199], a[116:119], v[48:51]
    v_mfma_f32_16x16x32_bf16 v[52:55], a[200:203], a[116:119], v[52:55]
    s_mul_i32 s36, s20, 4096
    v_mfma_f32_16x16x32_bf16 v[56:59], a[204:207], a[116:119], v[56:59]
    buffer_load_dwordx4 a[56:59], v1, s[4:7], s34 offen offset:2048 sc1
    s_waitcnt vmcnt(9)
    v_mfma_f32_16x16x32_bf16 v[40:43], a[208:211], a[20:23], v[40:43]
    v_mfma_f32_16x16x32_bf16 v[44:47], a[212:215], a[20:23], v[44:47]
    v_mfma_f32_16x16x32_bf16 v[48:51], a[216:219], a[20:23], v[48:51]
    v_mfma_f32_16x16x32_bf16 v[52:55], a[220:223], a[20:23], v[52:55]
    s_add_u32 s97, s97, s36
    v_mfma_f32_16x16x32_bf16 v[56:59], v[132:135], a[20:23], v[56:59]
    buffer_load_dwordx4 a[60:63], v1, s[4:7], s34 offen offset:3072 sc1
    s_waitcnt vmcnt(9)
    v_mfma_f32_16x16x32_bf16 v[40:43], v[136:139], a[24:27], v[40:43]
    v_mfma_f32_16x16x32_bf16 v[44:47], v[140:143], a[24:27], v[44:47]
    v_mfma_f32_16x16x32_bf16 v[48:51], v[144:147], a[24:27], v[48:51]
    v_mfma_f32_16x16x32_bf16 v[52:55], v[148:151], a[24:27], v[52:55]
    s_add_u32 s97, s97, 8847360
    v_mfma_f32_16x16x32_bf16 v[56:59], v[152:155], a[24:27], v[56:59]
    s_add_u32 s34, s32, 8192
    buffer_load_dwordx4 a[64:67], v1, s[4:7], s34 offen offset:0 sc1
    s_waitcnt vmcnt(9)
    v_mfma_f32_16x16x32_bf16 v[40:43], a[0:3], a[28:31], v[40:43]
    v_mfma_f32_16x16x32_bf16 v[44:47], a[4:7], a[28:31], v[44:47]
    v_mfma_f32_16x16x32_bf16 v[48:51], a[8:11], a[28:31], v[48:51]
    v_mfma_f32_16x16x32_bf16 v[52:55], a[12:15], a[28:31], v[52:55]
    s_mul_i32 s98, s23, 128
    v_mfma_f32_16x16x32_bf16 v[56:59], a[16:19], a[28:31], v[56:59]
    buffer_load_dwordx4 a[68:71], v1, s[4:7], s34 offen offset:1024 sc1
    s_waitcnt vmcnt(9)
    v_mfma_f32_16x16x32_bf16 v[20:23], v[156:159], a[32:35], 0
    v_add_u32 v7, s45, v1
    v_mfma_f32_16x16x32_bf16 v[24:27], v[160:163], a[32:35], 0
    v_mfma_f32_16x16x32_bf16 v[28:31], v[164:167], a[32:35], 0
    v_mfma_f32_16x16x32_bf16 v[32:35], v[168:171], a[32:35], 0
    s_waitcnt lgkmcnt(0)
    s_mul_i32 s36, s20, 8
    v_mfma_f32_16x16x32_bf16 v[36:39], v[172:175], a[32:35], 0
    v_add_f32 v80, v80, v40
    v_add_f32 v81, v81, v41
    buffer_load_dwordx4 a[72:75], v1, s[4:7], s34 offen offset:2048 sc1
    s_waitcnt vmcnt(9)
    v_mfma_f32_16x16x32_bf16 v[20:23], v[176:179], a[36:39], v[20:23]
    v_add_f32 v82, v82, v42
    v_add_f32 v83, v83, v43
    v_mfma_f32_16x16x32_bf16 v[24:27], v[180:183], a[36:39], v[24:27]
    ds_write_b128 v7, v[80:83] offset:0
    v_mfma_f32_16x16x32_bf16 v[28:31], v[184:187], a[36:39], v[28:31]
    v_mfma_f32_16x16x32_bf16 v[32:35], v[188:191], a[36:39], v[32:35]
    s_add_u32 s98, s98, s36
    v_mfma_f32_16x16x32_bf16 v[36:39], v[192:195], a[36:39], v[36:39]
    v_add_f32 v84, v84, v44
    v_add_f32 v85, v85, v45
    buffer_load_dwordx4 a[76:79], v1, s[4:7], s34 offen offset:3072 sc1
    s_waitcnt vmcnt(9)
    v_mfma_f32_16x16x32_bf16 v[20:23], v[196:199], a[40:43], v[20:23]
    v_add_f32 v86, v86, v46
    v_add_f32 v87, v87, v47
    v_mfma_f32_16x16x32_bf16 v[24:27], v[200:203], a[40:43], v[24:27]
    ds_write_b128 v7, v[84:87] offset:1024
    v_mfma_f32_16x16x32_bf16 v[28:31], v[204:207], a[40:43], v[28:31]
    v_mfma_f32_16x16x32_bf16 v[32:35], v[208:211], a[40:43], v[32:35]
    s_add_u32 s98, s98, 7270400
    v_mfma_f32_16x16x32_bf16 v[36:39], v[212:215], a[40:43], v[36:39]
    v_add_f32 v88, v88, v48
    v_add_f32 v89, v89, v49
    s_add_u32 s34, s32, 12288
    buffer_load_dwordx4 a[80:83], v1, s[4:7], s34 offen offset:0 sc1
    s_waitcnt vmcnt(9)
    v_mfma_f32_16x16x32_bf16 v[20:23], v[216:219], a[44:47], v[20:23]
    v_add_f32 v90, v90, v50
    v_add_f32 v91, v91, v51
    v_mfma_f32_16x16x32_bf16 v[24:27], v[220:223], a[44:47], v[24:27]
    ds_write_b128 v7, v[88:91] offset:2048
    v_mfma_f32_16x16x32_bf16 v[28:31], v[224:227], a[44:47], v[28:31]
    v_mfma_f32_16x16x32_bf16 v[32:35], v[228:231], a[44:47], v[32:35]
    v_bfe_u32 v122, v0, 1, 2
    v_mfma_f32_16x16x32_bf16 v[36:39], v[232:235], a[44:47], v[36:39]
    v_add_f32 v92, v92, v52
    v_add_f32 v93, v93, v53
    buffer_load_dwordx4 a[84:87], v1, s[4:7], s34 offen offset:1024 sc1
    s_waitcnt vmcnt(9)
    v_mfma_f32_16x16x32_bf16 v[20:23], v[236:239], a[48:51], v[20:23]
    v_add_f32 v94, v94, v54
    v_add_f32 v95, v95, v55
    v_mfma_f32_16x16x32_bf16 v[24:27], v[240:243], a[48:51], v[24:27]
    ds_write_b128 v7, v[92:95] offset:3072
    v_mfma_f32_16x16x32_bf16 v[28:31], v[244:247], a[48:51], v[28:31]
    v_mfma_f32_16x16x32_bf16 v[32:35], v[248:251], a[48:51], v[32:35]
    v_lshlrev_b32 v122, 5, v122
    v_mfma_f32_16x16x32_bf16 v[36:39], v[252:255], a[48:51], v[36:39]
    v_add_f32 v96, v96, v56
    v_add_f32 v97, v97, v57
    s_add_u32 s34, s33, 0
    buffer_load_dwordx4 a[88:91], v1, s[4:7], s34 offen offset:0 sc1
    s_waitcnt vmcnt(9)
    v_mfma_f32_16x16x32_bf16 v[20:23], a[224:227], a[52:55], v[20:23]
    v_add_f32 v98, v98, v58
    v_add_f32 v99, v99, v59
    v_mfma_f32_16x16x32_bf16 v[24:27], a[228:231], a[52:55], v[24:27]
    ds_write_b128 v7, v[96:99] offset:4096
    v_mfma_f32_16x16x32_bf16 v[28:31], a[232:235], a[52:55], v[28:31]
    v_mfma_f32_16x16x32_bf16 v[32:35], a[236:239], a[52:55], v[32:35]
    v_and_b32 v123, 1, v0
    v_mfma_f32_16x16x32_bf16 v[36:39], a[240:243], a[52:55], v[36:39]
    buffer_load_dwordx4 a[92:95], v1, s[4:7], s34 offen offset:1024 sc1
    s_waitcnt vmcnt(9)
    v_mfma_f32_16x16x32_bf16 v[20:23], a[244:247], a[56:59], v[20:23]
    v_mfma_f32_16x16x32_bf16 v[24:27], a[248:251], a[56:59], v[24:27]
    v_mfma_f32_16x16x32_bf16 v[28:31], a[252:255], a[56:59], v[28:31]
    v_mfma_f32_16x16x32_bf16 v[32:35], a[120:123], a[56:59], v[32:35]
    v_lshl_add_u32 v122, v123, 2, v122
    v_mfma_f32_16x16x32_bf16 v[36:39], a[124:127], a[56:59], v[36:39]
    buffer_load_dwordx4 a[96:99], v1, s[4:7], s34 offen offset:2048 sc1
    s_waitcnt vmcnt(9)
    v_mfma_f32_16x16x32_bf16 v[20:23], a[128:131], a[60:63], v[20:23]
    v_mfma_f32_16x16x32_bf16 v[24:27], a[132:135], a[60:63], v[24:27]
    v_mfma_f32_16x16x32_bf16 v[28:31], a[136:139], a[60:63], v[28:31]
    v_mfma_f32_16x16x32_bf16 v[32:35], a[140:143], a[60:63], v[32:35]
    s_waitcnt lgkmcnt(0)
    s_barrier
    v_add_u32 v6, s46, v1
    v_mfma_f32_16x16x32_bf16 v[36:39], a[144:147], a[60:63], v[36:39]
    buffer_load_dwordx4 a[100:103], v1, s[4:7], s34 offen offset:3072 sc1
    s_waitcnt vmcnt(9)
    v_mfma_f32_16x16x32_bf16 v[20:23], a[148:151], a[64:67], v[20:23]
    ds_read_b128 v[60:63], v6 offset:0
    v_mfma_f32_16x16x32_bf16 v[24:27], a[152:155], a[64:67], v[24:27]
    v_mfma_f32_16x16x32_bf16 v[28:31], a[156:159], a[64:67], v[28:31]
    ds_read_b128 v[64:67], v6 offset:1024
    v_mfma_f32_16x16x32_bf16 v[32:35], a[160:163], a[64:67], v[32:35]
    v_mfma_f32_16x16x32_bf16 v[36:39], a[164:167], a[64:67], v[36:39]
    ds_read_b128 v[68:71], v6 offset:2048
    s_add_u32 s34, s33, 4096
    buffer_load_dwordx4 a[104:107], v1, s[4:7], s34 offen offset:0 sc1
    s_waitcnt vmcnt(9)
    v_mfma_f32_16x16x32_bf16 v[20:23], a[168:171], a[68:71], v[20:23]
    v_mfma_f32_16x16x32_bf16 v[24:27], a[172:175], a[68:71], v[24:27]
    ds_read_b128 v[72:75], v6 offset:3072
    v_mfma_f32_16x16x32_bf16 v[28:31], a[176:179], a[68:71], v[28:31]
    v_mfma_f32_16x16x32_bf16 v[32:35], a[180:183], a[68:71], v[32:35]
    ds_read_b128 v[76:79], v6 offset:4096
    v_mfma_f32_16x16x32_bf16 v[36:39], a[184:187], a[68:71], v[36:39]
    buffer_load_dwordx4 a[108:111], v1, s[4:7], s34 offen offset:1024 sc1
    s_waitcnt vmcnt(9)
    v_mfma_f32_16x16x32_bf16 v[20:23], a[188:191], a[72:75], v[20:23]
    v_mfma_f32_16x16x32_bf16 v[24:27], a[192:195], a[72:75], v[24:27]
    v_mfma_f32_16x16x32_bf16 v[28:31], a[196:199], a[72:75], v[28:31]
    v_mfma_f32_16x16x32_bf16 v[32:35], a[200:203], a[72:75], v[32:35]
    v_mfma_f32_16x16x32_bf16 v[36:39], a[204:207], a[72:75], v[36:39]
    buffer_load_dwordx4 a[112:115], v1, s[4:7], s34 offen offset:2048 sc1
    s_waitcnt vmcnt(9)
    v_mfma_f32_16x16x32_bf16 v[20:23], a[208:211], a[76:79], v[20:23]
    v_mfma_f32_16x16x32_bf16 v[24:27], a[212:215], a[76:79], v[24:27]
    v_mfma_f32_16x16x32_bf16 v[28:31], a[216:219], a[76:79], v[28:31]
    v_mfma_f32_16x16x32_bf16 v[32:35], a[220:223], a[76:79], v[32:35]
    v_mfma_f32_16x16x32_bf16 v[36:39], v[132:135], a[76:79], v[36:39]
    buffer_load_dwordx4 a[116:119], v1, s[4:7], s34 offen offset:3072 sc1
    s_waitcnt vmcnt(9)
    v_mfma_f32_16x16x32_bf16 v[20:23], v[136:139], a[80:83], v[20:23]
    v_mfma_f32_16x16x32_bf16 v[24:27], v[140:143], a[80:83], v[24:27]
    v_mfma_f32_16x16x32_bf16 v[28:31], v[144:147], a[80:83], v[28:31]
    v_mfma_f32_16x16x32_bf16 v[32:35], v[148:151], a[80:83], v[32:35]
    v_mfma_f32_16x16x32_bf16 v[36:39], v[152:155], a[80:83], v[36:39]
    s_add_u32 s34, s33, 8192
    buffer_load_dwordx4 a[20:23], v1, s[4:7], s34 offen offset:0 sc1
    s_waitcnt vmcnt(9)
    v_mfma_f32_16x16x32_bf16 v[20:23], a[0:3], a[84:87], v[20:23]
    v_mfma_f32_16x16x32_bf16 v[24:27], a[4:7], a[84:87], v[24:27]
    v_mfma_f32_16x16x32_bf16 v[28:31], a[8:11], a[84:87], v[28:31]
    v_mfma_f32_16x16x32_bf16 v[32:35], a[12:15], a[84:87], v[32:35]
    v_mfma_f32_16x16x32_bf16 v[36:39], a[16:19], a[84:87], v[36:39]
    buffer_load_dwordx4 a[24:27], v1, s[4:7], s34 offen offset:1024 sc1
    s_waitcnt vmcnt(9)
    v_mfma_f32_16x16x32_bf16 v[40:43], v[156:159], a[88:91], 0
    v_add_u32 v7, s46, v1
    v_mfma_f32_16x16x32_bf16 v[44:47], v[160:163], a[88:91], 0
    v_mfma_f32_16x16x32_bf16 v[48:51], v[164:167], a[88:91], 0
    v_mfma_f32_16x16x32_bf16 v[52:55], v[168:171], a[88:91], 0
    s_waitcnt lgkmcnt(0)
    v_mfma_f32_16x16x32_bf16 v[56:59], v[172:175], a[88:91], 0
    v_add_f32 v60, v60, v20
    v_add_f32 v61, v61, v21
    buffer_load_dwordx4 a[28:31], v1, s[4:7], s34 offen offset:2048 sc1
    s_waitcnt vmcnt(9)
    v_mfma_f32_16x16x32_bf16 v[40:43], v[176:179], a[92:95], v[40:43]
    v_add_f32 v62, v62, v22
    v_add_f32 v63, v63, v23
    v_mfma_f32_16x16x32_bf16 v[44:47], v[180:183], a[92:95], v[44:47]
    ds_write_b128 v7, v[60:63] offset:0
    v_mfma_f32_16x16x32_bf16 v[48:51], v[184:187], a[92:95], v[48:51]
    v_mfma_f32_16x16x32_bf16 v[52:55], v[188:191], a[92:95], v[52:55]
    v_mfma_f32_16x16x32_bf16 v[56:59], v[192:195], a[92:95], v[56:59]
    v_add_f32 v64, v64, v24
    v_add_f32 v65, v65, v25
    buffer_load_dwordx4 a[32:35], v1, s[4:7], s34 offen offset:3072 sc1
    s_waitcnt vmcnt(9)
    v_mfma_f32_16x16x32_bf16 v[40:43], v[196:199], a[96:99], v[40:43]
    v_add_f32 v66, v66, v26
    v_add_f32 v67, v67, v27
    v_mfma_f32_16x16x32_bf16 v[44:47], v[200:203], a[96:99], v[44:47]
    ds_write_b128 v7, v[64:67] offset:1024
    v_mfma_f32_16x16x32_bf16 v[48:51], v[204:207], a[96:99], v[48:51]
    v_mfma_f32_16x16x32_bf16 v[52:55], v[208:211], a[96:99], v[52:55]
    v_mfma_f32_16x16x32_bf16 v[56:59], v[212:215], a[96:99], v[56:59]
    v_add_f32 v68, v68, v28
    v_add_f32 v69, v69, v29
    s_add_u32 s34, s33, 12288
    buffer_load_dwordx4 a[36:39], v1, s[4:7], s34 offen offset:0 sc1
    s_waitcnt vmcnt(9)
    v_mfma_f32_16x16x32_bf16 v[40:43], v[216:219], a[100:103], v[40:43]
    v_add_f32 v70, v70, v30
    v_add_f32 v71, v71, v31
    v_mfma_f32_16x16x32_bf16 v[44:47], v[220:223], a[100:103], v[44:47]
    ds_write_b128 v7, v[68:71] offset:2048
    v_mfma_f32_16x16x32_bf16 v[48:51], v[224:227], a[100:103], v[48:51]
    v_mfma_f32_16x16x32_bf16 v[52:55], v[228:231], a[100:103], v[52:55]
    v_mfma_f32_16x16x32_bf16 v[56:59], v[232:235], a[100:103], v[56:59]
    v_add_f32 v72, v72, v32
    v_add_f32 v73, v73, v33
    buffer_load_dwordx4 a[40:43], v1, s[4:7], s34 offen offset:1024 sc1
    s_waitcnt vmcnt(9)
    v_mfma_f32_16x16x32_bf16 v[40:43], v[236:239], a[104:107], v[40:43]
    v_add_f32 v74, v74, v34
    v_add_f32 v75, v75, v35
    v_mfma_f32_16x16x32_bf16 v[44:47], v[240:243], a[104:107], v[44:47]
    ds_write_b128 v7, v[72:75] offset:3072
    v_mfma_f32_16x16x32_bf16 v[48:51], v[244:247], a[104:107], v[48:51]
    v_mfma_f32_16x16x32_bf16 v[52:55], v[248:251], a[104:107], v[52:55]
    v_mfma_f32_16x16x32_bf16 v[56:59], v[252:255], a[104:107], v[56:59]
    v_add_f32 v76, v76, v36
    v_add_f32 v77, v77, v37
    s_mul_i32 s53, s20, 30720
    s_mul_i32 s52, s24, 122880
    s_add_u32 s52, s52, s53
    s_add_u32 s52, s52, 16384
    s_mov_b32 m0, s53
    s_nop 0
    buffer_load_dwordx4 v1, s[4:7], s52 offen offset:0 lds
    s_mov_b32 m0, s53
    s_nop 0
    buffer_load_dwordx4 v1, s[4:7], s52 offen offset:1024 lds
    s_waitcnt vmcnt(10)
    v_mfma_f32_16x16x32_bf16 v[40:43], a[224:227], a[108:111], v[40:43]
    v_add_f32 v78, v78, v38
    v_add_f32 v79, v79, v39
    v_mfma_f32_16x16x32_bf16 v[44:47], a[228:231], a[108:111], v[44:47]
    ds_write_b128 v7, v[76:79] offset:4096
    v_mfma_f32_16x16x32_bf16 v[48:51], a[232:235], a[108:111], v[48:51]
    v_mfma_f32_16x16x32_bf16 v[52:55], a[236:239], a[108:111], v[52:55]
    v_mfma_f32_16x16x32_bf16 v[56:59], a[240:243], a[108:111], v[56:59]
    s_mov_b32 m0, s53
    s_nop 0
    buffer_load_dwordx4 v1, s[4:7], s52 offen offset:2048 lds
    s_mov_b32 m0, s53
    s_nop 0
    buffer_load_dwordx4 v1, s[4:7], s52 offen offset:3072 lds
    s_waitcnt vmcnt(11)
    v_mfma_f32_16x16x32_bf16 v[40:43], a[244:247], a[112:115], v[40:43]
    v_mfma_f32_16x16x32_bf16 v[44:47], a[248:251], a[112:115], v[44:47]
    v_mfma_f32_16x16x32_bf16 v[48:51], a[252:255], a[112:115], v[48:51]
    v_mfma_f32_16x16x32_bf16 v[52:55], a[120:123], a[112:115], v[52:55]
    v_mfma_f32_16x16x32_bf16 v[56:59], a[124:127], a[112:115], v[56:59]
    s_add_u32 s52, s52, 4096
    s_add_u32 s53, s53, 4096
    s_mov_b32 m0, s53
    s_nop 0
    buffer_load_dwordx4 v1, s[4:7], s52 offen offset:0 lds
    s_mov_b32 m0, s53
    s_nop 0
    buffer_load_dwordx4 v1, s[4:7], s52 offen offset:1024 lds
    s_waitcnt vmcnt(12)
    v_mfma_f32_16x16x32_bf16 v[40:43], a[128:131], a[116:119], v[40:43]
    v_mfma_f32_16x16x32_bf16 v[44:47], a[132:135], a[116:119], v[44:47]
    v_mfma_f32_16x16x32_bf16 v[48:51], a[136:139], a[116:119], v[48:51]
    v_mfma_f32_16x16x32_bf16 v[52:55], a[140:143], a[116:119], v[52:55]
    s_waitcnt lgkmcnt(0)
    s_barrier
    v_add_u32 v6, s47, v1
    v_mfma_f32_16x16x32_bf16 v[56:59], a[144:147], a[116:119], v[56:59]
    s_mov_b32 m0, s53
    s_nop 0
    buffer_load_dwordx4 v1, s[4:7], s52 offen offset:2048 lds
    s_mov_b32 m0, s53
    s_nop 0
    buffer_load_dwordx4 v1, s[4:7], s52 offen offset:3072 lds
    s_waitcnt vmcnt(13)
    v_mfma_f32_16x16x32_bf16 v[40:43], a[148:151], a[20:23], v[40:43]
    ds_read_b128 v[80:83], v6 offset:0
    v_mfma_f32_16x16x32_bf16 v[44:47], a[152:155], a[20:23], v[44:47]
    v_mfma_f32_16x16x32_bf16 v[48:51], a[156:159], a[20:23], v[48:51]
    ds_read_b128 v[84:87], v6 offset:1024
    v_mfma_f32_16x16x32_bf16 v[52:55], a[160:163], a[20:23], v[52:55]
    v_mfma_f32_16x16x32_bf16 v[56:59], a[164:167], a[20:23], v[56:59]
    ds_read_b128 v[88:91], v6 offset:2048
    s_add_u32 s52, s52, 4096
    s_add_u32 s53, s53, 4096
    s_mov_b32 m0, s53
    s_nop 0
    buffer_load_dwordx4 v1, s[4:7], s52 offen offset:0 lds
    s_mov_b32 m0, s53
    s_nop 0
    buffer_load_dwordx4 v1, s[4:7], s52 offen offset:1024 lds
    s_waitcnt vmcnt(14)
    v_mfma_f32_16x16x32_bf16 v[40:43], a[168:171], a[24:27], v[40:43]
    v_mfma_f32_16x16x32_bf16 v[44:47], a[172:175], a[24:27], v[44:47]
    ds_read_b128 v[92:95], v6 offset:3072
    v_mfma_f32_16x16x32_bf16 v[48:51], a[176:179], a[24:27], v[48:51]
    v_mfma_f32_16x16x32_bf16 v[52:55], a[180:183], a[24:27], v[52:55]
    ds_read_b128 v[96:99], v6 offset:4096
    v_mfma_f32_16x16x32_bf16 v[56:59], a[184:187], a[24:27], v[56:59]
    s_mov_b32 m0, s53
    s_nop 0
    buffer_load_dwordx4 v1, s[4:7], s52 offen offset:2048 lds
    s_mov_b32 m0, s53
    s_nop 0
    buffer_load_dwordx4 v1, s[4:7], s52 offen offset:3072 lds
    s_waitcnt vmcnt(15)
    v_mfma_f32_16x16x32_bf16 v[40:43], a[188:191], a[28:31], v[40:43]
    v_mfma_f32_16x16x32_bf16 v[44:47], a[192:195], a[28:31], v[44:47]
    v_mfma_f32_16x16x32_bf16 v[48:51], a[196:199], a[28:31], v[48:51]
    v_mfma_f32_16x16x32_bf16 v[52:55], a[200:203], a[28:31], v[52:55]
    v_mfma_f32_16x16x32_bf16 v[56:59], a[204:207], a[28:31], v[56:59]
    s_add_u32 s52, s52, 4096
    s_add_u32 s53, s53, 4096
    s_mov_b32 m0, s53
    s_nop 0
    buffer_load_dwordx4 v1, s[4:7], s52 offen offset:0 lds
    s_mov_b32 m0, s53
    s_nop 0
    buffer_load_dwordx4 v1, s[4:7], s52 offen offset:1024 lds
    s_waitcnt vmcnt(16)
    v_mfma_f32_16x16x32_bf16 v[40:43], a[208:211], a[32:35], v[40:43]
    v_mfma_f32_16x16x32_bf16 v[44:47], a[212:215], a[32:35], v[44:47]
    v_mfma_f32_16x16x32_bf16 v[48:51], a[216:219], a[32:35], v[48:51]
    v_mfma_f32_16x16x32_bf16 v[52:55], a[220:223], a[32:35], v[52:55]
    v_mfma_f32_16x16x32_bf16 v[56:59], v[132:135], a[32:35], v[56:59]
    s_mov_b32 m0, s53
    s_nop 0
    buffer_load_dwordx4 v1, s[4:7], s52 offen offset:2048 lds
    s_mov_b32 m0, s53
    s_nop 0
    buffer_load_dwordx4 v1, s[4:7], s52 offen offset:3072 lds
    s_waitcnt vmcnt(17)
    v_mfma_f32_16x16x32_bf16 v[40:43], v[136:139], a[36:39], v[40:43]
    v_mfma_f32_16x16x32_bf16 v[44:47], v[140:143], a[36:39], v[44:47]
    v_mfma_f32_16x16x32_bf16 v[48:51], v[144:147], a[36:39], v[48:51]
    v_mfma_f32_16x16x32_bf16 v[52:55], v[148:151], a[36:39], v[52:55]
    v_mfma_f32_16x16x32_bf16 v[56:59], v[152:155], a[36:39], v[56:59]
    s_add_u32 s52, s52, 4096
    s_add_u32 s53, s53, 4096
    s_mov_b32 m0, s53
    s_nop 0
    buffer_load_dwordx4 v1, s[4:7], s52 offen offset:0 lds
    s_mov_b32 m0, s53
    s_nop 0
    buffer_load_dwordx4 v1, s[4:7], s52 offen offset:1024 lds
    s_waitcnt vmcnt(18)
    v_mfma_f32_16x16x32_bf16 v[40:43], a[0:3], a[40:43], v[40:43]
    v_mfma_f32_16x16x32_bf16 v[44:47], a[4:7], a[40:43], v[44:47]
    v_mfma_f32_16x16x32_bf16 v[48:51], a[8:11], a[40:43], v[48:51]
    v_mfma_f32_16x16x32_bf16 v[52:55], a[12:15], a[40:43], v[52:55]
    v_mfma_f32_16x16x32_bf16 v[56:59], a[16:19], a[40:43], v[56:59]
    s_mov_b32 m0, s53
    s_nop 0
    buffer_load_dwordx4 v1, s[4:7], s52 offen offset:2048 lds
    s_mov_b32 m0, s53
    s_nop 0
    buffer_load_dwordx4 v1, s[4:7], s52 offen offset:3072 lds
    s_waitcnt lgkmcnt(0)
    v_pk_add_f32 v[40:41], v[40:41], v[80:81]
    v_pk_add_f32 v[42:43], v[42:43], v[82:83]
    v_pk_add_f32 v[44:45], v[44:45], v[84:85]
    v_pk_add_f32 v[46:47], v[46:47], v[86:87]
    v_pk_add_f32 v[48:49], v[48:49], v[88:89]
    v_pk_add_f32 v[50:51], v[50:51], v[90:91]
    v_pk_add_f32 v[52:53], v[52:53], v[92:93]
    v_pk_add_f32 v[54:55], v[54:55], v[94:95]
    v_pk_add_f32 v[56:57], v[56:57], v[96:97]
    v_pk_add_f32 v[58:59], v[58:59], v[98:99]
    s_cmp_lg_u32 s28, 0
    s_cbranch_scc1 L_final
    v_dot2c_f32_bf16 v40, s66, v8
    v_dot2c_f32_bf16 v41, s67, v8
    v_dot2c_f32_bf16 v42, s66, v9
    v_dot2c_f32_bf16 v43, s67, v9
    v_dot2c_f32_bf16 v44, s66, v10
    v_dot2c_f32_bf16 v45, s67, v10
    v_dot2c_f32_bf16 v46, s66, v11
    v_dot2c_f32_bf16 v47, s67, v11
    v_dot2c_f32_bf16 v48, s66, v12
    v_dot2c_f32_bf16 v49, s67, v12
    v_dot2c_f32_bf16 v50, s66, v13
    v_dot2c_f32_bf16 v51, s67, v13
    v_dot2c_f32_bf16 v52, s66, v14
    v_dot2c_f32_bf16 v53, s67, v14
    v_dot2c_f32_bf16 v54, s66, v15
    v_dot2c_f32_bf16 v55, s67, v15
    v_dot2c_f32_bf16 v56, s66, v16
    v_dot2c_f32_bf16 v57, s67, v16
    v_dot2c_f32_bf16 v58, s66, v17
    v_dot2c_f32_bf16 v59, s67, v17
    v_mov_b32 v60, 0
    v_mov_b32 v61, 0
    v_cvt_pk_bf16_f32 v8, v40, v41
    v_cvt_pk_bf16_f32 v9, v42, v43
    v_cvt_pk_bf16_f32 v10, v44, v45
    v_cvt_pk_bf16_f32 v11, v46, v47
    buffer_store_dwordx4 v[8:11], v1, s[4:7], s39 offen
    v_cvt_pk_bf16_f32 v12, v48, v49
    v_cvt_pk_bf16_f32 v13, v50, v51
    v_cvt_pk_bf16_f32 v14, v52, v53
    v_cvt_pk_bf16_f32 v15, v54, v55
    buffer_store_dwordx4 v[12:15], v1, s[4:7], s39 offen offset:1024
    v_cvt_pk_bf16_f32 v16, v56, v57
    v_cvt_pk_bf16_f32 v17, v58, v59
    buffer_store_dwordx2 v[16:17], v1, s[4:7], s38 offen offset:2048
    v_dot2c_f32_bf16 v60, s68, v8
    v_dot2c_f32_bf16 v61, v8, v8
    v_dot2c_f32_bf16 v60, s68, v9
    v_dot2c_f32_bf16 v61, v9, v9
    v_dot2c_f32_bf16 v60, s68, v10
    v_dot2c_f32_bf16 v61, v10, v10
    v_dot2c_f32_bf16 v60, s68, v11
    v_dot2c_f32_bf16 v61, v11, v11
    v_dot2c_f32_bf16 v60, s68, v12
    v_dot2c_f32_bf16 v61, v12, v12
    v_dot2c_f32_bf16 v60, s68, v13
    v_dot2c_f32_bf16 v61, v13, v13
    v_dot2c_f32_bf16 v60, s68, v14
    v_dot2c_f32_bf16 v61, v14, v14
    v_dot2c_f32_bf16 v60, s68, v15
    v_dot2c_f32_bf16 v61, v15, v15
    v_dot2c_f32_bf16 v60, s68, v16
    v_dot2c_f32_bf16 v61, v16, v16
    v_dot2c_f32_bf16 v60, s68, v17
    v_dot2c_f32_bf16 v61, v17, v17
    s_nop 2
    buffer_store_dwordx2 v[60:61], v18, s[4:7], s41 offen
    s_add_u32 s52, s52, 4096
    s_add_u32 s53, s53, 4096
    s_mov_b32 m0, s53
    s_nop 0
    buffer_load_dwordx4 v1, s[4:7], s52 offen offset:0 lds
    s_mov_b32 m0, s53
    s_nop 0
    buffer_load_dwordx4 v1, s[4:7], s52 offen offset:1024 lds
    s_mov_b32 m0, s53
    s_nop 0
    buffer_load_dwordx4 v1, s[4:7], s52 offen offset:2048 lds
    s_mov_b32 m0, s53
    s_nop 0
    buffer_load_dwordx4 v1, s[4:7], s52 offen offset:3072 lds
    s_add_u32 s52, s52, 4096
    s_add_u32 s53, s53, 4096
    s_mov_b32 m0, s53
    s_nop 0
    buffer_load_dwordx4 v1, s[4:7], s52 offen offset:0 lds
    s_mov_b32 m0, s53
    s_nop 0
    buffer_load_dwordx4 v1, s[4:7], s52 offen offset:1024 lds
    s_waitcnt vmcnt(6)
    v_mov_b32 v5, s27
    s_mov_b64 exec, 1
    s_cmp_lg_u32 s29, 0
    s_cbranch_scc1 L_sg_50
    buffer_store_dword v5, off, s[4:7], s40
L_sj_51:
    s_mov_b64 exec, -1
    s_mov_b32 m0, s53
    s_nop 0
    buffer_load_dwordx4 v1, s[4:7], s52 offen offset:2048 lds
    s_mov_b32 m0, s53
    s_nop 0
    buffer_load_dwordx4 v1, s[4:7], s52 offen offset:3072 lds
    s_add_u32 s52, s52, 4096
    s_add_u32 s53, s53, 4096
    s_mov_b32 m0, s53
    s_nop 0
    buffer_load_dwordx4 v1, s[4:7], s52 offen offset:0 lds
    s_mov_b32 m0, s53
    s_nop 0
    buffer_load_dwordx4 v1, s[4:7], s52 offen offset:1024 lds
    s_mov_b32 s28, 200704
    buffer_load_dword v5, v122, s[4:7], s98 offen sc1
    s_mov_b32 s35, 0
    s_sleep 1
L_poll_52:
    buffer_load_dword v7, v122, s[4:7], s98 offen sc1
    s_waitcnt vmcnt(1)
    v_cmp_ne_u32 vcc, s27, v5
    s_nop 4
    s_cbranch_vccz L_pollx_53
    buffer_load_dword v5, v122, s[4:7], s98 offen sc1
    s_waitcnt vmcnt(1)
    v_cmp_ne_u32 vcc, s27, v7
    s_nop 4
    s_cbranch_vccz L_pollx_53
    s_add_u32 s35, s35, 1
    s_cmp_lt_u32 s35, 0x20000
    s_cbranch_scc1 L_poll_52
L_pollx_53:
    s_cmp_lg_u32 s29, 0
    s_cbranch_scc1 L_pg_54
L_pj_55:
    buffer_load_dwordx4 v[20:23], v1, s[4:7], s96 offen offset:0 sc1
    buffer_load_dwordx4 v[24:27], v1, s[4:7], s96 offen offset:1024 sc1
    buffer_load_dwordx4 v[28:31], v1, s[4:7], s96 offen offset:2048 sc1
    buffer_load_dwordx4 v[32:35], v1, s[4:7], s96 offen offset:3072 sc1
    s_add_u32 s96, s96, 4096
    buffer_load_dwordx4 v[36:39], v1, s[4:7], s96 offen offset:0 sc1
    buffer_load_dwordx4 v[40:43], v1, s[4:7], s96 offen offset:1024 sc1
    buffer_load_dwordx4 v[44:47], v1, s[4:7], s96 offen offset:2048 sc1
    v_add_u32 v240, 0, v1
    v_add_u32 v241, 61440, v1
    v_lshlrev_b32 v6, 4, v4
    v_add_u32 v6, 160640, v6
    ds_read_b128 v[216:219], v6 offset:0
    ds_read_b128 v[220:223], v6 offset:64
    ds_read_b128 v[224:227], v6 offset:128
    ds_read_b128 v[228:231], v6 offset:192
    ds_read_b128 v[232:235], v6 offset:256
    ds_read_b128 v[236:239], v6 offset:320
    s_waitcnt lgkmcnt(0)
    s_barrier
    ds_read_b128 v[100:103], v240 offset:5120
    ds_read_b128 v[104:107], v240 offset:0
    ds_read_b128 v[108:111], v240 offset:1024
    ds_read_b128 v[112:115], v240 offset:11264
    ds_read_b128 v[116:119], v240 offset:6144
    ds_read_b128 v[120:123], v240 offset:7168
    ds_read_b128 v[124:127], v240 offset:17408
    ds_read_b128 v[128:131], v240 offset:12288
    s_waitcnt vmcnt(6)
    s_waitcnt lgkmcnt(7)
    v_mfma_f32_16x16x32_bf16 v[168:171], v[100:103], v[20:23], 0
    ds_read_b128 v[132:135], v240 offset:13312
    s_waitcnt lgkmcnt(7)
    v_mfma_f32_16x16x32_bf16 v[148:151], v[104:107], v[20:23], 0
    ds_read_b128 v[136:139], v240 offset:23552
    buffer_load_dwordx4 v[48:51], v1, s[4:7], s96 offen offset:3072 sc1
    s_waitcnt lgkmcnt(7)
    v_mfma_f32_16x16x32_bf16 v[152:155], v[108:111], v[20:23], 0
    ds_read_b128 v[140:143], v240 offset:18432
    s_waitcnt vmcnt(6)
    s_waitcnt lgkmcnt(7)
    v_mfma_f32_16x16x32_bf16 v[168:171], v[112:115], v[24:27], v[168:171]
    ds_read_b128 v[144:147], v240 offset:19456
    s_add_u32 s96, s96, 4096
    buffer_load_dwordx4 v[52:55], v1, s[4:7], s96 offen offset:0 sc1
    s_waitcnt lgkmcnt(7)
    v_mfma_f32_16x16x32_bf16 v[148:151], v[116:119], v[24:27], v[148:151]
    ds_read_b128 v[100:103], v240 offset:29696
    s_waitcnt lgkmcnt(7)
    v_mfma_f32_16x16x32_bf16 v[152:155], v[120:123], v[24:27], v[152:155]
    ds_read_b128 v[104:107], v240 offset:24576
    buffer_load_dwordx4 v[56:59], v1, s[4:7], s96 offen offset:1024 sc1
    s_waitcnt vmcnt(7)
    s_waitcnt lgkmcnt(7)
    v_mfma_f32_16x16x32_bf16 v[168:171], v[124:127], v[28:31], v[168:171]
    ds_read_b128 v[108:111], v240 offset:25600
    buffer_load_dwordx4 v[196:199], v1, s[4:7], s97 offen offset:0 sc1
    buffer_load_dwordx4 v[200:203], v1, s[4:7], s97 offen offset:1024 sc1
    buffer_load_dwordx4 v[204:207], v1, s[4:7], s97 offen offset:2048 sc1
    buffer_load_dwordx4 v[208:211], v1, s[4:7], s97 offen offset:3072 sc1
    s_waitcnt lgkmcnt(7)
    v_mfma_f32_16x16x32_bf16 v[148:151], v[128:131], v[28:31], v[148:151]
    ds_read_b128 v[112:115], v240 offset:35840
    buffer_load_dwordx4 v[60:63], v1, s[4:7], s96 offen offset:2048 sc1
    s_waitcnt lgkmcnt(7)
    v_mfma_f32_16x16x32_bf16 v[152:155], v[132:135], v[28:31], v[152:155]
    ds_read_b128 v[116:119], v240 offset:30720
    s_waitcnt vmcnt(11)
    s_waitcnt lgkmcnt(7)
    v_mfma_f32_16x16x32_bf16 v[168:171], v[136:139], v[32:35], v[168:171]
    ds_read_b128 v[120:123], v240 offset:31744
    buffer_load_dwordx4 v[64:67], v1, s[4:7], s96 offen offset:3072 sc1
    s_waitcnt lgkmcnt(7)
    v_mfma_f32_16x16x32_bf16 v[148:151], v[140:143], v[32:35], v[148:151]
    ds_read_b128 v[124:127], v240 offset:41984
    s_waitcnt lgkmcnt(7)
    v_mfma_f32_16x16x32_bf16 v[152:155], v[144:147], v[32:35], v[152:155]
    ds_read_b128 v[128:131], v240 offset:36864
    s_add_u32 s96, s96, 4096
    buffer_load_dwordx4 v[68:71], v1, s[4:7], s96 offen offset:0 sc1
    s_waitcnt vmcnt(12)
    s_waitcnt lgkmcnt(7)
    v_mfma_f32_16x16x32_bf16 v[168:171], v[100:103], v[36:39], v[168:171]
    ds_read_b128 v[132:135], v240 offset:37888
    s_waitcnt lgkmcnt(7)
    v_mfma_f32_16x16x32_bf16 v[148:151], v[104:107], v[36:39], v[148:151]
    ds_read_b128 v[136:139], v240 offset:48128
    buffer_load_dwordx4 v[72:75], v1, s[4:7], s96 offen offset:1024 sc1
    s_waitcnt lgkmcnt(7)
    v_mfma_f32_16x16x32_bf16 v[152:155], v[108:111], v[36:39], v[152:155]
    ds_read_b128 v[140:143], v240 offset:43008
    s_waitcnt vmcnt(12)
    s_waitcnt lgkmcnt(7)
    v_mfma_f32_16x16x32_bf16 v[168:171], v[112:115], v[40:43], v[168:171]
    ds_read_b128 v[144:147], v240 offset:44032
    buffer_load_dwordx4 v[76:79], v1, s[4:7], s96 offen offset:2048 sc1
    s_waitcnt lgkmcnt(7)
    v_mfma_f32_16x16x32_bf16 v[148:151], v[116:119], v[40:43], v[148:151]
    ds_read_b128 v[100:103], v240 offset:54272
    s_waitcnt lgkmcnt(7)
    v_mfma_f32_16x16x32_bf16 v[152:155], v[120:123], v[40:43], v[152:155]
    ds_read_b128 v[104:107], v240 offset:49152
    buffer_load_dwordx4 v[80:83], v1, s[4:7], s96 offen offset:3072 sc1
    s_waitcnt vmcnt(13)
    s_waitcnt lgkmcnt(7)
    v_mfma_f32_16x16x32_bf16 v[168:171], v[124:127], v[44:47], v[168:171]
    ds_read_b128 v[108:111], v240 offset:50176
    s_waitcnt lgkmcnt(7)
    v_mfma_f32_16x16x32_bf16 v[148:151], v[128:131], v[44:47], v[148:151]
    ds_read_b128 v[112:115], v240 offset:60416
    s_add_u32 s96, s96, 4096
    buffer_load_dwordx4 v[84:87], v1, s[4:7], s96 offen offset:0 sc1
    s_waitcnt lgkmcnt(7)
    v_mfma_f32_16x16x32_bf16 v[152:155], v[132:135], v[44:47], v[152:155]
    ds_read_b128 v[116:119], v240 offset:55296
    s_waitcnt vmcnt(13)
    s_waitcnt lgkmcnt(7)
    v_mfma_f32_16x16x32_bf16 v[168:171], v[136:139], v[48:51], v[168:171]
    ds_read_b128 v[120:123], v240 offset:56320
    buffer_load_dwordx4 v[88:91], v1, s[4:7], s96 offen offset:1024 sc1
    s_waitcnt lgkmcnt(7)
    v_mfma_f32_16x16x32_bf16 v[148:151], v[140:143], v[48:51], v[148:151]
    ds_read_b128 v[124:127], v241 offset:5120
    s_waitcnt lgkmcnt(7)
    v_mfma_f32_16x16x32_bf16 v[152:155], v[144:147], v[48:51], v[152:155]
    ds_read_b128 v[128:131], v241 offset:0
    buffer_load_dwordx4 v[92:95], v1, s[4:7], s96 offen offset:2048 sc1
    s_waitcnt vmcnt(14)
    s_waitcnt lgkmcnt(7)
    v_mfma_f32_16x16x32_bf16 v[168:171], v[100:103], v[52:55], v[168:171]
    ds_read_b128 v[132:135], v241 offset:1024
    s_waitcnt lgkmcnt(7)
    v_mfma_f32_16x16x32_bf16 v[148:151], v[104:107], v[52:55], v[148:151]
    ds_read_b128 v[136:139], v241 offset:11264
    buffer_load_dwordx4 v[96:99], v1, s[4:7], s96 offen offset:3072 sc1
    s_waitcnt lgkmcnt(7)
    v_mfma_f32_16x16x32_bf16 v[152:155], v[108:111], v[52:55], v[152:155]
    ds_read_b128 v[140:143], v241 offset:6144
    s_waitcnt vmcnt(14)
    s_waitcnt lgkmcnt(7)
    v_mfma_f32_16x16x32_bf16 v[168:171], v[112:115], v[56:59], v[168:171]
    ds_read_b128 v[144:147], v241 offset:7168
    s_waitcnt lgkmcnt(7)
    v_mfma_f32_16x16x32_bf16 v[148:151], v[116:119], v[56:59], v[148:151]
    ds_read_b128 v[100:103], v241 offset:17408
    s_waitcnt lgkmcnt(7)
    v_mfma_f32_16x16x32_bf16 v[152:155], v[120:123], v[56:59], v[152:155]
    ds_read_b128 v[104:107], v241 offset:12288
    s_waitcnt vmcnt(9)
    s_waitcnt lgkmcnt(7)
    v_mfma_f32_16x16x32_bf16 v[168:171], v[124:127], v[60:63], v[168:171]
    ds_read_b128 v[108:111], v241 offset:13312
    v_add_f32 v196, v196, v204
    v_add_f32 v197, v197, v205
    s_waitcnt lgkmcnt(7)
    v_mfma_f32_16x16x32_bf16 v[148:151], v[128:131], v[60:63], v[148:151]
    ds_read_b128 v[112:115], v241 offset:23552
    v_add_f32 v198, v198, v206
    v_add_f32 v199, v199, v207
    s_waitcnt lgkmcnt(7)
    v_mfma_f32_16x16x32_bf16 v[152:155], v[132:135], v[60:63], v[152:155]
    ds_read_b128 v[116:119], v241 offset:18432
    v_add_f32 v200, v200, v208
    v_add_f32 v201, v201, v209
    s_waitcnt vmcnt(8)
    s_waitcnt lgkmcnt(7)
    v_mfma_f32_16x16x32_bf16 v[168:171], v[136:139], v[64:67], v[168:171]
    ds_read_b128 v[120:123], v241 offset:19456
    v_add_f32 v202, v202, v210
    v_add_f32 v203, v203, v211
    s_waitcnt lgkmcnt(7)
    v_mfma_f32_16x16x32_bf16 v[148:151], v[140:143], v[64:67], v[148:151]
    ds_read_b128 v[124:127], v241 offset:29696
    v_add_f32 v196, v196, v200
    v_add_f32 v197, v197, v201
    s_waitcnt lgkmcnt(7)
    v_mfma_f32_16x16x32_bf16 v[152:155], v[144:147], v[64:67], v[152:155]
    ds_read_b128 v[128:131], v241 offset:24576
    v_add_f32 v198, v198, v202
    v_add_f32 v199, v199, v203
    s_waitcnt vmcnt(7)
    s_waitcnt lgkmcnt(7)
    v_mfma_f32_16x16x32_bf16 v[168:171], v[100:103], v[68:71], v[168:171]
    ds_read_b128 v[132:135], v241 offset:25600
    v_add_f32 v196, v196, v198
    v_add_f32 v197, v197, v199
    s_waitcnt lgkmcnt(7)
    v_mfma_f32_16x16x32_bf16 v[148:151], v[104:107], v[68:71], v[148:151]
    ds_read_b128 v[136:139], v241 offset:35840
    v_mov_b32 v198, v196
    v_mov_b32 v199, v197
    s_waitcnt lgkmcnt(7)
    v_mfma_f32_16x16x32_bf16 v[152:155], v[108:111], v[68:71], v[152:155]
    ds_read_b128 v[140:143], v241 offset:30720
    v_permlane16_swap_b32 v196, v198
    v_permlane16_swap_b32 v197, v199
    s_waitcnt vmcnt(6)
    s_waitcnt lgkmcnt(7)
    v_mfma_f32_16x16x32_bf16 v[168:171], v[112:115], v[72:75], v[168:171]
    ds_read_b128 v[144:147], v241 offset:31744
    v_add_f32 v196, v196, v198
    v_add_f32 v197, v197, v199
    s_waitcnt lgkmcnt(7)
    v_mfma_f32_16x16x32_bf16 v[148:151], v[116:119], v[72:75], v[148:151]
    ds_read_b128 v[100:103], v241 offset:41984
    v_mov_b32 v198, v196
    v_mov_b32 v199, v197
    s_waitcnt lgkmcnt(7)
    v_mfma_f32_16x16x32_bf16 v[152:155], v[120:123], v[72:75], v[152:155]
    ds_read_b128 v[104:107], v241 offset:36864
    v_permlane32_swap_b32 v196, v198
    v_permlane32_swap_b32 v197, v199
    s_waitcnt vmcnt(5)
    s_waitcnt lgkmcnt(7)
    v_mfma_f32_16x16x32_bf16 v[168:171], v[124:127], v[76:79], v[168:171]
    ds_read_b128 v[108:111], v241 offset:37888
    v_add_f32 v196, v196, v198
    v_add_f32 v197, v197, v199
    s_waitcnt lgkmcnt(7)
    v_mfma_f32_16x16x32_bf16 v[148:151], v[128:131], v[76:79], v[148:151]
    ds_read_b128 v[112:115], v241 offset:48128
    v_mul_f32 v212, 0xbacccccd, v196
    v_mul_f32 v198, v212, v212
    s_waitcnt lgkmcnt(7)
    v_mfma_f32_16x16x32_bf16 v[152:155], v[132:135], v[76:79], v[152:155]
    ds_read_b128 v[116:119], v241 offset:43008
    v_mov_b32 v199, 0x3acccccd
    v_fma_f32 v197, v197, v199, -v198
    s_waitcnt vmcnt(4)
    s_waitcnt lgkmcnt(7)
    v_mfma_f32_16x16x32_bf16 v[168:171], v[136:139], v[80:83], v[168:171]
    ds_read_b128 v[120:123], v241 offset:44032
    v_max_f32 v197, 0, v197
    v_add_f32 v197, 0x3727c5ac, v197
    s_waitcnt lgkmcnt(7)
    v_mfma_f32_16x16x32_bf16 v[148:151], v[140:143], v[80:83], v[148:151]
    ds_read_b128 v[124:127], v241 offset:54272
    v_rsq_f32 v213, v197
    s_waitcnt lgkmcnt(7)
    v_mfma_f32_16x16x32_bf16 v[152:155], v[144:147], v[80:83], v[152:155]
    ds_read_b128 v[128:131], v241 offset:49152
    s_waitcnt vmcnt(3)
    s_waitcnt lgkmcnt(7)
    v_mfma_f32_16x16x32_bf16 v[168:171], v[100:103], v[84:87], v[168:171]
    ds_read_b128 v[132:135], v241 offset:50176
    s_waitcnt lgkmcnt(7)
    v_mfma_f32_16x16x32_bf16 v[148:151], v[104:107], v[84:87], v[148:151]
    ds_read_b128 v[136:139], v241 offset:60416
    s_waitcnt lgkmcnt(7)
    v_mfma_f32_16x16x32_bf16 v[152:155], v[108:111], v[84:87], v[152:155]
    ds_read_b128 v[140:143], v241 offset:55296
    s_waitcnt vmcnt(2)
    s_waitcnt lgkmcnt(7)
    v_mfma_f32_16x16x32_bf16 v[168:171], v[112:115], v[88:91], v[168:171]
    ds_read_b128 v[144:147], v241 offset:56320
    s_waitcnt lgkmcnt(7)
    v_mfma_f32_16x16x32_bf16 v[148:151], v[116:119], v[88:91], v[148:151]
    s_waitcnt lgkmcnt(6)
    v_mfma_f32_16x16x32_bf16 v[152:155], v[120:123], v[88:91], v[152:155]
    s_waitcnt vmcnt(1)
    s_waitcnt lgkmcnt(5)
    v_mfma_f32_16x16x32_bf16 v[168:171], v[124:127], v[92:95], v[168:171]
    s_waitcnt lgkmcnt(4)
    v_mfma_f32_16x16x32_bf16 v[148:151], v[128:131], v[92:95], v[148:151]
    s_waitcnt lgkmcnt(3)
    v_mfma_f32_16x16x32_bf16 v[152:155], v[132:135], v[92:95], v[152:155]
    s_waitcnt vmcnt(0)
    s_waitcnt lgkmcnt(2)
    v_mfma_f32_16x16x32_bf16 v[168:171], v[136:139], v[96:99], v[168:171]
    s_waitcnt lgkmcnt(1)
    v_mfma_f32_16x16x32_bf16 v[148:151], v[140:143], v[96:99], v[148:151]
    s_waitcnt lgkmcnt(0)
    v_mfma_f32_16x16x32_bf16 v[152:155], v[144:147], v[96:99], v[152:155]
    v_mov_b32 v214, v213
    s_lshr_b32 s36, s24, 2
    s_xor_b32 s48, s36, s20
    s_and_b32 s48, s48, 1
    s_cbranch_scc1 L_kvdone_56
    v_pk_fma_f32 v[168:169], v[212:213], v[236:237], v[168:169] op_sel_hi:[0,1,1]
    v_pk_fma_f32 v[170:171], v[212:213], v[238:239], v[170:171] op_sel_hi:[0,1,1]
    v_pk_mul_f32 v[168:169], v[214:215], v[168:169] op_sel_hi:[0,1]
    v_pk_mul_f32 v[170:171], v[214:215], v[170:171] op_sel_hi:[0,1]
    v_cvt_pk_bf16_f32 v172, v168, v169
    v_cvt_pk_bf16_f32 v173, v170, v171
    s_and_b32 s37, s20, 1
    s_bitcmp1_b32 s24, 1
    s_cbranch_scc1 L_kvv_57
    s_lshl_b32 s37, s37, 4
    v_add_u32 v6, s37, v3
    s_bitcmp1_b32 s24, 0
    s_cbranch_scc1 L_kvk1_58
    v_lshrrev_b32 v7, 1, v4
    v_lshlrev_b32 v7, 9, v7
    v_lshl_add_u32 v7, v6, 4, v7
    v_and_b32 v6, 1, v4
    v_lshl_add_u32 v7, v6, 3, v7
    buffer_store_dwordx2 v[172:173], v7, s[4:7], s94 offen sc1
    s_branch L_kvj_59
L_kvk1_58:
    v_lshlrev_b32 v6, 3, v6
    s_mov_b64 exec, 0xffff
    buffer_store_dwordx2 v[172:173], v6, s[4:7], s94 offen offset:1024 sc1
    s_mov_b64 exec, -1
    s_branch L_kvj_59
L_kvv_57:
    s_lshr_b32 s36, s20, 1
    s_lshl_b32 s36, s36, 9
    s_add_u32 s36, s36, 161088
    v_lshlrev_b32 v6, 7, v4
    v_lshl_add_u32 v6, v3, 1, v6
    v_add_u32 v6, s36, v6
    ds_write_b16 v6, v172
    ds_write_b16_d16_hi v6, v172 offset:32
    ds_write_b16 v6, v173 offset:64
    ds_write_b16_d16_hi v6, v173 offset:96
    v_lshlrev_b32 v6, 5, v3
    v_lshl_add_u32 v6, v4, 3, v6
    v_add_u32 v6, s36, v6
    ds_read_b64 v[174:175], v6
    s_mul_i32 s37, s37, 768
    s_add_u32 s37, s94, s37
    s_and_b32 s36, s24, 1
    s_lshl_b32 s36, s36, 8
    s_add_u32 s37, s37, s36
    v_and_b32 v6, 1, v4
    v_mul_u32_u24 v6, 384, v6
    v_lshl_add_u32 v6, v3, 4, v6
    v_lshrrev_b32 v7, 1, v4
    v_lshl_add_u32 v6, v7, 3, v6
    s_cmp_lg_u32 s36, 0
    s_cselect_b32 s36, 4, 99
    s_cselect_b32 exec_lo, 0x00ff00ff, -1
    v_cmp_eq_u32 vcc, s36, v3
    v_mov_b32 v7, 0x3f803f80
    s_mov_b32 exec_hi, exec_lo
    s_waitcnt lgkmcnt(0)
    v_cndmask_b32 v174, v174, v7, vcc
    v_cndmask_b32 v175, v175, v7, vcc
    buffer_store_dwordx2 v[174:175], v6, s[4:7], s37 offen offset:1280 sc1
    s_mov_b64 exec, -1
    s_branch L_kvj_59
L_kvdone_56:
    v_mov_b32 v6, 1073741824
    buffer_store_dwordx2 v[172:173], v6, s[4:7], 0 offen
L_kvj_59:
    ds_read_b128 v[100:103], v240 offset:2048
    ds_read_b128 v[104:107], v240 offset:3072
    ds_read_b128 v[108:111], v240 offset:4096
    ds_read_b128 v[112:115], v240 offset:8192
    ds_read_b128 v[116:119], v240 offset:9216
    ds_read_b128 v[120:123], v240 offset:10240
    ds_read_b128 v[124:127], v240 offset:14336
    ds_read_b128 v[128:131], v240 offset:15360
    s_waitcnt lgkmcnt(7)
    v_mfma_f32_16x16x32_bf16 v[156:159], v[100:103], v[20:23], 0
    ds_read_b128 v[132:135], v240 offset:16384
    s_waitcnt lgkmcnt(7)
    v_mfma_f32_16x16x32_bf16 v[160:163], v[104:107], v[20:23], 0
    ds_read_b128 v[136:139], v240 offset:20480
    s_waitcnt lgkmcnt(7)
    v_mfma_f32_16x16x32_bf16 v[164:167], v[108:111], v[20:23], 0
    ds_read_b128 v[140:143], v240 offset:21504
    s_waitcnt lgkmcnt(7)
    v_mfma_f32_16x16x32_bf16 v[156:159], v[112:115], v[24:27], v[156:159]
    ds_read_b128 v[144:147], v240 offset:22528
    s_waitcnt lgkmcnt(7)
    v_mfma_f32_16x16x32_bf16 v[160:163], v[116:119], v[24:27], v[160:163]
    ds_read_b128 v[100:103], v240 offset:26624
    s_waitcnt lgkmcnt(7)
    v_mfma_f32_16x16x32_bf16 v[164:167], v[120:123], v[24:27], v[164:167]
    ds_read_b128 v[104:107], v240 offset:27648
    s_waitcnt lgkmcnt(7)
    v_mfma_f32_16x16x32_bf16 v[156:159], v[124:127], v[28:31], v[156:159]
    ds_read_b128 v[108:111], v240 offset:28672
    s_waitcnt lgkmcnt(7)
    v_mfma_f32_16x16x32_bf16 v[160:163], v[128:131], v[28:31], v[160:163]
    ds_read_b128 v[112:115], v240 offset:32768
    s_waitcnt lgkmcnt(7)
    v_mfma_f32_16x16x32_bf16 v[164:167], v[132:135], v[28:31], v[164:167]
    ds_read_b128 v[116:119], v240 offset:33792
    s_waitcnt lgkmcnt(7)
    v_mfma_f32_16x16x32_bf16 v[156:159], v[136:139], v[32:35], v[156:159]
    ds_read_b128 v[120:123], v240 offset:34816
    s_waitcnt lgkmcnt(7)
    v_mfma_f32_16x16x32_bf16 v[160:163], v[140:143], v[32:35], v[160:163]
    ds_read_b128 v[124:127], v240 offset:38912
    s_waitcnt lgkmcnt(7)
    v_mfma_f32_16x16x32_bf16 v[164:167], v[144:147], v[32:35], v[164:167]
    ds_read_b128 v[128:131], v240 offset:39936
    s_waitcnt lgkmcnt(7)
    v_mfma_f32_16x16x32_bf16 v[156:159], v[100:103], v[36:39], v[156:159]
    ds_read_b128 v[132:135], v240 offset:40960
    s_waitcnt lgkmcnt(7)
    v_mfma_f32_16x16x32_bf16 v[160:163], v[104:107], v[36:39], v[160:163]
    ds_read_b128 v[136:139], v240 offset:45056
    s_waitcnt lgkmcnt(7)
    v_mfma_f32_16x16x32_bf16 v[164:167], v[108:111], v[36:39], v[164:167]
    ds_read_b128 v[140:143], v240 offset:46080
    s_waitcnt lgkmcnt(7)
    v_mfma_f32_16x16x32_bf16 v[156:159], v[112:115], v[40:43], v[156:159]
    ds_read_b128 v[144:147], v240 offset:47104
    s_waitcnt lgkmcnt(7)
    v_mfma_f32_16x16x32_bf16 v[160:163], v[116:119], v[40:43], v[160:163]
    ds_read_b128 v[100:103], v240 offset:51200
    s_waitcnt lgkmcnt(7)
    v_mfma_f32_16x16x32_bf16 v[164:167], v[120:123], v[40:43], v[164:167]
    ds_read_b128 v[104:107], v240 offset:52224
    s_waitcnt lgkmcnt(7)
    v_mfma_f32_16x16x32_bf16 v[156:159], v[124:127], v[44:47], v[156:159]
    ds_read_b128 v[108:111], v240 offset:53248
    s_waitcnt lgkmcnt(7)
    v_mfma_f32_16x16x32_bf16 v[160:163], v[128:131], v[44:47], v[160:163]
    ds_read_b128 v[112:115], v240 offset:57344
    s_waitcnt lgkmcnt(7)
    v_mfma_f32_16x16x32_bf16 v[164:167], v[132:135], v[44:47], v[164:167]
    ds_read_b128 v[116:119], v240 offset:58368
    s_waitcnt lgkmcnt(7)
    v_mfma_f32_16x16x32_bf16 v[156:159], v[136:139], v[48:51], v[156:159]
    ds_read_b128 v[120:123], v240 offset:59392
    s_waitcnt lgkmcnt(7)
    v_mfma_f32_16x16x32_bf16 v[160:163], v[140:143], v[48:51], v[160:163]
    ds_read_b128 v[124:127], v241 offset:2048
    s_waitcnt lgkmcnt(7)
    v_mfma_f32_16x16x32_bf16 v[164:167], v[144:147], v[48:51], v[164:167]
    ds_read_b128 v[128:131], v241 offset:3072
    s_waitcnt lgkmcnt(7)
    v_mfma_f32_16x16x32_bf16 v[156:159], v[100:103], v[52:55], v[156:159]
    ds_read_b128 v[132:135], v241 offset:4096
    s_waitcnt lgkmcnt(7)
    v_mfma_f32_16x16x32_bf16 v[160:163], v[104:107], v[52:55], v[160:163]
    ds_read_b128 v[136:139], v241 offset:8192
    s_waitcnt lgkmcnt(7)
    v_mfma_f32_16x16x32_bf16 v[164:167], v[108:111], v[52:55], v[164:167]
    ds_read_b128 v[140:143], v241 offset:9216
    s_waitcnt lgkmcnt(7)
    v_mfma_f32_16x16x32_bf16 v[156:159], v[112:115], v[56:59], v[156:159]
    ds_read_b128 v[144:147], v241 offset:10240
    s_waitcnt lgkmcnt(7)
    v_mfma_f32_16x16x32_bf16 v[160:163], v[116:119], v[56:59], v[160:163]
    ds_read_b128 v[100:103], v241 offset:14336
    s_waitcnt lgkmcnt(7)
    v_mfma_f32_16x16x32_bf16 v[164:167], v[120:123], v[56:59], v[164:167]
    ds_read_b128 v[104:107], v241 offset:15360
    s_waitcnt lgkmcnt(7)
    v_mfma_f32_16x16x32_bf16 v[156:159], v[124:127], v[60:63], v[156:159]
    ds_read_b128 v[108:111], v241 offset:16384
    s_waitcnt lgkmcnt(7)
    v_mfma_f32_16x16x32_bf16 v[160:163], v[128:131], v[60:63], v[160:163]
    ds_read_b128 v[112:115], v241 offset:20480
    s_waitcnt lgkmcnt(7)
    v_mfma_f32_16x16x32_bf16 v[164:167], v[132:135], v[60:63], v[164:167]
    ds_read_b128 v[116:119], v241 offset:21504
    s_waitcnt lgkmcnt(7)
    v_mfma_f32_16x16x32_bf16 v[156:159], v[136:139], v[64:67], v[156:159]
    ds_read_b128 v[120:123], v241 offset:22528
    s_waitcnt lgkmcnt(7)
    v_mfma_f32_16x16x32_bf16 v[160:163], v[140:143], v[64:67], v[160:163]
    ds_read_b128 v[124:127], v241 offset:26624
    s_waitcnt lgkmcnt(7)
    v_mfma_f32_16x16x32_bf16 v[164:167], v[144:147], v[64:67], v[164:167]
    ds_read_b128 v[128:131], v241 offset:27648
    s_waitcnt lgkmcnt(7)
    v_mfma_f32_16x16x32_bf16 v[156:159], v[100:103], v[68:71], v[156:159]
    ds_read_b128 v[132:135], v241 offset:28672
    s_waitcnt vmcnt(0)
    s_barrier
    s_cmp_lg_u32 s20, 0
    s_cbranch_scc1 L_kvsig_60
    v_mov_b32 v5, s75
    s_mov_b64 exec, 1
    buffer_store_dword v5, off, s[4:7], s95 sc1
    s_mov_b64 exec, -1
L_kvsig_60:
    s_waitcnt lgkmcnt(7)
    v_mfma_f32_16x16x32_bf16 v[160:163], v[104:107], v[68:71], v[160:163]
    ds_read_b128 v[136:139], v241 offset:32768
    s_waitcnt lgkmcnt(7)
    v_mfma_f32_16x16x32_bf16 v[164:167], v[108:111], v[68:71], v[164:167]
    ds_read_b128 v[140:143], v241 offset:33792
    s_waitcnt lgkmcnt(7)
    v_mfma_f32_16x16x32_bf16 v[156:159], v[112:115], v[72:75], v[156:159]
    ds_read_b128 v[144:147], v241 offset:34816
    s_waitcnt lgkmcnt(7)
    v_mfma_f32_16x16x32_bf16 v[160:163], v[116:119], v[72:75], v[160:163]
    ds_read_b128 v[100:103], v241 offset:38912
    s_waitcnt lgkmcnt(7)
    v_mfma_f32_16x16x32_bf16 v[164:167], v[120:123], v[72:75], v[164:167]
    ds_read_b128 v[104:107], v241 offset:39936
    s_waitcnt lgkmcnt(7)
    v_mfma_f32_16x16x32_bf16 v[156:159], v[124:127], v[76:79], v[156:159]
    ds_read_b128 v[108:111], v241 offset:40960
    s_waitcnt lgkmcnt(7)
    v_mfma_f32_16x16x32_bf16 v[160:163], v[128:131], v[76:79], v[160:163]
    ds_read_b128 v[112:115], v241 offset:45056
    s_waitcnt lgkmcnt(7)
    v_mfma_f32_16x16x32_bf16 v[164:167], v[132:135], v[76:79], v[164:167]
    ds_read_b128 v[116:119], v241 offset:46080
    s_waitcnt lgkmcnt(7)
    v_mfma_f32_16x16x32_bf16 v[156:159], v[136:139], v[80:83], v[156:159]
    ds_read_b128 v[120:123], v241 offset:47104
    s_waitcnt lgkmcnt(7)
    v_mfma_f32_16x16x32_bf16 v[160:163], v[140:143], v[80:83], v[160:163]
    ds_read_b128 v[124:127], v241 offset:51200
    s_waitcnt lgkmcnt(7)
    v_mfma_f32_16x16x32_bf16 v[164:167], v[144:147], v[80:83], v[164:167]
    ds_read_b128 v[128:131], v241 offset:52224
    s_waitcnt lgkmcnt(7)
    v_mfma_f32_16x16x32_bf16 v[156:159], v[100:103], v[84:87], v[156:159]
    ds_read_b128 v[132:135], v241 offset:53248
    s_waitcnt lgkmcnt(7)
    v_mfma_f32_16x16x32_bf16 v[160:163], v[104:107], v[84:87], v[160:163]
    ds_read_b128 v[136:139], v241 offset:57344
    s_waitcnt lgkmcnt(7)
    v_mfma_f32_16x16x32_bf16 v[164:167], v[108:111], v[84:87], v[164:167]
    ds_read_b128 v[140:143], v241 offset:58368
    s_waitcnt lgkmcnt(7)
    v_mfma_f32_16x16x32_bf16 v[156:159], v[112:115], v[88:91], v[156:159]
    ds_read_b128 v[144:147], v241 offset:59392
    s_waitcnt lgkmcnt(7)
    v_mfma_f32_16x16x32_bf16 v[160:163], v[116:119], v[88:91], v[160:163]
    s_waitcnt lgkmcnt(6)
    v_mfma_f32_16x16x32_bf16 v[164:167], v[120:123], v[88:91], v[164:167]
    s_waitcnt lgkmcnt(5)
    v_mfma_f32_16x16x32_bf16 v[156:159], v[124:127], v[92:95], v[156:159]
    s_waitcnt lgkmcnt(4)
    v_mfma_f32_16x16x32_bf16 v[160:163], v[128:131], v[92:95], v[160:163]
    s_waitcnt lgkmcnt(3)
    v_mfma_f32_16x16x32_bf16 v[164:167], v[132:135], v[92:95], v[164:167]
    s_waitcnt lgkmcnt(2)
    v_mfma_f32_16x16x32_bf16 v[156:159], v[136:139], v[96:99], v[156:159]
    s_waitcnt lgkmcnt(1)
    v_mfma_f32_16x16x32_bf16 v[160:163], v[140:143], v[96:99], v[160:163]
    s_waitcnt lgkmcnt(0)
    v_mfma_f32_16x16x32_bf16 v[164:167], v[144:147], v[96:99], v[164:167]
    v_mul_f32 v214, 0x3ea52b5c, v213
    v_pk_fma_f32 v[148:149], v[212:213], v[216:217], v[148:149] op_sel_hi:[0,1,1]
    v_pk_fma_f32 v[150:151], v[212:213], v[218:219], v[150:151] op_sel_hi:[0,1,1]
    v_pk_fma_f32 v[152:153], v[212:213], v[220:221], v[152:153] op_sel_hi:[0,1,1]
    v_pk_fma_f32 v[154:155], v[212:213], v[222:223], v[154:155] op_sel_hi:[0,1,1]
    v_pk_fma_f32 v[156:157], v[212:213], v[224:225], v[156:157] op_sel_hi:[0,1,1]
    v_pk_fma_f32 v[158:159], v[212:213], v[226:227], v[158:159] op_sel_hi:[0,1,1]
    v_pk_fma_f32 v[160:161], v[212:213], v[228:229], v[160:161] op_sel_hi:[0,1,1]
    v_pk_fma_f32 v[162:163], v[212:213], v[230:231], v[162:163] op_sel_hi:[0,1,1]
    v_pk_fma_f32 v[164:165], v[212:213], v[232:233], v[164:165] op_sel_hi:[0,1,1]
    v_pk_fma_f32 v[166:167], v[212:213], v[234:235], v[166:167] op_sel_hi:[0,1,1]
    v_pk_mul_f32 v[148:149], v[214:215], v[148:149] op_sel_hi:[0,1]
    v_pk_mul_f32 v[150:151], v[214:215], v[150:151] op_sel_hi:[0,1]
    v_pk_mul_f32 v[152:153], v[214:215], v[152:153] op_sel_hi:[0,1]
    v_pk_mul_f32 v[154:155], v[214:215], v[154:155] op_sel_hi:[0,1]
    v_pk_mul_f32 v[156:157], v[214:215], v[156:157] op_sel_hi:[0,1]
    v_pk_mul_f32 v[158:159], v[214:215], v[158:159] op_sel_hi:[0,1]
    v_pk_mul_f32 v[160:161], v[214:215], v[160:161] op_sel_hi:[0,1]
    v_pk_mul_f32 v[162:163], v[214:215], v[162:163] op_sel_hi:[0,1]
    v_pk_mul_f32 v[164:165], v[214:215], v[164:165] op_sel_hi:[0,1]
    v_pk_mul_f32 v[166:167], v[214:215], v[166:167] op_sel_hi:[0,1]
    v_cvt_pk_bf16_f32 v176, v148, v149
    v_cvt_pk_bf16_f32 v177, v150, v151
    v_cvt_pk_bf16_f32 v178, v152, v153
    v_cvt_pk_bf16_f32 v179, v154, v155
    v_cvt_pk_bf16_f32 v180, v156, v157
    v_cvt_pk_bf16_f32 v181, v158, v159
    v_cvt_pk_bf16_f32 v182, v160, v161
    v_cvt_pk_bf16_f32 v183, v162, v163
    v_cvt_pk_bf16_f32 v184, v164, v165
    v_mov_b32 v185, 0
    v_cvt_pk_bf16_f32 v186, v166, v167
    v_mov_b32 v187, 0
    s_lshr_b32 s36, s20, 1
    s_mul_i32 s36, s36, 1536
    s_add_u32 s36, s36, 147456
    s_and_b32 s37, s20, 1
    s_lshl_b32 s37, s37, 4
    v_add_u32 v6, s37, v3
    v_mul_u32_u24 v7, 3072, v4
    v_add_u32 v7, s36, v7
    v_lshl_add_u32 v5, v6, 4, v7
    v_lshl_add_u32 v6, v6, 3, v7
    ds_write_b128 v5, v[176:179]
    ds_write_b128 v5, v[180:183] offset:512
    ds_write_b64 v6, v[184:185] offset:1024
    ds_write_b64 v6, v[186:187] offset:1280
    s_waitcnt lgkmcnt(0)
    s_barrier
    s_mov_b32 s69, 1073741824
    s_mov_b32 s70, 1073741824
    s_mov_b32 s71, 1073741824
    s_mov_b32 s72, 1073741824
    v_mov_b32 v220, 0
    s_branch L_layer
L_final:
    s_mul_i32 s36, s23, 81920
    s_mul_i32 s37, s20, 20480
    s_add_u32 s36, s36, s37
    s_mul_i32 s37, s24, 160
    s_add_u32 s36, s36, s37
    v_mul_u32_u24 v6, 1280, v3
    v_lshl_add_u32 v6, v4, 3, v6
    v_and_b32 v7, 1, v4
    v_mul_u32_u24 v7, 24, v7
    v_add_u32 v7, v6, v7
    v_dot2c_f32_bf16 v40, s66, v8
    v_dot2c_f32_bf16 v41, s67, v8
    v_dot2c_f32_bf16 v42, s66, v9
    v_dot2c_f32_bf16 v43, s67, v9
    v_dot2c_f32_bf16 v44, s66, v10
    v_dot2c_f32_bf16 v45, s67, v10
    v_dot2c_f32_bf16 v46, s66, v11
    v_dot2c_f32_bf16 v47, s67, v11
    v_dot2c_f32_bf16 v48, s66, v12
    v_dot2c_f32_bf16 v49, s67, v12
    v_dot2c_f32_bf16 v50, s66, v13
    v_dot2c_f32_bf16 v51, s67, v13
    v_dot2c_f32_bf16 v52, s66, v14
    v_dot2c_f32_bf16 v53, s67, v14
    v_dot2c_f32_bf16 v54, s66, v15
    v_dot2c_f32_bf16 v55, s67, v15
    v_dot2c_f32_bf16 v56, s66, v16
    v_dot2c_f32_bf16 v57, s67, v16
    v_dot2c_f32_bf16 v58, s66, v17
    v_dot2c_f32_bf16 v59, s67, v17
    v_cvt_pk_bf16_f32 v8, v40, v41
    v_cvt_pk_bf16_f32 v9, v42, v43
    v_cvt_pk_bf16_f32 v10, v44, v45
    v_cvt_pk_bf16_f32 v11, v46, v47
    v_cvt_pk_bf16_f32 v12, v48, v49
    v_cvt_pk_bf16_f32 v13, v50, v51
    v_cvt_pk_bf16_f32 v14, v52, v53
    v_cvt_pk_bf16_f32 v15, v54, v55
    v_cvt_pk_bf16_f32 v16, v56, v57
    v_cvt_pk_bf16_f32 v17, v58, v59
    v_permlane16_swap_b32 v8, v10
    v_permlane16_swap_b32 v9, v11
    buffer_store_dwordx4 v[8:11], v7, s[8:11], s36 offen offset:0
    v_permlane16_swap_b32 v12, v14
    v_permlane16_swap_b32 v13, v15
    buffer_store_dwordx4 v[12:15], v7, s[8:11], s36 offen offset:64
    buffer_store_dwordx2 v[16:17], v6, s[8:11], s36 offen offset:128
L_end:
    s_endpgm
L_sg_29:
    buffer_wbl2 sc1
    s_waitcnt vmcnt(0)
    buffer_store_dword v5, off, s[4:7], s49 sc1
    s_branch L_sj_30
L_pg_34:
    s_waitcnt vmcnt(0)
    buffer_inv sc1
    s_waitcnt vmcnt(0)
    s_branch L_pj_35
L_sg_36:
    buffer_wbl2 sc1
    s_waitcnt vmcnt(0)
    buffer_store_dword v5, off, s[4:7], s40 sc1
    s_branch L_sj_37
L_pg_41:
    s_waitcnt vmcnt(0)
    buffer_inv sc1
    s_waitcnt vmcnt(0)
    s_branch L_pj_42
L_sg_44:
    buffer_wbl2 sc1
    s_waitcnt vmcnt(0)
    buffer_store_dword v5, off, s[4:7], s88 sc1
    s_branch L_sj_45
L_pg_48:
    s_waitcnt vmcnt(0)
    buffer_inv sc1
    s_waitcnt vmcnt(0)
    s_branch L_pj_49
L_sg_50:
    buffer_wbl2 sc1
    s_waitcnt vmcnt(0)
    buffer_store_dword v5, off, s[4:7], s40 sc1
    s_branch L_sj_51
L_pg_54:
    s_waitcnt vmcnt(0)
    buffer_inv sc1
    s_waitcnt vmcnt(0)
    s_branch L_pj_55
L_slow:
    s_mov_b32 s69, 1073741824
    s_mov_b32 s70, 1073741824
    s_mov_b32 s71, 1073741824
    s_mov_b32 s72, 1073741824
    v_mov_b32 v220, 0
    s_mov_b32 s76, 1
    s_waitcnt vmcnt(0)
    s_barrier
    v_mov_b32 v7, 0
    ds_write_b32 v6, v7
    s_mul_i32 s60, s20, 45056
    s_add_u32 s60, s60, s56
    v_lshlrev_b32 v116, 4, v0
    v_and_b32 v119, 31, v0
    v_lshrrev_b32 v120, 5, v0
    v_lshlrev_b32 v117, 3, v119
    v_lshl_add_u32 v117, v120, 2, v117
    v_lshlrev_b32 v118, 4, v119
    v_mad_u32_u24 v118, v120, s59, v118
    v_cmp_lt_u32 vcc, 20, v119
    v_mov_b32 v120, 0x40000000
    s_nop 0
    v_cndmask_b32 v118, v118, v120, vcc
    buffer_load_dwordx4 a[0:3], v116, s[4:7], s60 offen sc1
    buffer_load_dword a192, v117, s[4:7], s60 offen offset:1024 sc1
    buffer_load_dwordx4 a[4:7], v118, s[4:7], s60 offen offset:1280 sc1
    buffer_load_dwordx4 a[8:11], v118, s[4:7], s60 offen offset:2048 sc1
    s_add_u32 s60, s60, 2816
    buffer_load_dwordx4 a[12:15], v116, s[4:7], s60 offen sc1
    buffer_load_dword a194, v117, s[4:7], s60 offen offset:1024 sc1
    buffer_load_dwordx4 a[16:19], v118, s[4:7], s60 offen offset:1280 sc1
    buffer_load_dwordx4 a[20:23], v118, s[4:7], s60 offen offset:2048 sc1
    s_add_u32 s60, s60, 2816
    buffer_load_dwordx4 a[24:27], v116, s[4:7], s60 offen sc1
    buffer_load_dword a196, v117, s[4:7], s60 offen offset:1024 sc1
    buffer_load_dwordx4 a[28:31], v118, s[4:7], s60 offen offset:1280 sc1
    buffer_load_dwordx4 a[32:35], v118, s[4:7], s60 offen offset:2048 sc1
    s_add_u32 s60, s60, 2816
    buffer_load_dwordx4 a[36:39], v116, s[4:7], s60 offen sc1
    buffer_load_dword a198, v117, s[4:7], s60 offen offset:1024 sc1
    buffer_load_dwordx4 a[40:43], v118, s[4:7], s60 offen offset:1280 sc1
    buffer_load_dwordx4 a[44:47], v118, s[4:7], s60 offen offset:2048 sc1
    s_add_u32 s60, s60, 2816
    buffer_load_dwordx4 a[48:51], v116, s[4:7], s60 offen sc1
    buffer_load_dword a200, v117, s[4:7], s60 offen offset:1024 sc1
    buffer_load_dwordx4 a[52:55], v118, s[4:7], s60 offen offset:1280 sc1
    buffer_load_dwordx4 a[56:59], v118, s[4:7], s60 offen offset:2048 sc1
    s_add_u32 s60, s60, 2816
    buffer_load_dwordx4 a[60:63], v116, s[4:7], s60 offen sc1
    buffer_load_dword a202, v117, s[4:7], s60 offen offset:1024 sc1
    buffer_load_dwordx4 a[64:67], v118, s[4:7], s60 offen offset:1280 sc1
    buffer_load_dwordx4 a[68:71], v118, s[4:7], s60 offen offset:2048 sc1
    s_add_u32 s60, s60, 2816
    buffer_load_dwordx4 a[72:75], v116, s[4:7], s60 offen sc1
    buffer_load_dword a204, v117, s[4:7], s60 offen offset:1024 sc1
    buffer_load_dwordx4 a[76:79], v118, s[4:7], s60 offen offset:1280 sc1
    buffer_load_dwordx4 a[80:83], v118, s[4:7], s60 offen offset:2048 sc1
    s_add_u32 s60, s60, 2816
    buffer_load_dwordx4 a[84:87], v116, s[4:7], s60 offen sc1
    buffer_load_dword a206, v117, s[4:7], s60 offen offset:1024 sc1
    buffer_load_dwordx4 a[88:91], v118, s[4:7], s60 offen offset:1280 sc1
    buffer_load_dwordx4 a[92:95], v118, s[4:7], s60 offen offset:2048 sc1
    s_add_u32 s60, s60, 2816
    s_waitcnt vmcnt(0)
    buffer_load_dwordx4 a[96:99], v116, s[4:7], s60 offen sc1
    buffer_load_dword a208, v117, s[4:7], s60 offen offset:1024 sc1
    buffer_load_dwordx4 a[100:103], v118, s[4:7], s60 offen offset:1280 sc1
    buffer_load_dwordx4 a[104:107], v118, s[4:7], s60 offen offset:2048 sc1
    s_add_u32 s60, s60, 2816
    buffer_load_dwordx4 a[108:111], v116, s[4:7], s60 offen sc1
    buffer_load_dword a210, v117, s[4:7], s60 offen offset:1024 sc1
    buffer_load_dwordx4 a[112:115], v118, s[4:7], s60 offen offset:1280 sc1
    buffer_load_dwordx4 a[116:119], v118, s[4:7], s60 offen offset:2048 sc1
    s_add_u32 s60, s60, 2816
    buffer_load_dwordx4 a[120:123], v116, s[4:7], s60 offen sc1
    buffer_load_dword a212, v117, s[4:7], s60 offen offset:1024 sc1
    buffer_load_dwordx4 a[124:127], v118, s[4:7], s60 offen offset:1280 sc1
    buffer_load_dwordx4 a[128:131], v118, s[4:7], s60 offen offset:2048 sc1
    s_add_u32 s60, s60, 2816
    buffer_load_dwordx4 a[132:135], v116, s[4:7], s60 offen sc1
    buffer_load_dword a214, v117, s[4:7], s60 offen offset:1024 sc1
    buffer_load_dwordx4 a[136:139], v118, s[4:7], s60 offen offset:1280 sc1
    buffer_load_dwordx4 a[140:143], v118, s[4:7], s60 offen offset:2048 sc1
    s_add_u32 s60, s60, 2816
    buffer_load_dwordx4 a[144:147], v116, s[4:7], s60 offen sc1
    buffer_load_dword a216, v117, s[4:7], s60 offen offset:1024 sc1
    buffer_load_dwordx4 a[148:151], v118, s[4:7], s60 offen offset:1280 sc1
    buffer_load_dwordx4 a[152:155], v118, s[4:7], s60 offen offset:2048 sc1
    s_add_u32 s60, s60, 2816
    buffer_load_dwordx4 a[156:159], v116, s[4:7], s60 offen sc1
    buffer_load_dword a218, v117, s[4:7], s60 offen offset:1024 sc1
    buffer_load_dwordx4 a[160:163], v118, s[4:7], s60 offen offset:1280 sc1
    buffer_load_dwordx4 a[164:167], v118, s[4:7], s60 offen offset:2048 sc1
    s_add_u32 s60, s60, 2816
    buffer_load_dwordx4 a[168:171], v116, s[4:7], s60 offen sc1
    buffer_load_dword a220, v117, s[4:7], s60 offen offset:1024 sc1
    buffer_load_dwordx4 a[172:175], v118, s[4:7], s60 offen offset:1280 sc1
    buffer_load_dwordx4 a[176:179], v118, s[4:7], s60 offen offset:2048 sc1
    s_add_u32 s60, s60, 2816
    buffer_load_dwordx4 a[180:183], v116, s[4:7], s60 offen sc1
    buffer_load_dword a222, v117, s[4:7], s60 offen offset:1024 sc1
    buffer_load_dwordx4 a[184:187], v118, s[4:7], s60 offen offset:1280 sc1
    buffer_load_dwordx4 a[188:191], v118, s[4:7], s60 offen offset:2048 sc1
    s_add_u32 s60, s60, 2816
    s_waitcnt vmcnt(0)
    s_mov_b32 s62, 0
L_mx_100001:
    s_mul_i32 s61, s62, 1536
    s_add_u32 s61, s61, 147456
    v_lshl_add_u32 v112, v0, 4, s61
    v_lshl_add_u32 v113, v0, 3, s61
    ds_read_b128 v[100:103], v112 offset:0
    ds_read_b64 v[108:109], v113 offset:1024
    v_mov_b32 v116, 0xff800000
    s_waitcnt lgkmcnt(0)
    v_mfma_f32_32x32x16_bf16 v[20:35], a[0:3], v[100:103], 0
    v_mfma_f32_32x32x8_bf16 v[20:35], a[192:193], v[108:109], v[20:35]
    s_nop 11
    v_max3_f32 v116, v116, v20, v21
    v_max3_f32 v116, v116, v22, v23
    v_max3_f32 v116, v116, v24, v25
    v_max3_f32 v116, v116, v26, v27
    v_max3_f32 v116, v116, v28, v29
    v_max3_f32 v116, v116, v30, v31
    v_max3_f32 v116, v116, v32, v33
    v_max3_f32 v116, v116, v34, v35
    v_mfma_f32_32x32x16_bf16 v[36:51], a[12:15], v[100:103], 0
    v_mfma_f32_32x32x8_bf16 v[36:51], a[194:195], v[108:109], v[36:51]
    s_nop 11
    v_max3_f32 v116, v116, v36, v37
    v_max3_f32 v116, v116, v38, v39
    v_max3_f32 v116, v116, v40, v41
    v_max3_f32 v116, v116, v42, v43
    v_max3_f32 v116, v116, v44, v45
    v_max3_f32 v116, v116, v46, v47
    s_nop 5
    v_max3_f32 v116, v116, v48, v49
    v_max3_f32 v116, v116, v50, v51
    v_mfma_f32_32x32x16_bf16 v[20:35], a[24:27], v[100:103], 0
    v_mfma_f32_32x32x8_bf16 v[20:35], a[196:197], v[108:109], v[20:35]
    s_nop 11
    v_max3_f32 v116, v116, v20, v21
    v_max3_f32 v116, v116, v22, v23
    v_max3_f32 v116, v116, v24, v25
    v_max3_f32 v116, v116, v26, v27
    v_max3_f32 v116, v116, v28, v29
    s_nop 6
    v_max3_f32 v116, v116, v30, v31
    v_max3_f32 v116, v116, v32, v33
    v_max3_f32 v116, v116, v34, v35
    v_mfma_f32_32x32x16_bf16 v[36:51], a[36:39], v[100:103], 0
    v_mfma_f32_32x32x8_bf16 v[36:51], a[198:199], v[108:109], v[36:51]
    s_nop 11
    v_max3_f32 v116, v116, v36, v37
    v_max3_f32 v116, v116, v38, v39
    s_nop 9
    v_max3_f32 v116, v116, v40, v41
    v_max3_f32 v116, v116, v42, v43
    v_max3_f32 v116, v116, v44, v45
    v_max3_f32 v116, v116, v46, v47
    v_max3_f32 v116, v116, v48, v49
    v_max3_f32 v116, v116, v50, v51
    v_mfma_f32_32x32x16_bf16 v[20:35], a[48:51], v[100:103], 0
    v_mfma_f32_32x32x8_bf16 v[20:35], a[200:201], v[108:109], v[20:35]
    s_nop 11
    v_max3_f32 v116, v116, v20, v21
    v_max3_f32 v116, v116, v22, v23
    v_max3_f32 v116, v116, v24, v25
    v_max3_f32 v116, v116, v26, v27
    v_max3_f32 v116, v116, v28, v29
    v_max3_f32 v116, v116, v30, v31
    v_max3_f32 v116, v116, v32, v33
    v_max3_f32 v116, v116, v34, v35
    v_mfma_f32_32x32x16_bf16 v[36:51], a[60:63], v[100:103], 0
    v_mfma_f32_32x32x8_bf16 v[36:51], a[202:203], v[108:109], v[36:51]
    s_nop 11
    v_max3_f32 v116, v116, v36, v37
    v_max3_f32 v116, v116, v38, v39
    v_max3_f32 v116, v116, v40, v41
    v_max3_f32 v116, v116, v42, v43
    v_max3_f32 v116, v116, v44, v45
    v_max3_f32 v116, v116, v46, v47
    v_max3_f32 v116, v116, v48, v49
    v_max3_f32 v116, v116, v50, v51
    v_mfma_f32_32x32x16_bf16 v[20:35], a[72:75], v[100:103], 0
    v_mfma_f32_32x32x8_bf16 v[20:35], a[204:205], v[108:109], v[20:35]
    s_nop 11
    v_max3_f32 v116, v116, v20, v21
    v_max3_f32 v116, v116, v22, v23
    v_max3_f32 v116, v116, v24, v25
    v_max3_f32 v116, v116, v26, v27
    v_max3_f32 v116, v116, v28, v29
    v_max3_f32 v116, v116, v30, v31
    s_nop 5
    v_max3_f32 v116, v116, v32, v33
    v_max3_f32 v116, v116, v34, v35
    v_mfma_f32_32x32x16_bf16 v[36:51], a[84:87], v[100:103], 0
    v_mfma_f32_32x32x8_bf16 v[36:51], a[206:207], v[108:109], v[36:51]
    s_nop 11
    v_max3_f32 v116, v116, v36, v37
    v_max3_f32 v116, v116, v38, v39
    v_max3_f32 v116, v116, v40, v41
    v_max3_f32 v116, v116, v42, v43
    v_max3_f32 v116, v116, v44, v45
    s_nop 6
    v_max3_f32 v116, v116, v46, v47
    v_max3_f32 v116, v116, v48, v49
    v_max3_f32 v116, v116, v50, v51
    v_mfma_f32_32x32x16_bf16 v[20:35], a[96:99], v[100:103], 0
    v_mfma_f32_32x32x8_bf16 v[20:35], a[208:209], v[108:109], v[20:35]
    s_nop 11
    v_max3_f32 v116, v116, v20, v21
    v_max3_f32 v116, v116, v22, v23
    s_nop 9
    v_max3_f32 v116, v116, v24, v25
    v_max3_f32 v116, v116, v26, v27
    v_max3_f32 v116, v116, v28, v29
    v_max3_f32 v116, v116, v30, v31
    v_max3_f32 v116, v116, v32, v33
    v_max3_f32 v116, v116, v34, v35
    v_mfma_f32_32x32x16_bf16 v[36:51], a[108:111], v[100:103], 0
    v_mfma_f32_32x32x8_bf16 v[36:51], a[210:211], v[108:109], v[36:51]
    s_nop 11
    v_max3_f32 v116, v116, v36, v37
    v_max3_f32 v116, v116, v38, v39
    v_max3_f32 v116, v116, v40, v41
    v_max3_f32 v116, v116, v42, v43
    v_max3_f32 v116, v116, v44, v45
    v_max3_f32 v116, v116, v46, v47
    v_max3_f32 v116, v116, v48, v49
    v_max3_f32 v116, v116, v50, v51
    v_mfma_f32_32x32x16_bf16 v[20:35], a[120:123], v[100:103], 0
    v_mfma_f32_32x32x8_bf16 v[20:35], a[212:213], v[108:109], v[20:35]
    s_nop 11
    v_max3_f32 v116, v116, v20, v21
    v_max3_f32 v116, v116, v22, v23
    v_max3_f32 v116, v116, v24, v25
    v_max3_f32 v116, v116, v26, v27
    v_max3_f32 v116, v116, v28, v29
    v_max3_f32 v116, v116, v30, v31
    v_max3_f32 v116, v116, v32, v33
    v_max3_f32 v116, v116, v34, v35
    v_mfma_f32_32x32x16_bf16 v[36:51], a[132:135], v[100:103], 0
    v_mfma_f32_32x32x8_bf16 v[36:51], a[214:215], v[108:109], v[36:51]
    s_nop 11
    v_max3_f32 v116, v116, v36, v37
    v_max3_f32 v116, v116, v38, v39
    v_max3_f32 v116, v116, v40, v41
    v_max3_f32 v116, v116, v42, v43
    v_max3_f32 v116, v116, v44, v45
    v_max3_f32 v116, v116, v46, v47
    s_nop 5
    v_max3_f32 v116, v116, v48, v49
    v_max3_f32 v116, v116, v50, v51
    v_mfma_f32_32x32x16_bf16 v[20:35], a[144:147], v[100:103], 0
    v_mfma_f32_32x32x8_bf16 v[20:35], a[216:217], v[108:109], v[20:35]
    s_nop 11
    v_max3_f32 v116, v116, v20, v21
    v_max3_f32 v116, v116, v22, v23
    v_max3_f32 v116, v116, v24, v25
    v_max3_f32 v116, v116, v26, v27
    v_max3_f32 v116, v116, v28, v29
    s_nop 6
    v_max3_f32 v116, v116, v30, v31
    v_max3_f32 v116, v116, v32, v33
    v_max3_f32 v116, v116, v34, v35
    v_mfma_f32_32x32x16_bf16 v[36:51], a[156:159], v[100:103], 0
    v_mfma_f32_32x32x8_bf16 v[36:51], a[218:219], v[108:109], v[36:51]
    s_nop 11
    v_max3_f32 v116, v116, v36, v37
    v_max3_f32 v116, v116, v38, v39
    s_nop 9
    v_max3_f32 v116, v116, v40, v41
    v_max3_f32 v116, v116, v42, v43
    v_max3_f32 v116, v116, v44, v45
    v_max3_f32 v116, v116, v46, v47
    v_max3_f32 v116, v116, v48, v49
    v_max3_f32 v116, v116, v50, v51
    v_mfma_f32_32x32x16_bf16 v[20:35], a[168:171], v[100:103], 0
    v_mfma_f32_32x32x8_bf16 v[20:35], a[220:221], v[108:109], v[20:35]
    s_nop 11
    v_max3_f32 v116, v116, v20, v21
    v_max3_f32 v116, v116, v22, v23
    v_max3_f32 v116, v116, v24, v25
    v_max3_f32 v116, v116, v26, v27
    v_max3_f32 v116, v116, v28, v29
    v_max3_f32 v116, v116, v30, v31
    v_max3_f32 v116, v116, v32, v33
    v_max3_f32 v116, v116, v34, v35
    v_mfma_f32_32x32x16_bf16 v[36:51], a[180:183], v[100:103], 0
    v_mfma_f32_32x32x8_bf16 v[36:51], a[222:223], v[108:109], v[36:51]
    s_nop 11
    v_max3_f32 v116, v116, v36, v37
    v_max3_f32 v116, v116, v38, v39
    v_max3_f32 v116, v116, v40, v41
    v_max3_f32 v116, v116, v42, v43
    v_max3_f32 v116, v116, v44, v45
    v_max3_f32 v116, v116, v46, v47
    v_max3_f32 v116, v116, v48, v49
    v_max3_f32 v116, v116, v50, v51
    v_mov_b32 v117, v116
    s_nop 1
    v_permlane32_swap_b32 v116, v117
    v_max_f32 v116, v116, v117
    s_lshl_b32 s61, s62, 2
    s_add_u32 s61, s61, s20
    s_lshl_b32 s61, s61, 8
    s_add_u32 s61, s61, 122880
    v_lshl_add_u32 v118, v0, 2, s61
    ds_write_b32 v118, v116
    s_add_u32 s62, s62, 1
    s_cmp_lt_u32 s62, 8
    s_cbranch_scc1 L_mx_100001
    s_waitcnt lgkmcnt(0)
    s_barrier
    s_lshl_b32 s61, s20, 11
    s_add_u32 s61, s61, 122880
    v_lshl_add_u32 v118, v0, 2, s61
    s_mul_i32 s61, s20, 3072
    s_add_u32 s61, s61, 148484
    v_lshl_add_u32 v113, v0, 3, s61
    v_cmp_lt_u32 s[64:65], 31, v0
    ds_read_b32 v20, v118 offset:0
    ds_read_b32 v21, v118 offset:256
    ds_read_b32 v22, v118 offset:512
    ds_read_b32 v23, v118 offset:768
    s_waitcnt lgkmcnt(0)
    v_max_f32 v20, v20, v21
    v_max3_f32 v20, v20, v22, v23
    v_sub_f32 v20, 0, v20
    v_and_b32 v21, 0xffff0000, v20
    v_sub_f32 v20, v20, v21
    v_and_b32 v22, 0xffff0000, v20
    v_sub_f32 v20, v20, v22
    v_lshrrev_b32 v21, 16, v21
    v_or_b32 v21, v21, v22
    v_lshrrev_b32 v20, 16, v20
    v_cndmask_b32 v20, v21, v20, s[64:65]
    ds_write_b32 v113, v20 offset:0
    ds_read_b32 v20, v118 offset:1024
    ds_read_b32 v21, v118 offset:1280
    ds_read_b32 v22, v118 offset:1536
    ds_read_b32 v23, v118 offset:1792
    s_waitcnt lgkmcnt(0)
    v_max_f32 v20, v20, v21
    v_max3_f32 v20, v20, v22, v23
    v_sub_f32 v20, 0, v20
    v_and_b32 v21, 0xffff0000, v20
    v_sub_f32 v20, v20, v21
    v_and_b32 v22, 0xffff0000, v20
    v_sub_f32 v20, v20, v22
    v_lshrrev_b32 v21, 16, v21
    v_or_b32 v21, v21, v22
    v_lshrrev_b32 v20, 16, v20
    v_cndmask_b32 v20, v21, v20, s[64:65]
    ds_write_b32 v113, v20 offset:1536
    s_waitcnt lgkmcnt(0)
    s_barrier
    s_branch L_att
L_codeend:
.section .rodata,"a"
.p2align 6
.amdhsa_kernel interleave_layers__grouped_kv_mqa__dense_activation_mish__prompt_kernel
  .amdhsa_next_free_vgpr 512
  .amdhsa_next_free_sgpr 102
  .amdhsa_accum_offset 256
  .amdhsa_group_segment_fixed_size 0
  .amdhsa_kernarg_size 96
  .amdhsa_user_sgpr_count 2
  .amdhsa_user_sgpr_kernarg_segment_ptr 1
  .amdhsa_system_sgpr_workgroup_id_x 1
.end_amdhsa_kernel
```
